```python
import torch

def _softmax(x, axis=-1):
    return torch.softmax(x, dim=axis)
def _gelu(x):
    return torch.nn.functional.gelu(x, approximate="tanh")
def _silu(x):
    return torch.nn.functional.silu(x)
def _sigmoid(x):
    return torch.sigmoid(x)
def _layernorm(x, axis=-1, eps=1e-5):
    m = x.mean(dim=axis, keepdim=True)
    v = x.var(dim=axis, keepdim=True, unbiased=False)
    return (x - m) / torch.sqrt(v + eps)
def _scatter_add(tgt, idx, src, axis=0):
    return tgt.clone().index_add_(axis, idx, src)
def _segment_sum(src, seg, n):
    out = torch.zeros((n,) + src.shape[1:], dtype=src.dtype)
    return out.index_add_(0, seg, src)
def _pad(x, pw):
    flat = tuple(v for pair in reversed(pw) for v in pair)
    return torch.nn.functional.pad(x, flat)

kernel_name = 'sequential_preLN__compressed_kv_cla__dense_activation_relu__prompt'

def setup_inputs():

    _w = (lambda a: (lambda t: t.to(torch.bfloat16) if t.is_floating_point() else t)(torch.as_tensor(a)))
    def _A_setup():
        B, H, Sq, Sk, D, M = 1, 32, 2048, 2048, 128, 512
        Dc = 4 * D
        return {
            "x": _w((lambda *s: torch.randn(*s, dtype=torch.bfloat16) * 0.05)(B, Sq, M)),
            "c_kv": _w((lambda *s: torch.randn(*s, dtype=torch.bfloat16) * 0.4)(B, Sk, Dc)),
            "w_q": _w((lambda *s: torch.randn(*s, dtype=torch.bfloat16) * 3.2)(M, H, D) * (M ** -0.5)),
            "w_uk": _w((lambda *s: torch.randn(*s, dtype=torch.bfloat16) * 3.2)(Dc, H, D) * (Dc ** -0.5)),
            "w_uv": _w((lambda *s: torch.randn(*s, dtype=torch.bfloat16) * 0.4)(Dc, H, D) * (Dc ** -0.5)),
            "w_o": _w((lambda *s: torch.randn(*s, dtype=torch.bfloat16) * 0.4)(H, D, M) * ((H * D) ** -0.5)),
        }
    _A_in = _A_setup()

    def _B_setup():
        B, S, D, Dff = 1, 2048, 512, 1792
        return {
            "x": _w((lambda *s: torch.randn(*s, dtype=torch.bfloat16) * 0.05)(B, S, D)),
            "w1": _w((lambda *s: torch.randn(*s, dtype=torch.bfloat16) * 0.05)(D, Dff)),
            "w2": _w((lambda *s: torch.randn(*s, dtype=torch.bfloat16) * 0.05)(Dff, D)),
        }
    _B_in = _B_setup()

    return {
        "A_x": _A_in["x"],
        "A_c_kv": _A_in["c_kv"],
        "A_w_q": _A_in["w_q"],
        "A_w_uk": _A_in["w_uk"],
        "A_w_uv": _A_in["w_uv"],
        "A_w_o": _A_in["w_o"],
        "B_x": _B_in["x"],
        "B_w1": _B_in["w1"],
        "B_w2": _B_in["w2"],
    }

def reference(A_x, A_c_kv, A_w_q, A_w_uk, A_w_uv, A_w_o, B_x, B_w1, B_w2):
    def _A_ref(x, c_kv, w_q, w_uk, w_uv, w_o):
        B, Sq, M = x.shape[0], x.shape[1], x.shape[2]
        Sk = c_kv.shape[1]
        H, D = w_q.shape[1], w_q.shape[2]
        q = torch.einsum("bqm,mhd->bhqd", x, w_q)
        k = torch.einsum("bkc,chd->bhkd", c_kv, w_uk)
        v = torch.einsum("bkc,chd->bhkd", c_kv, w_uv)
        scores = torch.einsum("bhqd,bhkd->bhqk", q, k) * (D ** -0.5)
        off = Sk - Sq
        qi = torch.arange(Sq)[:, None]
        kj = torch.arange(Sk)[None, :]
        cmask = kj <= (qi + off)
        scores = torch.where(cmask[None, None], scores, -1e9)
        p = _softmax(scores, axis=-1)
        ctx = torch.einsum("bhqk,bhkd->bhqd", p, v)
        return torch.einsum("bhqd,hdm->bqm", ctx, w_o)

    def _B_ref(x, w1, w2):
        h = torch.einsum("bsd,df->bsf", x, w1)
        zero = torch.zeros_like(h)
        h = torch.maximum(h, zero)
        return torch.einsum("bsf,fd->bsd", h, w2)

    x = A_x
    h = x + _A_ref(_layernorm(x, axis=-1), A_c_kv, A_w_q, A_w_uk, A_w_uv, A_w_o)
    h2 = h + _B_ref(_layernorm(h, axis=-1), B_w1, B_w2)
    return h2
```

```asm
; @launch kernel=fused_kernel grid=(256,1,1) block=(512,1,1) lds=163840
.amdgcn_target "amdgcn-amd-amdhsa--gfx950"
.text
.globl fused_kernel
.p2align 8
.type fused_kernel,@function
fused_kernel:
    s_cmp_ge_u32 s2, 256
    s_cbranch_scc1 kfend_1
    s_load_dwordx4 s[4:7], s[0:1], 0
    s_load_dwordx4 s[8:11], s[0:1], 16
    s_load_dwordx4 s[12:15], s[0:1], 32
    s_load_dwordx4 s[16:19], s[0:1], 56
    s_load_dwordx4 s[68:71], s[0:1], 80
    v_and_b32 v1, 63, v0
    v_lshrrev_b32 v2, 6, v0
    s_nop 0
    v_readfirstlane_b32 s44, v2
    s_and_b32 s45, s2, 7
    s_lshl_b32 s45, s45, 2
    s_lshr_b32 s46, s2, 3
    s_and_b32 s3, s46, 3
    s_add_u32 s45, s45, s3
    s_lshr_b32 s46, s46, 2
    v_lshrrev_b32 v80, 4, v1
    v_and_b32 v81, 3, v1
    v_bfe_u32 v83, v1, 2, 2
    v_xor_b32 v85, v83, v80
    v_lshlrev_b32 v85, 6, v85
    v_lshlrev_b32 v84, 4, v81
    v_add_u32 v85, v85, v84
    v_lshrrev_b32 v82, 3, v1
    v_and_b32 v84, 7, v1
    v_xor_b32 v84, v84, v80
    v_lshlrev_b32 v84, 4, v84
    v_lshlrev_b32 v10, 10, v82
    v_add_u32 v10, v10, v84
    s_lshl_b32 s48, s46, 18
    s_lshl_b32 s49, s44, 15
    s_add_u32 s48, s48, s49
    v_add_u32 v10, s48, v10
    v_xor_b32 v13, 64, v10
    v_add_u32 v13, 0x2000, v13
    v_lshlrev_b32 v11, 13, v80
    v_add_u32 v11, v11, v85
    s_lshl_b32 s48, s44, 15
    s_lshl_b32 s49, s45, 8
    s_add_u32 s48, s48, s49
    v_add_u32 v11, s48, v11
    s_lshl_b32 s60, s44, 12
    s_lshl_b32 s61, s44, 10
    v_lshlrev_b32 v4, 4, v1
    s_add_u32 s100, s3, s46
    s_and_b32 s100, s100, 3
    s_lshl_b32 s100, s100, 1
    s_lshl_b32 s101, s100, 19
    s_lshl_b32 s100, s100, 7
    s_waitcnt lgkmcnt(0)
    s_mov_b32 s20, s6
    s_mov_b32 s21, s7
    s_mov_b32 s22, 2097152
    s_mov_b32 s23, 0x20000
    s_mov_b32 s24, s10
    s_mov_b32 s25, s11
    s_mov_b32 s26, 4194304
    s_mov_b32 s27, 0x20000
    s_mov_b32 s28, s12
    s_mov_b32 s29, s13
    s_mov_b32 s30, 4194304
    s_mov_b32 s31, 0x20000
    s_add_u32 m0, s61, 98304
    s_add_u32 s62, s101, 0
    s_and_b32 s62, s62, 0x3fffff
    buffer_load_dwordx4 v11, s[24:27], s62 offen lds
    s_add_u32 m0, s61, 106496
    s_add_u32 s62, s101, 0
    s_and_b32 s62, s62, 0x3fffff
    buffer_load_dwordx4 v11, s[28:31], s62 offen lds
    s_add_u32 m0, s60, 32768
    s_add_u32 s62, s100, 0
    s_and_b32 s62, s62, 1023
    buffer_load_dwordx4 v10, s[20:23], s62 offen lds
    s_add_u32 m0, s60, 33792
    s_add_u32 s62, s100, 0
    s_and_b32 s62, s62, 1023
    buffer_load_dwordx4 v13, s[20:23], s62 offen lds
    s_add_u32 m0, s60, 34816
    s_add_u32 s62, s100, 0
    s_and_b32 s62, s62, 1023
    s_add_u32 s62, s62, 16384
    buffer_load_dwordx4 v10, s[20:23], s62 offen lds
    s_add_u32 m0, s60, 35840
    s_add_u32 s62, s100, 0
    s_and_b32 s62, s62, 1023
    s_add_u32 s62, s62, 16384
    buffer_load_dwordx4 v13, s[20:23], s62 offen lds
    s_mov_b32 s32, s70
    s_mov_b32 s33, s71
    s_mov_b32 s34, 268435456
    s_mov_b32 s35, 0x20000
    s_mov_b32 s40, s4
    s_mov_b32 s41, s5
    s_mov_b32 s42, 2097152
    s_mov_b32 s43, 0x20000
    s_sub_u32 s47, 15, s46
    s_mov_b32 s58, 1073741824
    s_cmp_ge_u32 s44, 3
    s_cbranch_scc1 t_2
    s_mov_b32 s72, s6
    s_mov_b32 s73, s7
    s_mov_b32 s74, 2097152
    s_mov_b32 s75, 0x20000
    s_lshl_b32 s48, s46, 8
    s_lshl_b32 s49, s3, 6
    s_add_u32 s48, s48, s49
    v_add_u32 v7, s48, v1
    v_lshlrev_b32 v7, 10, v7
    s_cmp_eq_u32 s44, 0
    s_cselect_b32 s63, 128, s58
    s_lshl_b32 s48, s44, 7
    s_add_u32 s64, s48, 256
    s_add_u32 s65, s48, 640
    s_branch t_4
t_2:
    v_lshlrev_b32 v7, 5, v82
    v_bfe_u32 v84, v1, 1, 2
    v_add_u32 v7, v7, v84
    s_lshl_b32 s48, s46, 2
    v_add_u32 v7, s48, v7
    v_lshlrev_b32 v7, 13, v7
    v_and_b32 v84, 1, v1
    v_lshlrev_b32 v84, 7, v84
    s_lshl_b32 s48, s45, 8
    v_add3_u32 v7, v7, v84, s48
    s_cmp_ge_u32 s44, 5
    s_cbranch_scc1 t_3
    s_cmp_eq_u32 s44, 3
    s_cselect_b32 s72, s10, s12
    s_cselect_b32 s73, s11, s13
    s_mov_b32 s74, 0x400000
    s_mov_b32 s75, 0x20000
    s_mov_b32 s63, 262144
    s_mov_b32 s64, 2359296
    s_mov_b32 s65, s58
    s_branch t_4
t_3:
    s_mov_b32 s72, s8
    s_mov_b32 s73, s9
    s_mov_b32 s74, 4194304
    s_mov_b32 s75, 0x20000
    s_mov_b32 s63, s58
    s_mov_b32 s64, s58
    s_sub_u32 s65, s44, 5
    s_lshl_b32 s65, s65, 21
t_4:
    s_mov_b32 s63, s58
    s_mov_b32 s64, s58
    s_cmp_lt_u32 s44, 5
    s_cselect_b32 s65, s58, s65
    s_lshl_b32 s50, s45, 3
    s_cmp_lt_u32 s50, 128
    s_cselect_b32 s48, s47, s46
    s_lshl_b32 s48, s48, 7
    s_and_b32 s50, s50, 127
    s_add_u32 s50, s50, s48
    s_add_u32 s48, s50, s44
    s_lshl_b32 s48, s48, 10
    s_barrier
    buffer_load_dwordx4 v[88:91], v4, s[40:43], s48 offen
    buffer_load_dword v126, v7, s[72:75], s63 offen
    s_lshr_b32 s48, s50, 5
    s_lshl_b32 s48, s48, 15
    s_and_b32 s49, s50, 31
    s_lshl_b32 s49, s49, 4
    s_add_u32 s48, s48, s49
    s_add_u32 s48, s48, s60
    s_add_u32 s66, s48, 33554432
    s_mov_b32 s4, s8
    s_mov_b32 s5, s9
    s_mov_b32 s6, 4194304
    s_mov_b32 s7, 0x20000
    s_mov_b32 s8, s68
    s_mov_b32 s9, s69
    s_mov_b32 s10, 256
    s_mov_b32 s11, 0x20000
    s_lshl_b32 s50, s2, 2
    s_and_b32 s55, s44, 3
    s_add_u32 s50, s50, s55
    s_add_u32 s55, s50, 1024
    s_cmp_ge_u32 s55, 1472
    s_cbranch_scc1 t_6
    s_mov_b32 s36, s16
    s_mov_b32 s37, s17
    s_mov_b32 s38, 1835008
    s_mov_b32 s39, 0x20000
    s_mov_b32 s51, 3584
    s_sub_u32 s55, s55, 1024
    s_mul_i32 s56, s55, 4682
    s_lshr_b32 s56, s56, 16
    s_mul_i32 s57, s56, 14
    s_sub_u32 s57, s55, s57
    s_mov_b32 s53, 58720256
    s_mov_b32 s54, 32768
    s_branch t_7
t_6:
    s_mov_b32 s36, s18
    s_mov_b32 s37, s19
    s_mov_b32 s38, 1835008
    s_mov_b32 s39, 0x20000
    s_mov_b32 s51, 1024
    s_sub_u32 s55, s55, 1472
    s_lshr_b32 s56, s55, 2
    s_and_b32 s57, s55, 3
    s_mov_b32 s53, 60817408
    s_mov_b32 s54, 114688
t_7:
    s_mul_i32 s52, s56, s51
    s_lshl_b32 s52, s52, 4
    s_lshl_b32 s55, s57, 8
    s_add_u32 s12, s52, s55
    s_lshl_b32 s55, s57, 2
    s_mul_i32 s55, s55, s54
    s_add_u32 s53, s53, s55
    s_lshl_b32 s55, s56, 10
    s_add_u32 s13, s53, s55
    s_mov_b32 s14, s54
    s_mov_b32 s15, s51
    s_cmp_ge_u32 s50, 896
    s_cselect_b32 s12, s58, s12
    s_cselect_b32 s13, s58, s13
    s_cmp_ge_u32 s44, 4
    s_cselect_b32 s13, s58, s13
    v_and_b32 v86, 31, v1
    v_lshrrev_b32 v87, 5, v1
    v_bfe_u32 v84, v1, 1, 3
    v_xor_b32 v14, v87, v84
    v_lshlrev_b32 v14, 4, v14
    v_lshlrev_b32 v84, 7, v86
    v_add_u32 v14, v14, v84
    s_and_b32 s41, s44, 3
    s_lshl_b32 s48, s41, 13
    v_add_u32 v14, s48, v14
    v_xor_b32 v15, 32, v14
    v_xor_b32 v16, 64, v14
    v_xor_b32 v17, 96, v14
    v_add_u32 v24, 0x10000, v14
    v_add_u32 v25, 0x10000, v15
    v_add_u32 v26, 0x10000, v16
    v_add_u32 v27, 0x10000, v17
    s_lshr_b32 s40, s44, 2
    s_lshl_b32 s67, s40, 13
    s_add_u32 s48, s67, 98304
    v_and_b32 v92, 1, v80
    v_lshlrev_b32 v92, 5, v92
    v_lshlrev_b32 v93, 3, v81
    v_add_u32 v92, v92, v93
    v_lshlrev_b32 v93, 8, v83
    v_add_u32 v92, v92, v93
    v_lshlrev_b32 v93, 11, v87
    v_add_u32 v92, v92, v93
    v_xor_b32 v93, 0, v83
    v_lshlrev_b32 v93, 6, v93
    v_add3_u32 v20, v92, v93, s48
    v_xor_b32 v93, 1, v83
    v_lshlrev_b32 v93, 6, v93
    v_add3_u32 v21, v92, v93, s48
    v_xor_b32 v93, 2, v83
    v_lshlrev_b32 v93, 6, v93
    v_add3_u32 v22, v92, v93, s48
    v_xor_b32 v93, 3, v83
    v_lshlrev_b32 v93, 6, v93
    v_add3_u32 v23, v92, v93, s48
    s_lshl_b32 s48, s44, 11
    v_add_u32 v5, s48, v4
    v_add_u32 v3, s67, v4
    s_sub_u32 s48, s41, s40
    s_lshl_b32 s48, s48, 5
    v_lshlrev_b32 v93, 2, v87
    v_sub_u32 v6, v86, v93
    v_add_u32 v6, s48, v6
    v_add_u32 v9, 0x2000, v4
    s_add_u32 m0, s61, 114688
    s_add_u32 s62, s101, 262144
    s_and_b32 s62, s62, 0x3fffff
    buffer_load_dwordx4 v11, s[24:27], s62 offen lds
    s_add_u32 m0, s61, 122880
    s_add_u32 s62, s101, 262144
    s_and_b32 s62, s62, 0x3fffff
    buffer_load_dwordx4 v11, s[28:31], s62 offen lds
    s_lshl_b32 s48, s46, 5
    s_add_u32 s48, s48, s45
    v_lshlrev_b32 v8, 8, v0
    v_add_u32 v8, s48, v8
    v_cmp_eq_u32 vcc, 0, v0
    s_lshl_b32 s48, s46, 2
    v_mov_b32 v92, s48
    v_mov_b32 v93, s58
    v_cndmask_b32 v28, v93, v92, vcc
    s_lshl_b32 s16, s45, 8
    s_add_u32 s16, s16, 75497472
    s_cmp_eq_u32 s44, 4
    s_cselect_b32 s48, 0, s58
    s_cselect_b64 s[56:57], -1, 0
    v_lshlrev_b32 v18, 2, v1
    v_add_u32 v18, s48, v18
    v_mov_b32 v19, 0x01010101
    v_cndmask_b32 v19, 0, v19, s[56:57]
    s_lshr_b32 s48, s47, 1
    v_cmp_ge_u32 vcc, s48, v1
    s_nop 0
    s_and_b64 vcc, vcc, s[56:57]
    v_cndmask_b32 v12, 0, 1, vcc
    s_cmp_eq_u32 s40, 1
    s_cselect_b32 s48, s47, s46
    s_lshl_b32 s48, s48, 2
    s_add_u32 s48, s48, s41
    s_lshl_b32 s48, s48, 15
    s_add_u32 s42, s48, 33554432
    s_waitcnt vmcnt(4)
    s_barrier
    ds_read_b128 v[32:35], v14 offset:32768
    ds_read_b64_tr_b16 v[40:41], v20 offset:0
    ds_read_b64_tr_b16 v[42:43], v20 offset:1024
    ds_read_b128 v[36:39], v14 offset:36864
    ds_read_b64_tr_b16 v[44:45], v21 offset:0
    ds_read_b64_tr_b16 v[46:47], v21 offset:1024
    ds_read_b64_tr_b16 v[48:49], v22 offset:0
    ds_read_b64_tr_b16 v[50:51], v22 offset:1024
    ds_read_b64_tr_b16 v[52:53], v23 offset:0
    ds_read_b64_tr_b16 v[54:55], v23 offset:1024
    s_cmp_ge_u32 s44, 4
    s_cbranch_scc1 kv_8
    s_waitcnt lgkmcnt(7)
    v_mfma_f32_32x32x16_bf16 v[128:143], v[40:43], v[32:35], 0
    ds_read_b128 v[56:59], v15 offset:32768
    ds_read_b64_tr_b16 v[64:65], v20 offset:4096
    s_add_u32 m0, s60, 65536
    s_add_u32 s62, s100, 128
    s_and_b32 s62, s62, 1023
    buffer_load_dwordx4 v10, s[20:23], s62 offen lds
    s_waitcnt vmcnt(4)
    v_lshlrev_b32 v96, 16, v88
    v_and_b32 v97, 0xffff0000, v88
    v_lshlrev_b32 v98, 16, v89
    v_and_b32 v99, 0xffff0000, v89
    v_lshlrev_b32 v100, 16, v90
    v_and_b32 v101, 0xffff0000, v90
    v_lshlrev_b32 v102, 16, v91
    v_and_b32 v103, 0xffff0000, v91
    v_add_f32 v104, v96, v97
    s_waitcnt lgkmcnt(8)
    v_mfma_f32_32x32x16_bf16 v[144:159], v[40:43], v[36:39], 0
    ds_read_b64_tr_b16 v[66:67], v20 offset:5120
    ds_read_b128 v[60:63], v15 offset:36864
    s_add_u32 m0, s60, 66560
    s_add_u32 s62, s100, 128
    s_and_b32 s62, s62, 1023
    buffer_load_dwordx4 v13, s[20:23], s62 offen lds
    v_add_f32 v104, v104, v98
    v_add_f32 v104, v104, v99
    v_add_f32 v104, v104, v100
    v_add_f32 v104, v104, v101
    v_add_f32 v104, v104, v102
    v_add_f32 v104, v104, v103
    s_nop 1
    v_add_f32_dpp v104, v104, v104 quad_perm:[1,0,3,2] row_mask:0xf bank_mask:0xf
    s_nop 1
    v_add_f32_dpp v104, v104, v104 quad_perm:[2,3,0,1] row_mask:0xf bank_mask:0xf
    s_nop 1
    v_add_f32_dpp v104, v104, v104 row_half_mirror row_mask:0xf bank_mask:0xf
    s_waitcnt lgkmcnt(8)
    v_mfma_f32_32x32x16_bf16 v[160:175], v[44:47], v[32:35], 0
    ds_read_b64_tr_b16 v[68:69], v21 offset:4096
    ds_read_b64_tr_b16 v[70:71], v21 offset:5120
    s_add_u32 m0, s60, 67584
    s_add_u32 s62, s100, 128
    s_and_b32 s62, s62, 1023
    s_add_u32 s62, s62, 16384
    buffer_load_dwordx4 v10, s[20:23], s62 offen lds
    v_add_f32_dpp v104, v104, v104 row_mirror row_mask:0xf bank_mask:0xf
    s_nop 0
    v_readlane_b32 s68, v104, 0
    v_readlane_b32 s69, v104, 16
    v_readlane_b32 s70, v104, 32
    v_readlane_b32 s71, v104, 48
    v_mov_b32 v104, s68
    v_add_f32 v104, s69, v104
    v_add_f32 v104, s70, v104
    v_add_f32 v104, s71, v104
    s_add_u32 m0, s60, 68608
    s_add_u32 s62, s100, 128
    s_and_b32 s62, s62, 1023
    s_add_u32 s62, s62, 16384
    buffer_load_dwordx4 v13, s[20:23], s62 offen lds
    v_mfma_f32_32x32x16_bf16 v[176:191], v[44:47], v[36:39], 0
    ds_read_b64_tr_b16 v[72:73], v22 offset:4096
    ds_read_b64_tr_b16 v[74:75], v22 offset:5120
    v_mul_f32 v104, 0x3b000000, v104
    v_sub_f32 v96, v96, v104
    v_sub_f32 v97, v97, v104
    v_sub_f32 v98, v98, v104
    v_sub_f32 v99, v99, v104
    v_sub_f32 v100, v100, v104
    v_sub_f32 v101, v101, v104
    v_sub_f32 v102, v102, v104
    v_sub_f32 v103, v103, v104
    s_add_u32 m0, s61, 131072
    s_add_u32 s62, s101, 524288
    s_and_b32 s62, s62, 0x3fffff
    buffer_load_dwordx4 v11, s[24:27], s62 offen lds
    s_waitcnt lgkmcnt(10)
    v_mfma_f32_32x32x16_bf16 v[192:207], v[48:51], v[32:35], 0
    ds_read_b64_tr_b16 v[76:77], v23 offset:4096
    ds_read_b64_tr_b16 v[78:79], v23 offset:5120
    v_mul_f32 v105, v96, v96
    v_fmac_f32 v105, v97, v97
    v_fmac_f32 v105, v98, v98
    v_fmac_f32 v105, v99, v99
    v_fmac_f32 v105, v100, v100
    v_fmac_f32 v105, v101, v101
    v_fmac_f32 v105, v102, v102
    v_fmac_f32 v105, v103, v103
    s_nop 1
    v_add_f32_dpp v105, v105, v105 quad_perm:[1,0,3,2] row_mask:0xf bank_mask:0xf
    s_add_u32 m0, s61, 139264
    s_add_u32 s62, s101, 524288
    s_and_b32 s62, s62, 0x3fffff
    buffer_load_dwordx4 v11, s[28:31], s62 offen lds
    v_mfma_f32_32x32x16_bf16 v[208:223], v[48:51], v[36:39], 0
    v_add_f32_dpp v105, v105, v105 quad_perm:[2,3,0,1] row_mask:0xf bank_mask:0xf
    s_nop 1
    v_add_f32_dpp v105, v105, v105 row_half_mirror row_mask:0xf bank_mask:0xf
    s_nop 1
    v_add_f32_dpp v105, v105, v105 row_mirror row_mask:0xf bank_mask:0xf
    s_nop 0
    v_readlane_b32 s68, v105, 0
    v_readlane_b32 s69, v105, 16
    v_readlane_b32 s70, v105, 32
    v_readlane_b32 s71, v105, 48
    v_mov_b32 v105, s68
    v_add_f32 v105, s69, v105
    s_add_u32 m0, s61, 147456
    s_add_u32 s62, s101, 786432
    s_and_b32 s62, s62, 0x3fffff
    buffer_load_dwordx4 v11, s[24:27], s62 offen lds
    v_add_f32 v105, s70, v105
    v_add_f32 v105, s71, v105
    v_mov_b32 v106, 0x3727c5ac
    v_fmac_f32 v106, 0x3b000000, v105
    v_rsq_f32 v106, v106
    v_lshlrev_b32 v104, 7, v1
    s_lshl_b32 s48, s44, 4
    v_add_u32 v104, s48, v104
    v_mul_f32 v96, v96, v106
    s_waitcnt lgkmcnt(10)
    v_mfma_f32_32x32x16_bf16 v[224:239], v[52:55], v[32:35], 0
    s_add_u32 m0, s61, 155648
    s_add_u32 s62, s101, 786432
    s_and_b32 s62, s62, 0x3fffff
    buffer_load_dwordx4 v11, s[28:31], s62 offen lds
    v_mul_f32 v97, v97, v106
    v_mul_f32 v98, v98, v106
    v_mul_f32 v99, v99, v106
    v_mul_f32 v100, v100, v106
    v_mul_f32 v101, v101, v106
    v_mul_f32 v102, v102, v106
    v_mul_f32 v103, v103, v106
    v_cvt_pk_bf16_f32 v88, v96, v97
    v_cvt_pk_bf16_f32 v89, v98, v99
    v_mfma_f32_32x32x16_bf16 v[240:255], v[52:55], v[36:39], 0
    buffer_load_dword v127, v7, s[72:75], s64 offen
    v_cvt_pk_bf16_f32 v90, v100, v101
    v_cvt_pk_bf16_f32 v91, v102, v103
    ds_write_b128 v104, v[88:91]
    v_mov_b32 v124, 0
    buffer_store_dword v124, v28, s[32:35], s16 offen sc1
    s_waitcnt lgkmcnt(0)
    v_mfma_f32_32x32x16_bf16 v[128:143], v[64:67], v[56:59], v[128:143]
    v_mfma_f32_32x32x16_bf16 v[144:159], v[64:67], v[60:63], v[144:159]
    s_waitcnt vmcnt(10)
    s_barrier
    ds_read_b128 v[32:35], v16 offset:32768
    v_add_u32 v104, s61, v4
    ds_read_b128 v[88:91], v104
    v_lshlrev_b32 v105, 9, v82
    v_and_b32 v106, 7, v1
    v_lshlrev_b32 v106, 4, v106
    v_add_u32 v105, v105, v106
    v_mfma_f32_32x32x16_bf16 v[160:175], v[68:71], v[56:59], v[160:175]
    ds_read_b64_tr_b16 v[40:41], v20 offset:16384
    ds_read_b64_tr_b16 v[42:43], v20 offset:17408
    v_mfma_f32_32x32x16_bf16 v[176:191], v[68:71], v[60:63], v[176:191]
    ds_read_b128 v[36:39], v16 offset:36864
    ds_read_b64_tr_b16 v[44:45], v21 offset:16384
    v_mfma_f32_32x32x16_bf16 v[192:207], v[72:75], v[56:59], v[192:207]
    ds_read_b64_tr_b16 v[46:47], v21 offset:17408
    s_add_u32 m0, s61, 98304
    s_add_u32 s62, s101, 1048576
    s_and_b32 s62, s62, 0x3fffff
    buffer_load_dwordx4 v11, s[24:27], s62 offen lds
    v_mfma_f32_32x32x16_bf16 v[208:223], v[72:75], v[60:63], v[208:223]
    ds_read_b64_tr_b16 v[48:49], v22 offset:16384
    ds_read_b64_tr_b16 v[50:51], v22 offset:17408
    v_mfma_f32_32x32x16_bf16 v[224:239], v[76:79], v[56:59], v[224:239]
    s_add_u32 m0, s61, 106496
    s_add_u32 s62, s101, 1048576
    s_and_b32 s62, s62, 0x3fffff
    buffer_load_dwordx4 v11, s[28:31], s62 offen lds
    ds_read_b64_tr_b16 v[52:53], v23 offset:16384
    v_mfma_f32_32x32x16_bf16 v[240:255], v[76:79], v[60:63], v[240:255]
    ds_read_b64_tr_b16 v[54:55], v23 offset:17408
    s_waitcnt lgkmcnt(7)
    v_mfma_f32_32x32x16_bf16 v[128:143], v[40:43], v[32:35], v[128:143]
    ds_read_b128 v[56:59], v17 offset:32768
    ds_read_b64_tr_b16 v[64:65], v20 offset:20480
    s_waitcnt lgkmcnt(8)
    v_mfma_f32_32x32x16_bf16 v[144:159], v[40:43], v[36:39], v[144:159]
    ds_read_b64_tr_b16 v[66:67], v20 offset:21504
    ds_read_b128 v[60:63], v17 offset:36864
    s_waitcnt lgkmcnt(8)
    v_mfma_f32_32x32x16_bf16 v[160:175], v[44:47], v[32:35], v[160:175]
    ds_read_b64_tr_b16 v[68:69], v21 offset:20480
    ds_read_b64_tr_b16 v[70:71], v21 offset:21504
    v_mfma_f32_32x32x16_bf16 v[176:191], v[44:47], v[36:39], v[176:191]
    ds_read_b64_tr_b16 v[72:73], v22 offset:20480
    ds_read_b64_tr_b16 v[74:75], v22 offset:21504
    s_waitcnt lgkmcnt(10)
    v_mfma_f32_32x32x16_bf16 v[192:207], v[48:51], v[32:35], v[192:207]
    ds_read_b64_tr_b16 v[76:77], v23 offset:20480
    ds_read_b64_tr_b16 v[78:79], v23 offset:21504
    v_mfma_f32_32x32x16_bf16 v[208:223], v[48:51], v[36:39], v[208:223]
    s_waitcnt lgkmcnt(10)
    v_mfma_f32_32x32x16_bf16 v[224:239], v[52:55], v[32:35], v[224:239]
    v_mfma_f32_32x32x16_bf16 v[240:255], v[52:55], v[36:39], v[240:255]
    buffer_store_dwordx4 v[88:91], v105, s[32:35], s66 offen sc1
    s_waitcnt lgkmcnt(0)
    v_mfma_f32_32x32x16_bf16 v[128:143], v[64:67], v[56:59], v[128:143]
    v_mfma_f32_32x32x16_bf16 v[144:159], v[64:67], v[60:63], v[144:159]
    s_waitcnt vmcnt(7)
    s_barrier
    ds_read_b128 v[32:35], v24 offset:0
    buffer_load_dword v125, v7, s[72:75], s65 offen
    ds_read_b64_tr_b16 v[40:41], v20 offset:32768
    v_mfma_f32_32x32x16_bf16 v[160:175], v[68:71], v[56:59], v[160:175]
    ds_read_b64_tr_b16 v[42:43], v20 offset:33792
    ds_read_b128 v[36:39], v24 offset:4096
    ds_read_b64_tr_b16 v[44:45], v21 offset:32768
    v_mfma_f32_32x32x16_bf16 v[176:191], v[68:71], v[60:63], v[176:191]
    ds_read_b64_tr_b16 v[46:47], v21 offset:33792
    s_add_u32 m0, s60, 0
    s_add_u32 s62, s100, 256
    s_and_b32 s62, s62, 1023
    buffer_load_dwordx4 v10, s[20:23], s62 offen lds
    s_add_u32 m0, s60, 1024
    s_add_u32 s62, s100, 256
    s_and_b32 s62, s62, 1023
    buffer_load_dwordx4 v13, s[20:23], s62 offen lds
    v_mfma_f32_32x32x16_bf16 v[192:207], v[72:75], v[56:59], v[192:207]
    ds_read_b64_tr_b16 v[48:49], v22 offset:32768
    s_add_u32 m0, s60, 2048
    s_add_u32 s62, s100, 256
    s_and_b32 s62, s62, 1023
    s_add_u32 s62, s62, 16384
    buffer_load_dwordx4 v10, s[20:23], s62 offen lds
    v_mfma_f32_32x32x16_bf16 v[208:223], v[72:75], v[60:63], v[208:223]
    s_add_u32 m0, s60, 3072
    s_add_u32 s62, s100, 256
    s_and_b32 s62, s62, 1023
    s_add_u32 s62, s62, 16384
    buffer_load_dwordx4 v13, s[20:23], s62 offen lds
    ds_read_b64_tr_b16 v[50:51], v22 offset:33792
    s_add_u32 m0, s61, 114688
    s_add_u32 s62, s101, 1310720
    s_and_b32 s62, s62, 0x3fffff
    buffer_load_dwordx4 v11, s[24:27], s62 offen lds
    v_mfma_f32_32x32x16_bf16 v[224:239], v[76:79], v[56:59], v[224:239]
    ds_read_b64_tr_b16 v[52:53], v23 offset:32768
    s_add_u32 m0, s61, 122880
    s_add_u32 s62, s101, 1310720
    s_and_b32 s62, s62, 0x3fffff
    buffer_load_dwordx4 v11, s[28:31], s62 offen lds
    s_add_u32 m0, s60, 32768
    s_add_u32 s62, s100, 384
    s_and_b32 s62, s62, 1023
    buffer_load_dwordx4 v10, s[20:23], s62 offen lds
    v_mfma_f32_32x32x16_bf16 v[240:255], v[76:79], v[60:63], v[240:255]
    ds_read_b64_tr_b16 v[54:55], v23 offset:33792
    s_add_u32 m0, s60, 33792
    s_add_u32 s62, s100, 384
    s_and_b32 s62, s62, 1023
    buffer_load_dwordx4 v13, s[20:23], s62 offen lds
    s_waitcnt lgkmcnt(7)
    v_mfma_f32_32x32x16_bf16 v[128:143], v[40:43], v[32:35], v[128:143]
    ds_read_b128 v[56:59], v25 offset:0
    ds_read_b64_tr_b16 v[64:65], v20 offset:36864
    s_waitcnt lgkmcnt(8)
    v_mfma_f32_32x32x16_bf16 v[144:159], v[40:43], v[36:39], v[144:159]
    ds_read_b64_tr_b16 v[66:67], v20 offset:37888
    ds_read_b128 v[60:63], v25 offset:4096
    s_waitcnt lgkmcnt(8)
    v_mfma_f32_32x32x16_bf16 v[160:175], v[44:47], v[32:35], v[160:175]
    ds_read_b64_tr_b16 v[68:69], v21 offset:36864
    ds_read_b64_tr_b16 v[70:71], v21 offset:37888
    v_mfma_f32_32x32x16_bf16 v[176:191], v[44:47], v[36:39], v[176:191]
    ds_read_b64_tr_b16 v[72:73], v22 offset:36864
    ds_read_b64_tr_b16 v[74:75], v22 offset:37888
    s_waitcnt lgkmcnt(10)
    v_mfma_f32_32x32x16_bf16 v[192:207], v[48:51], v[32:35], v[192:207]
    ds_read_b64_tr_b16 v[76:77], v23 offset:36864
    ds_read_b64_tr_b16 v[78:79], v23 offset:37888
    v_mfma_f32_32x32x16_bf16 v[208:223], v[48:51], v[36:39], v[208:223]
    s_waitcnt lgkmcnt(10)
    v_mfma_f32_32x32x16_bf16 v[224:239], v[52:55], v[32:35], v[224:239]
    v_mfma_f32_32x32x16_bf16 v[240:255], v[52:55], v[36:39], v[240:255]
    s_waitcnt lgkmcnt(0)
    v_mfma_f32_32x32x16_bf16 v[128:143], v[64:67], v[56:59], v[128:143]
    v_mfma_f32_32x32x16_bf16 v[144:159], v[64:67], v[60:63], v[144:159]
    s_waitcnt vmcnt(14)
    s_barrier
    ds_read_b128 v[32:35], v26 offset:0
    ds_read_b64_tr_b16 v[40:41], v20 offset:49152
    v_mfma_f32_32x32x16_bf16 v[160:175], v[68:71], v[56:59], v[160:175]
    ds_read_b64_tr_b16 v[42:43], v20 offset:50176
    ds_read_b128 v[36:39], v26 offset:4096
    v_mfma_f32_32x32x16_bf16 v[176:191], v[68:71], v[60:63], v[176:191]
    ds_read_b64_tr_b16 v[44:45], v21 offset:49152
    ds_read_b64_tr_b16 v[46:47], v21 offset:50176
    v_mfma_f32_32x32x16_bf16 v[192:207], v[72:75], v[56:59], v[192:207]
    s_add_u32 m0, s61, 131072
    s_add_u32 s62, s101, 1572864
    s_and_b32 s62, s62, 0x3fffff
    buffer_load_dwordx4 v11, s[24:27], s62 offen lds
    ds_read_b64_tr_b16 v[48:49], v22 offset:49152
    v_mfma_f32_32x32x16_bf16 v[208:223], v[72:75], v[60:63], v[208:223]
    s_add_u32 m0, s61, 139264
    s_add_u32 s62, s101, 1572864
    s_and_b32 s62, s62, 0x3fffff
    buffer_load_dwordx4 v11, s[28:31], s62 offen lds
    ds_read_b64_tr_b16 v[50:51], v22 offset:50176
    v_mfma_f32_32x32x16_bf16 v[224:239], v[76:79], v[56:59], v[224:239]
    s_add_u32 m0, s60, 34816
    s_add_u32 s62, s100, 384
    s_and_b32 s62, s62, 1023
    s_add_u32 s62, s62, 16384
    buffer_load_dwordx4 v10, s[20:23], s62 offen lds
    ds_read_b64_tr_b16 v[52:53], v23 offset:49152
    v_mfma_f32_32x32x16_bf16 v[240:255], v[76:79], v[60:63], v[240:255]
    s_add_u32 m0, s60, 35840
    s_add_u32 s62, s100, 384
    s_and_b32 s62, s62, 1023
    s_add_u32 s62, s62, 16384
    buffer_load_dwordx4 v13, s[20:23], s62 offen lds
    ds_read_b64_tr_b16 v[54:55], v23 offset:50176
    s_waitcnt lgkmcnt(7)
    v_mfma_f32_32x32x16_bf16 v[128:143], v[40:43], v[32:35], v[128:143]
    ds_read_b128 v[56:59], v27 offset:0
    ds_read_b64_tr_b16 v[64:65], v20 offset:53248
    s_waitcnt lgkmcnt(8)
    v_mfma_f32_32x32x16_bf16 v[144:159], v[40:43], v[36:39], v[144:159]
    ds_read_b64_tr_b16 v[66:67], v20 offset:54272
    ds_read_b128 v[60:63], v27 offset:4096
    s_waitcnt lgkmcnt(8)
    v_mfma_f32_32x32x16_bf16 v[160:175], v[44:47], v[32:35], v[160:175]
    ds_read_b64_tr_b16 v[68:69], v21 offset:53248
    ds_read_b64_tr_b16 v[70:71], v21 offset:54272
    v_mfma_f32_32x32x16_bf16 v[176:191], v[44:47], v[36:39], v[176:191]
    ds_read_b64_tr_b16 v[72:73], v22 offset:53248
    ds_read_b64_tr_b16 v[74:75], v22 offset:54272
    s_waitcnt lgkmcnt(10)
    v_mfma_f32_32x32x16_bf16 v[192:207], v[48:51], v[32:35], v[192:207]
    ds_read_b64_tr_b16 v[76:77], v23 offset:53248
    ds_read_b64_tr_b16 v[78:79], v23 offset:54272
    v_mfma_f32_32x32x16_bf16 v[208:223], v[48:51], v[36:39], v[208:223]
    s_waitcnt lgkmcnt(10)
    v_mfma_f32_32x32x16_bf16 v[224:239], v[52:55], v[32:35], v[224:239]
    v_mfma_f32_32x32x16_bf16 v[240:255], v[52:55], v[36:39], v[240:255]
    s_waitcnt lgkmcnt(0)
    v_mfma_f32_32x32x16_bf16 v[128:143], v[64:67], v[56:59], v[128:143]
    v_mfma_f32_32x32x16_bf16 v[144:159], v[64:67], v[60:63], v[144:159]
    s_waitcnt vmcnt(14)
    s_waitcnt vmcnt(8)
    s_barrier
    ds_read_b128 v[32:35], v14 offset:0
    v_mov_b32 v124, 1
    buffer_store_byte v124, v8, s[8:11], 0 offen sc1
    ds_read_b64_tr_b16 v[40:41], v20 offset:0
    v_mfma_f32_32x32x16_bf16 v[160:175], v[68:71], v[56:59], v[160:175]
    ds_read_b64_tr_b16 v[42:43], v20 offset:1024
    ds_read_b128 v[36:39], v14 offset:4096
    v_mfma_f32_32x32x16_bf16 v[176:191], v[68:71], v[60:63], v[176:191]
    ds_read_b64_tr_b16 v[44:45], v21 offset:0
    ds_read_b64_tr_b16 v[46:47], v21 offset:1024
    v_mfma_f32_32x32x16_bf16 v[192:207], v[72:75], v[56:59], v[192:207]
    s_add_u32 m0, s61, 147456
    s_add_u32 s62, s101, 1835008
    s_and_b32 s62, s62, 0x3fffff
    buffer_load_dwordx4 v11, s[24:27], s62 offen lds
    ds_read_b64_tr_b16 v[48:49], v22 offset:0
    v_mfma_f32_32x32x16_bf16 v[208:223], v[72:75], v[60:63], v[208:223]
    s_add_u32 m0, s61, 155648
    s_add_u32 s62, s101, 1835008
    s_and_b32 s62, s62, 0x3fffff
    buffer_load_dwordx4 v11, s[28:31], s62 offen lds
    ds_read_b64_tr_b16 v[50:51], v22 offset:1024
    v_mfma_f32_32x32x16_bf16 v[224:239], v[76:79], v[56:59], v[224:239]
    s_add_u32 m0, s60, 65536
    s_add_u32 s62, s100, 512
    s_and_b32 s62, s62, 1023
    buffer_load_dwordx4 v10, s[20:23], s62 offen lds
    ds_read_b64_tr_b16 v[52:53], v23 offset:0
    v_mfma_f32_32x32x16_bf16 v[240:255], v[76:79], v[60:63], v[240:255]
    s_add_u32 m0, s60, 66560
    s_add_u32 s62, s100, 512
    s_and_b32 s62, s62, 1023
    buffer_load_dwordx4 v13, s[20:23], s62 offen lds
    ds_read_b64_tr_b16 v[54:55], v23 offset:1024
    s_waitcnt lgkmcnt(7)
    v_mfma_f32_32x32x16_bf16 v[128:143], v[40:43], v[32:35], v[128:143]
    ds_read_b128 v[56:59], v15 offset:0
    ds_read_b64_tr_b16 v[64:65], v20 offset:4096
    s_waitcnt lgkmcnt(8)
    v_mfma_f32_32x32x16_bf16 v[144:159], v[40:43], v[36:39], v[144:159]
    ds_read_b64_tr_b16 v[66:67], v20 offset:5120
    ds_read_b128 v[60:63], v15 offset:4096
    s_waitcnt lgkmcnt(8)
    v_mfma_f32_32x32x16_bf16 v[160:175], v[44:47], v[32:35], v[160:175]
    ds_read_b64_tr_b16 v[68:69], v21 offset:4096
    ds_read_b64_tr_b16 v[70:71], v21 offset:5120
    v_mfma_f32_32x32x16_bf16 v[176:191], v[44:47], v[36:39], v[176:191]
    ds_read_b64_tr_b16 v[72:73], v22 offset:4096
    ds_read_b64_tr_b16 v[74:75], v22 offset:5120
    s_waitcnt lgkmcnt(10)
    v_mfma_f32_32x32x16_bf16 v[192:207], v[48:51], v[32:35], v[192:207]
    ds_read_b64_tr_b16 v[76:77], v23 offset:4096
    ds_read_b64_tr_b16 v[78:79], v23 offset:5120
    v_mfma_f32_32x32x16_bf16 v[208:223], v[48:51], v[36:39], v[208:223]
    s_waitcnt lgkmcnt(10)
    v_mfma_f32_32x32x16_bf16 v[224:239], v[52:55], v[32:35], v[224:239]
    v_mfma_f32_32x32x16_bf16 v[240:255], v[52:55], v[36:39], v[240:255]
    s_waitcnt lgkmcnt(0)
    v_mfma_f32_32x32x16_bf16 v[128:143], v[64:67], v[56:59], v[128:143]
    v_mfma_f32_32x32x16_bf16 v[144:159], v[64:67], v[60:63], v[144:159]
    s_waitcnt vmcnt(11)
    s_barrier
    ds_read_b128 v[32:35], v16 offset:0
    ds_read_b64_tr_b16 v[40:41], v20 offset:16384
    v_mfma_f32_32x32x16_bf16 v[160:175], v[68:71], v[56:59], v[160:175]
    ds_read_b64_tr_b16 v[42:43], v20 offset:17408
    ds_read_b128 v[36:39], v16 offset:4096
    v_mfma_f32_32x32x16_bf16 v[176:191], v[68:71], v[60:63], v[176:191]
    ds_read_b64_tr_b16 v[44:45], v21 offset:16384
    ds_read_b64_tr_b16 v[46:47], v21 offset:17408
    v_mfma_f32_32x32x16_bf16 v[192:207], v[72:75], v[56:59], v[192:207]
    s_add_u32 m0, s61, 98304
    s_add_u32 s62, s101, 2097152
    s_and_b32 s62, s62, 0x3fffff
    buffer_load_dwordx4 v11, s[24:27], s62 offen lds
    ds_read_b64_tr_b16 v[48:49], v22 offset:16384
    v_mfma_f32_32x32x16_bf16 v[208:223], v[72:75], v[60:63], v[208:223]
    s_add_u32 m0, s61, 106496
    s_add_u32 s62, s101, 2097152
    s_and_b32 s62, s62, 0x3fffff
    buffer_load_dwordx4 v11, s[28:31], s62 offen lds
    ds_read_b64_tr_b16 v[50:51], v22 offset:17408
    v_mfma_f32_32x32x16_bf16 v[224:239], v[76:79], v[56:59], v[224:239]
    s_add_u32 m0, s60, 67584
    s_add_u32 s62, s100, 512
    s_and_b32 s62, s62, 1023
    s_add_u32 s62, s62, 16384
    buffer_load_dwordx4 v10, s[20:23], s62 offen lds
    ds_read_b64_tr_b16 v[52:53], v23 offset:16384
    v_mfma_f32_32x32x16_bf16 v[240:255], v[76:79], v[60:63], v[240:255]
    s_add_u32 m0, s60, 68608
    s_add_u32 s62, s100, 512
    s_and_b32 s62, s62, 1023
    s_add_u32 s62, s62, 16384
    buffer_load_dwordx4 v13, s[20:23], s62 offen lds
    ds_read_b64_tr_b16 v[54:55], v23 offset:17408
    s_waitcnt lgkmcnt(7)
    v_mfma_f32_32x32x16_bf16 v[128:143], v[40:43], v[32:35], v[128:143]
    ds_read_b128 v[56:59], v17 offset:0
    ds_read_b64_tr_b16 v[64:65], v20 offset:20480
    s_waitcnt lgkmcnt(8)
    v_mfma_f32_32x32x16_bf16 v[144:159], v[40:43], v[36:39], v[144:159]
    ds_read_b64_tr_b16 v[66:67], v20 offset:21504
    ds_read_b128 v[60:63], v17 offset:4096
    s_waitcnt lgkmcnt(8)
    v_mfma_f32_32x32x16_bf16 v[160:175], v[44:47], v[32:35], v[160:175]
    ds_read_b64_tr_b16 v[68:69], v21 offset:20480
    ds_read_b64_tr_b16 v[70:71], v21 offset:21504
    v_mfma_f32_32x32x16_bf16 v[176:191], v[44:47], v[36:39], v[176:191]
    ds_read_b64_tr_b16 v[72:73], v22 offset:20480
    ds_read_b64_tr_b16 v[74:75], v22 offset:21504
    s_waitcnt lgkmcnt(10)
    v_mfma_f32_32x32x16_bf16 v[192:207], v[48:51], v[32:35], v[192:207]
    ds_read_b64_tr_b16 v[76:77], v23 offset:20480
    ds_read_b64_tr_b16 v[78:79], v23 offset:21504
    v_mfma_f32_32x32x16_bf16 v[208:223], v[48:51], v[36:39], v[208:223]
    s_waitcnt lgkmcnt(10)
    v_mfma_f32_32x32x16_bf16 v[224:239], v[52:55], v[32:35], v[224:239]
    v_mfma_f32_32x32x16_bf16 v[240:255], v[52:55], v[36:39], v[240:255]
    s_waitcnt lgkmcnt(0)
    v_mfma_f32_32x32x16_bf16 v[128:143], v[64:67], v[56:59], v[128:143]
    v_mfma_f32_32x32x16_bf16 v[144:159], v[64:67], v[60:63], v[144:159]
    s_waitcnt vmcnt(11)
    s_waitcnt vmcnt(9)
    s_barrier
    ds_read_b128 v[32:35], v14 offset:32768
    ds_read_b64_tr_b16 v[40:41], v20 offset:32768
    v_mfma_f32_32x32x16_bf16 v[160:175], v[68:71], v[56:59], v[160:175]
    ds_read_b64_tr_b16 v[42:43], v20 offset:33792
    ds_read_b128 v[36:39], v14 offset:36864
    v_mfma_f32_32x32x16_bf16 v[176:191], v[68:71], v[60:63], v[176:191]
    ds_read_b64_tr_b16 v[44:45], v21 offset:32768
    ds_read_b64_tr_b16 v[46:47], v21 offset:33792
    v_mfma_f32_32x32x16_bf16 v[192:207], v[72:75], v[56:59], v[192:207]
    s_add_u32 m0, s61, 114688
    s_add_u32 s62, s101, 2359296
    s_and_b32 s62, s62, 0x3fffff
    buffer_load_dwordx4 v11, s[24:27], s62 offen lds
    ds_read_b64_tr_b16 v[48:49], v22 offset:32768
    v_mfma_f32_32x32x16_bf16 v[208:223], v[72:75], v[60:63], v[208:223]
    s_add_u32 m0, s61, 122880
    s_add_u32 s62, s101, 2359296
    s_and_b32 s62, s62, 0x3fffff
    buffer_load_dwordx4 v11, s[28:31], s62 offen lds
    ds_read_b64_tr_b16 v[50:51], v22 offset:33792
    v_mfma_f32_32x32x16_bf16 v[224:239], v[76:79], v[56:59], v[224:239]
    s_add_u32 m0, s60, 0
    s_add_u32 s62, s100, 640
    s_and_b32 s62, s62, 1023
    buffer_load_dwordx4 v10, s[20:23], s62 offen lds
    ds_read_b64_tr_b16 v[52:53], v23 offset:32768
    v_mfma_f32_32x32x16_bf16 v[240:255], v[76:79], v[60:63], v[240:255]
    s_add_u32 m0, s60, 1024
    s_add_u32 s62, s100, 640
    s_and_b32 s62, s62, 1023
    buffer_load_dwordx4 v13, s[20:23], s62 offen lds
    ds_read_b64_tr_b16 v[54:55], v23 offset:33792
    s_waitcnt lgkmcnt(7)
    v_mfma_f32_32x32x16_bf16 v[128:143], v[40:43], v[32:35], v[128:143]
    ds_read_b128 v[56:59], v15 offset:32768
    ds_read_b64_tr_b16 v[64:65], v20 offset:36864
    s_waitcnt lgkmcnt(8)
    v_mfma_f32_32x32x16_bf16 v[144:159], v[40:43], v[36:39], v[144:159]
    ds_read_b64_tr_b16 v[66:67], v20 offset:37888
    ds_read_b128 v[60:63], v15 offset:36864
    s_waitcnt lgkmcnt(8)
    v_mfma_f32_32x32x16_bf16 v[160:175], v[44:47], v[32:35], v[160:175]
    ds_read_b64_tr_b16 v[68:69], v21 offset:36864
    ds_read_b64_tr_b16 v[70:71], v21 offset:37888
    v_mfma_f32_32x32x16_bf16 v[176:191], v[44:47], v[36:39], v[176:191]
    ds_read_b64_tr_b16 v[72:73], v22 offset:36864
    ds_read_b64_tr_b16 v[74:75], v22 offset:37888
    s_waitcnt lgkmcnt(10)
    v_mfma_f32_32x32x16_bf16 v[192:207], v[48:51], v[32:35], v[192:207]
    ds_read_b64_tr_b16 v[76:77], v23 offset:36864
    ds_read_b64_tr_b16 v[78:79], v23 offset:37888
    v_mfma_f32_32x32x16_bf16 v[208:223], v[48:51], v[36:39], v[208:223]
    s_waitcnt lgkmcnt(10)
    v_mfma_f32_32x32x16_bf16 v[224:239], v[52:55], v[32:35], v[224:239]
    v_mfma_f32_32x32x16_bf16 v[240:255], v[52:55], v[36:39], v[240:255]
    s_waitcnt lgkmcnt(0)
    v_mfma_f32_32x32x16_bf16 v[128:143], v[64:67], v[56:59], v[128:143]
    v_mfma_f32_32x32x16_bf16 v[144:159], v[64:67], v[60:63], v[144:159]
    s_waitcnt vmcnt(10)
    s_barrier
    ds_read_b128 v[32:35], v16 offset:32768
    ds_read_b64_tr_b16 v[40:41], v20 offset:49152
    v_mfma_f32_32x32x16_bf16 v[160:175], v[68:71], v[56:59], v[160:175]
    ds_read_b64_tr_b16 v[42:43], v20 offset:50176
    ds_read_b128 v[36:39], v16 offset:36864
    v_mfma_f32_32x32x16_bf16 v[176:191], v[68:71], v[60:63], v[176:191]
    ds_read_b64_tr_b16 v[44:45], v21 offset:49152
    ds_read_b64_tr_b16 v[46:47], v21 offset:50176
    v_mfma_f32_32x32x16_bf16 v[192:207], v[72:75], v[56:59], v[192:207]
    s_add_u32 m0, s61, 131072
    s_add_u32 s62, s101, 2621440
    s_and_b32 s62, s62, 0x3fffff
    buffer_load_dwordx4 v11, s[24:27], s62 offen lds
    ds_read_b64_tr_b16 v[48:49], v22 offset:49152
    v_mfma_f32_32x32x16_bf16 v[208:223], v[72:75], v[60:63], v[208:223]
    s_add_u32 m0, s61, 139264
    s_add_u32 s62, s101, 2621440
    s_and_b32 s62, s62, 0x3fffff
    buffer_load_dwordx4 v11, s[28:31], s62 offen lds
    ds_read_b64_tr_b16 v[50:51], v22 offset:50176
    v_mfma_f32_32x32x16_bf16 v[224:239], v[76:79], v[56:59], v[224:239]
    s_add_u32 m0, s60, 2048
    s_add_u32 s62, s100, 640
    s_and_b32 s62, s62, 1023
    s_add_u32 s62, s62, 16384
    buffer_load_dwordx4 v10, s[20:23], s62 offen lds
    ds_read_b64_tr_b16 v[52:53], v23 offset:49152
    v_mfma_f32_32x32x16_bf16 v[240:255], v[76:79], v[60:63], v[240:255]
    s_add_u32 m0, s60, 3072
    s_add_u32 s62, s100, 640
    s_and_b32 s62, s62, 1023
    s_add_u32 s62, s62, 16384
    buffer_load_dwordx4 v13, s[20:23], s62 offen lds
    ds_read_b64_tr_b16 v[54:55], v23 offset:50176
    s_waitcnt lgkmcnt(7)
    v_mfma_f32_32x32x16_bf16 v[128:143], v[40:43], v[32:35], v[128:143]
    ds_read_b128 v[56:59], v17 offset:32768
    ds_read_b64_tr_b16 v[64:65], v20 offset:53248
    s_waitcnt lgkmcnt(8)
    v_mfma_f32_32x32x16_bf16 v[144:159], v[40:43], v[36:39], v[144:159]
    ds_read_b64_tr_b16 v[66:67], v20 offset:54272
    ds_read_b128 v[60:63], v17 offset:36864
    s_waitcnt lgkmcnt(8)
    v_mfma_f32_32x32x16_bf16 v[160:175], v[44:47], v[32:35], v[160:175]
    ds_read_b64_tr_b16 v[68:69], v21 offset:53248
    ds_read_b64_tr_b16 v[70:71], v21 offset:54272
    v_mfma_f32_32x32x16_bf16 v[176:191], v[44:47], v[36:39], v[176:191]
    ds_read_b64_tr_b16 v[72:73], v22 offset:53248
    ds_read_b64_tr_b16 v[74:75], v22 offset:54272
    s_waitcnt lgkmcnt(10)
    v_mfma_f32_32x32x16_bf16 v[192:207], v[48:51], v[32:35], v[192:207]
    ds_read_b64_tr_b16 v[76:77], v23 offset:53248
    ds_read_b64_tr_b16 v[78:79], v23 offset:54272
    v_mfma_f32_32x32x16_bf16 v[208:223], v[48:51], v[36:39], v[208:223]
    s_waitcnt lgkmcnt(10)
    v_mfma_f32_32x32x16_bf16 v[224:239], v[52:55], v[32:35], v[224:239]
    v_mfma_f32_32x32x16_bf16 v[240:255], v[52:55], v[36:39], v[240:255]
    s_waitcnt lgkmcnt(0)
    v_mfma_f32_32x32x16_bf16 v[128:143], v[64:67], v[56:59], v[128:143]
    v_mfma_f32_32x32x16_bf16 v[144:159], v[64:67], v[60:63], v[144:159]
    s_waitcnt vmcnt(10)
    s_waitcnt vmcnt(8)
    s_barrier
    ds_read_b128 v[32:35], v24 offset:0
    ds_read_b64_tr_b16 v[40:41], v20 offset:0
    v_mfma_f32_32x32x16_bf16 v[160:175], v[68:71], v[56:59], v[160:175]
    ds_read_b64_tr_b16 v[42:43], v20 offset:1024
    ds_read_b128 v[36:39], v24 offset:4096
    v_mfma_f32_32x32x16_bf16 v[176:191], v[68:71], v[60:63], v[176:191]
    ds_read_b64_tr_b16 v[44:45], v21 offset:0
    ds_read_b64_tr_b16 v[46:47], v21 offset:1024
    v_mfma_f32_32x32x16_bf16 v[192:207], v[72:75], v[56:59], v[192:207]
    s_add_u32 m0, s61, 147456
    s_add_u32 s62, s101, 2883584
    s_and_b32 s62, s62, 0x3fffff
    buffer_load_dwordx4 v11, s[24:27], s62 offen lds
    ds_read_b64_tr_b16 v[48:49], v22 offset:0
    v_mfma_f32_32x32x16_bf16 v[208:223], v[72:75], v[60:63], v[208:223]
    s_add_u32 m0, s61, 155648
    s_add_u32 s62, s101, 2883584
    s_and_b32 s62, s62, 0x3fffff
    buffer_load_dwordx4 v11, s[28:31], s62 offen lds
    ds_read_b64_tr_b16 v[50:51], v22 offset:1024
    v_mfma_f32_32x32x16_bf16 v[224:239], v[76:79], v[56:59], v[224:239]
    s_add_u32 m0, s60, 32768
    s_add_u32 s62, s100, 768
    s_and_b32 s62, s62, 1023
    buffer_load_dwordx4 v10, s[20:23], s62 offen lds
    ds_read_b64_tr_b16 v[52:53], v23 offset:0
    v_mfma_f32_32x32x16_bf16 v[240:255], v[76:79], v[60:63], v[240:255]
    s_add_u32 m0, s60, 33792
    s_add_u32 s62, s100, 768
    s_and_b32 s62, s62, 1023
    buffer_load_dwordx4 v13, s[20:23], s62 offen lds
    ds_read_b64_tr_b16 v[54:55], v23 offset:1024
    s_waitcnt lgkmcnt(7)
    v_mfma_f32_32x32x16_bf16 v[128:143], v[40:43], v[32:35], v[128:143]
    ds_read_b128 v[56:59], v25 offset:0
    ds_read_b64_tr_b16 v[64:65], v20 offset:4096
    s_waitcnt lgkmcnt(8)
    v_mfma_f32_32x32x16_bf16 v[144:159], v[40:43], v[36:39], v[144:159]
    ds_read_b64_tr_b16 v[66:67], v20 offset:5120
    ds_read_b128 v[60:63], v25 offset:4096
    s_mul_i32 s76, s46, 7
    s_add_u32 s76, s76, s44
    s_lshl_b32 s76, s76, 11
    s_mul_i32 s77, s45, 229376
    s_add_u32 s76, s76, s77
    s_add_u32 s76, s76, 65011712
    s_cmp_eq_u32 s44, 7
    s_cselect_b32 s76, 1073741824, s76
    s_add_u32 s77, s76, 114688
    s_waitcnt lgkmcnt(8)
    v_mfma_f32_32x32x16_bf16 v[160:175], v[44:47], v[32:35], v[160:175]
    ds_read_b64_tr_b16 v[68:69], v21 offset:4096
    ds_read_b64_tr_b16 v[70:71], v21 offset:5120
    v_mov_b32 v108, -1
    v_mov_b32 v109, -1
    v_mov_b32 v110, -1
    v_mov_b32 v111, -1
    v_mfma_f32_32x32x16_bf16 v[176:191], v[44:47], v[36:39], v[176:191]
    ds_read_b64_tr_b16 v[72:73], v22 offset:4096
    ds_read_b64_tr_b16 v[74:75], v22 offset:5120
    buffer_store_dwordx4 v[108:111], v4, s[32:35], s76 offen offset:0 sc1
    s_waitcnt lgkmcnt(10)
    v_mfma_f32_32x32x16_bf16 v[192:207], v[48:51], v[32:35], v[192:207]
    ds_read_b64_tr_b16 v[76:77], v23 offset:4096
    ds_read_b64_tr_b16 v[78:79], v23 offset:5120
    buffer_store_dwordx4 v[108:111], v4, s[32:35], s76 offen offset:1024 sc1
    v_mfma_f32_32x32x16_bf16 v[208:223], v[48:51], v[36:39], v[208:223]
    buffer_store_dwordx4 v[108:111], v4, s[32:35], s77 offen offset:0 sc1
    s_waitcnt lgkmcnt(10)
    v_mfma_f32_32x32x16_bf16 v[224:239], v[52:55], v[32:35], v[224:239]
    buffer_store_dwordx4 v[108:111], v4, s[32:35], s77 offen offset:1024 sc1
    v_mfma_f32_32x32x16_bf16 v[240:255], v[52:55], v[36:39], v[240:255]
    buffer_load_dword v124, v18, s[8:11], 0 offen sc1
    s_waitcnt lgkmcnt(0)
    v_mfma_f32_32x32x16_bf16 v[128:143], v[64:67], v[56:59], v[128:143]
    v_mfma_f32_32x32x16_bf16 v[144:159], v[64:67], v[60:63], v[144:159]
    s_waitcnt vmcnt(15)
    s_barrier
    ds_read_b128 v[32:35], v26 offset:0
    ds_read_b64_tr_b16 v[40:41], v20 offset:16384
    v_mfma_f32_32x32x16_bf16 v[160:175], v[68:71], v[56:59], v[160:175]
    ds_read_b64_tr_b16 v[42:43], v20 offset:17408
    ds_read_b128 v[36:39], v26 offset:4096
    v_mfma_f32_32x32x16_bf16 v[176:191], v[68:71], v[60:63], v[176:191]
    ds_read_b64_tr_b16 v[44:45], v21 offset:16384
    ds_read_b64_tr_b16 v[46:47], v21 offset:17408
    v_mfma_f32_32x32x16_bf16 v[192:207], v[72:75], v[56:59], v[192:207]
    s_add_u32 m0, s61, 98304
    s_add_u32 s62, s101, 3145728
    s_and_b32 s62, s62, 0x3fffff
    buffer_load_dwordx4 v11, s[24:27], s62 offen lds
    ds_read_b64_tr_b16 v[48:49], v22 offset:16384
    v_mfma_f32_32x32x16_bf16 v[208:223], v[72:75], v[60:63], v[208:223]
    s_add_u32 m0, s61, 106496
    s_add_u32 s62, s101, 3145728
    s_and_b32 s62, s62, 0x3fffff
    buffer_load_dwordx4 v11, s[28:31], s62 offen lds
    ds_read_b64_tr_b16 v[50:51], v22 offset:17408
    v_mfma_f32_32x32x16_bf16 v[224:239], v[76:79], v[56:59], v[224:239]
    s_add_u32 m0, s60, 34816
    s_add_u32 s62, s100, 768
    s_and_b32 s62, s62, 1023
    s_add_u32 s62, s62, 16384
    buffer_load_dwordx4 v10, s[20:23], s62 offen lds
    ds_read_b64_tr_b16 v[52:53], v23 offset:16384
    v_mfma_f32_32x32x16_bf16 v[240:255], v[76:79], v[60:63], v[240:255]
    s_add_u32 m0, s60, 35840
    s_add_u32 s62, s100, 768
    s_and_b32 s62, s62, 1023
    s_add_u32 s62, s62, 16384
    buffer_load_dwordx4 v13, s[20:23], s62 offen lds
    ds_read_b64_tr_b16 v[54:55], v23 offset:17408
    s_waitcnt lgkmcnt(7)
    v_mfma_f32_32x32x16_bf16 v[128:143], v[40:43], v[32:35], v[128:143]
    ds_read_b128 v[56:59], v27 offset:0
    ds_read_b64_tr_b16 v[64:65], v20 offset:20480
    s_waitcnt lgkmcnt(8)
    v_mfma_f32_32x32x16_bf16 v[144:159], v[40:43], v[36:39], v[144:159]
    ds_read_b64_tr_b16 v[66:67], v20 offset:21504
    ds_read_b128 v[60:63], v27 offset:4096
    s_waitcnt lgkmcnt(8)
    v_mfma_f32_32x32x16_bf16 v[160:175], v[44:47], v[32:35], v[160:175]
    ds_read_b64_tr_b16 v[68:69], v21 offset:20480
    ds_read_b64_tr_b16 v[70:71], v21 offset:21504
    v_mfma_f32_32x32x16_bf16 v[176:191], v[44:47], v[36:39], v[176:191]
    ds_read_b64_tr_b16 v[72:73], v22 offset:20480
    ds_read_b64_tr_b16 v[74:75], v22 offset:21504
    s_waitcnt lgkmcnt(10)
    v_mfma_f32_32x32x16_bf16 v[192:207], v[48:51], v[32:35], v[192:207]
    ds_read_b64_tr_b16 v[76:77], v23 offset:20480
    ds_read_b64_tr_b16 v[78:79], v23 offset:21504
    v_mfma_f32_32x32x16_bf16 v[208:223], v[48:51], v[36:39], v[208:223]
    s_waitcnt lgkmcnt(10)
    v_mfma_f32_32x32x16_bf16 v[224:239], v[52:55], v[32:35], v[224:239]
    v_mfma_f32_32x32x16_bf16 v[240:255], v[52:55], v[36:39], v[240:255]
    s_waitcnt lgkmcnt(0)
    v_mfma_f32_32x32x16_bf16 v[128:143], v[64:67], v[56:59], v[128:143]
    v_mfma_f32_32x32x16_bf16 v[144:159], v[64:67], v[60:63], v[144:159]
    s_waitcnt vmcnt(15)
    s_waitcnt vmcnt(13)
    s_waitcnt vmcnt(4)
    v_and_b32 v124, v124, v19
    v_cmp_ne_u32 vcc, v124, v19
    s_cbranch_vccnz spin_10
spb_11:
    s_barrier
    ds_read_b128 v[32:35], v14 offset:0
    ds_read_b64_tr_b16 v[40:41], v20 offset:32768
    v_mfma_f32_32x32x16_bf16 v[160:175], v[68:71], v[56:59], v[160:175]
    ds_read_b64_tr_b16 v[42:43], v20 offset:33792
    ds_read_b128 v[36:39], v14 offset:4096
    v_mfma_f32_32x32x16_bf16 v[176:191], v[68:71], v[60:63], v[176:191]
    ds_read_b64_tr_b16 v[44:45], v21 offset:32768
    ds_read_b64_tr_b16 v[46:47], v21 offset:33792
    v_mfma_f32_32x32x16_bf16 v[192:207], v[72:75], v[56:59], v[192:207]
    s_add_u32 m0, s61, 114688
    s_add_u32 s62, s101, 3407872
    s_and_b32 s62, s62, 0x3fffff
    buffer_load_dwordx4 v11, s[24:27], s62 offen lds
    ds_read_b64_tr_b16 v[48:49], v22 offset:32768
    v_mfma_f32_32x32x16_bf16 v[208:223], v[72:75], v[60:63], v[208:223]
    s_add_u32 m0, s61, 122880
    s_add_u32 s62, s101, 3407872
    s_and_b32 s62, s62, 0x3fffff
    buffer_load_dwordx4 v11, s[28:31], s62 offen lds
    ds_read_b64_tr_b16 v[50:51], v22 offset:33792
    v_mfma_f32_32x32x16_bf16 v[224:239], v[76:79], v[56:59], v[224:239]
    s_add_u32 m0, s60, 65536
    s_add_u32 s62, s100, 896
    s_and_b32 s62, s62, 1023
    buffer_load_dwordx4 v10, s[20:23], s62 offen lds
    ds_read_b64_tr_b16 v[52:53], v23 offset:32768
    v_mfma_f32_32x32x16_bf16 v[240:255], v[76:79], v[60:63], v[240:255]
    s_add_u32 m0, s60, 66560
    s_add_u32 s62, s100, 896
    s_and_b32 s62, s62, 1023
    buffer_load_dwordx4 v13, s[20:23], s62 offen lds
    ds_read_b64_tr_b16 v[54:55], v23 offset:33792
    s_waitcnt lgkmcnt(7)
    v_mfma_f32_32x32x16_bf16 v[128:143], v[40:43], v[32:35], v[128:143]
    ds_read_b128 v[56:59], v15 offset:0
    ds_read_b64_tr_b16 v[64:65], v20 offset:36864
    s_waitcnt lgkmcnt(8)
    v_mfma_f32_32x32x16_bf16 v[144:159], v[40:43], v[36:39], v[144:159]
    ds_read_b64_tr_b16 v[66:67], v20 offset:37888
    ds_read_b128 v[60:63], v15 offset:4096
    s_waitcnt lgkmcnt(8)
    v_mfma_f32_32x32x16_bf16 v[160:175], v[44:47], v[32:35], v[160:175]
    ds_read_b64_tr_b16 v[68:69], v21 offset:36864
    ds_read_b64_tr_b16 v[70:71], v21 offset:37888
    v_mfma_f32_32x32x16_bf16 v[176:191], v[44:47], v[36:39], v[176:191]
    ds_read_b64_tr_b16 v[72:73], v22 offset:36864
    ds_read_b64_tr_b16 v[74:75], v22 offset:37888
    s_waitcnt lgkmcnt(10)
    v_mfma_f32_32x32x16_bf16 v[192:207], v[48:51], v[32:35], v[192:207]
    ds_read_b64_tr_b16 v[76:77], v23 offset:36864
    ds_read_b64_tr_b16 v[78:79], v23 offset:37888
    v_mfma_f32_32x32x16_bf16 v[208:223], v[48:51], v[36:39], v[208:223]
    s_waitcnt lgkmcnt(10)
    v_mfma_f32_32x32x16_bf16 v[224:239], v[52:55], v[32:35], v[224:239]
    v_mfma_f32_32x32x16_bf16 v[240:255], v[52:55], v[36:39], v[240:255]
    s_waitcnt lgkmcnt(0)
    v_mfma_f32_32x32x16_bf16 v[128:143], v[64:67], v[56:59], v[128:143]
    v_mfma_f32_32x32x16_bf16 v[144:159], v[64:67], v[60:63], v[144:159]
    s_barrier
    ds_read_b128 v[32:35], v16 offset:0
    ds_read_b64_tr_b16 v[40:41], v20 offset:49152
    v_mfma_f32_32x32x16_bf16 v[160:175], v[68:71], v[56:59], v[160:175]
    ds_read_b64_tr_b16 v[42:43], v20 offset:50176
    ds_read_b128 v[36:39], v16 offset:4096
    v_mfma_f32_32x32x16_bf16 v[176:191], v[68:71], v[60:63], v[176:191]
    ds_read_b64_tr_b16 v[44:45], v21 offset:49152
    ds_read_b64_tr_b16 v[46:47], v21 offset:50176
    v_mfma_f32_32x32x16_bf16 v[192:207], v[72:75], v[56:59], v[192:207]
    s_add_u32 m0, s61, 131072
    s_add_u32 s62, s101, 3670016
    s_and_b32 s62, s62, 0x3fffff
    buffer_load_dwordx4 v11, s[24:27], s62 offen lds
    ds_read_b64_tr_b16 v[48:49], v22 offset:49152
    v_mfma_f32_32x32x16_bf16 v[208:223], v[72:75], v[60:63], v[208:223]
    s_add_u32 m0, s61, 139264
    s_add_u32 s62, s101, 3670016
    s_and_b32 s62, s62, 0x3fffff
    buffer_load_dwordx4 v11, s[28:31], s62 offen lds
    ds_read_b64_tr_b16 v[50:51], v22 offset:50176
    v_mfma_f32_32x32x16_bf16 v[224:239], v[76:79], v[56:59], v[224:239]
    s_add_u32 m0, s60, 67584
    s_add_u32 s62, s100, 896
    s_and_b32 s62, s62, 1023
    s_add_u32 s62, s62, 16384
    buffer_load_dwordx4 v10, s[20:23], s62 offen lds
    ds_read_b64_tr_b16 v[52:53], v23 offset:49152
    v_mfma_f32_32x32x16_bf16 v[240:255], v[76:79], v[60:63], v[240:255]
    s_add_u32 m0, s60, 68608
    s_add_u32 s62, s100, 896
    s_and_b32 s62, s62, 1023
    s_add_u32 s62, s62, 16384
    buffer_load_dwordx4 v13, s[20:23], s62 offen lds
    ds_read_b64_tr_b16 v[54:55], v23 offset:50176
    s_waitcnt lgkmcnt(7)
    v_mfma_f32_32x32x16_bf16 v[128:143], v[40:43], v[32:35], v[128:143]
    ds_read_b128 v[56:59], v17 offset:0
    ds_read_b64_tr_b16 v[64:65], v20 offset:53248
    s_waitcnt lgkmcnt(8)
    v_mfma_f32_32x32x16_bf16 v[144:159], v[40:43], v[36:39], v[144:159]
    ds_read_b64_tr_b16 v[66:67], v20 offset:54272
    ds_read_b128 v[60:63], v17 offset:4096
    s_waitcnt lgkmcnt(8)
    v_mfma_f32_32x32x16_bf16 v[160:175], v[44:47], v[32:35], v[160:175]
    ds_read_b64_tr_b16 v[68:69], v21 offset:53248
    ds_read_b64_tr_b16 v[70:71], v21 offset:54272
    v_mfma_f32_32x32x16_bf16 v[176:191], v[44:47], v[36:39], v[176:191]
    ds_read_b64_tr_b16 v[72:73], v22 offset:53248
    ds_read_b64_tr_b16 v[74:75], v22 offset:54272
    s_waitcnt lgkmcnt(10)
    v_mfma_f32_32x32x16_bf16 v[192:207], v[48:51], v[32:35], v[192:207]
    ds_read_b64_tr_b16 v[76:77], v23 offset:53248
    ds_read_b64_tr_b16 v[78:79], v23 offset:54272
    v_mfma_f32_32x32x16_bf16 v[208:223], v[48:51], v[36:39], v[208:223]
    s_waitcnt lgkmcnt(10)
    v_mfma_f32_32x32x16_bf16 v[224:239], v[52:55], v[32:35], v[224:239]
    v_mfma_f32_32x32x16_bf16 v[240:255], v[52:55], v[36:39], v[240:255]
    s_waitcnt lgkmcnt(0)
    v_mfma_f32_32x32x16_bf16 v[128:143], v[64:67], v[56:59], v[128:143]
    v_mfma_f32_32x32x16_bf16 v[144:159], v[64:67], v[60:63], v[144:159]
    s_waitcnt vmcnt(10)
    s_waitcnt vmcnt(8)
    s_barrier
    ds_read_b128 v[32:35], v14 offset:32768
    ds_read_b64_tr_b16 v[40:41], v20 offset:0
    v_mfma_f32_32x32x16_bf16 v[160:175], v[68:71], v[56:59], v[160:175]
    ds_read_b64_tr_b16 v[42:43], v20 offset:1024
    ds_read_b128 v[36:39], v14 offset:36864
    v_mfma_f32_32x32x16_bf16 v[176:191], v[68:71], v[60:63], v[176:191]
    ds_read_b64_tr_b16 v[44:45], v21 offset:0
    ds_read_b64_tr_b16 v[46:47], v21 offset:1024
    v_mfma_f32_32x32x16_bf16 v[192:207], v[72:75], v[56:59], v[192:207]
    s_add_u32 m0, s61, 147456
    s_add_u32 s62, s101, 3932160
    s_and_b32 s62, s62, 0x3fffff
    buffer_load_dwordx4 v11, s[24:27], s62 offen lds
    ds_read_b64_tr_b16 v[48:49], v22 offset:0
    v_mfma_f32_32x32x16_bf16 v[208:223], v[72:75], v[60:63], v[208:223]
    s_add_u32 m0, s61, 155648
    s_add_u32 s62, s101, 3932160
    s_and_b32 s62, s62, 0x3fffff
    buffer_load_dwordx4 v11, s[28:31], s62 offen lds
    ds_read_b64_tr_b16 v[50:51], v22 offset:1024
    v_mfma_f32_32x32x16_bf16 v[224:239], v[76:79], v[56:59], v[224:239]
    s_add_u32 m0, s61, 0
    s_mov_b32 s62, 0
    buffer_load_dwordx4 v11, s[4:7], s62 offen lds
    ds_read_b64_tr_b16 v[52:53], v23 offset:0
    v_mfma_f32_32x32x16_bf16 v[240:255], v[76:79], v[60:63], v[240:255]
    s_add_u32 m0, s61, 8192
    s_mov_b32 s62, 262144
    buffer_load_dwordx4 v11, s[4:7], s62 offen lds
    ds_read_b64_tr_b16 v[54:55], v23 offset:1024
    s_waitcnt lgkmcnt(7)
    v_mfma_f32_32x32x16_bf16 v[128:143], v[40:43], v[32:35], v[128:143]
    ds_read_b128 v[56:59], v15 offset:32768
    ds_read_b64_tr_b16 v[64:65], v20 offset:4096
    s_waitcnt lgkmcnt(8)
    v_mfma_f32_32x32x16_bf16 v[144:159], v[40:43], v[36:39], v[144:159]
    ds_read_b64_tr_b16 v[66:67], v20 offset:5120
    ds_read_b128 v[60:63], v15 offset:36864
    s_waitcnt lgkmcnt(8)
    v_mfma_f32_32x32x16_bf16 v[160:175], v[44:47], v[32:35], v[160:175]
    ds_read_b64_tr_b16 v[68:69], v21 offset:4096
    ds_read_b64_tr_b16 v[70:71], v21 offset:5120
    v_mfma_f32_32x32x16_bf16 v[176:191], v[44:47], v[36:39], v[176:191]
    ds_read_b64_tr_b16 v[72:73], v22 offset:4096
    ds_read_b64_tr_b16 v[74:75], v22 offset:5120
    buffer_load_dwordx4 v[80:83], v4, s[32:35], s42 offen offset:0 sc1
    s_waitcnt lgkmcnt(10)
    v_mfma_f32_32x32x16_bf16 v[192:207], v[48:51], v[32:35], v[192:207]
    ds_read_b64_tr_b16 v[76:77], v23 offset:4096
    ds_read_b64_tr_b16 v[78:79], v23 offset:5120
    v_mfma_f32_32x32x16_bf16 v[208:223], v[48:51], v[36:39], v[208:223]
    s_waitcnt lgkmcnt(10)
    v_mfma_f32_32x32x16_bf16 v[224:239], v[52:55], v[32:35], v[224:239]
    v_mfma_f32_32x32x16_bf16 v[240:255], v[52:55], v[36:39], v[240:255]
    buffer_load_dwordx4 v[84:87], v4, s[32:35], s42 offen offset:1024 sc1
    s_waitcnt lgkmcnt(0)
    v_mfma_f32_32x32x16_bf16 v[128:143], v[64:67], v[56:59], v[128:143]
    v_mfma_f32_32x32x16_bf16 v[144:159], v[64:67], v[60:63], v[144:159]
    s_waitcnt vmcnt(12)
    s_barrier
    ds_read_b128 v[32:35], v16 offset:32768
    buffer_load_dwordx4 v[88:91], v4, s[32:35], s42 offen offset:2048 sc1
    ds_read_b64_tr_b16 v[40:41], v20 offset:16384
    v_mfma_f32_32x32x16_bf16 v[160:175], v[68:71], v[56:59], v[160:175]
    ds_read_b64_tr_b16 v[42:43], v20 offset:17408
    ds_read_b128 v[36:39], v16 offset:36864
    v_mfma_f32_32x32x16_bf16 v[176:191], v[68:71], v[60:63], v[176:191]
    ds_read_b64_tr_b16 v[44:45], v21 offset:16384
    ds_read_b64_tr_b16 v[46:47], v21 offset:17408
    v_mfma_f32_32x32x16_bf16 v[192:207], v[72:75], v[56:59], v[192:207]
    s_add_u32 m0, s61, 98304
    s_mov_b32 s62, 2097152
    buffer_load_dwordx4 v11, s[4:7], s62 offen lds
    ds_read_b64_tr_b16 v[48:49], v22 offset:16384
    buffer_load_dwordx4 v[92:95], v4, s[32:35], s42 offen offset:3072 sc1
    s_add_u32 s42, s42, 4096
    v_mfma_f32_32x32x16_bf16 v[208:223], v[72:75], v[60:63], v[208:223]
    s_add_u32 m0, s61, 106496
    s_mov_b32 s62, 2359296
    buffer_load_dwordx4 v11, s[4:7], s62 offen lds
    ds_read_b64_tr_b16 v[50:51], v22 offset:17408
    v_mfma_f32_32x32x16_bf16 v[224:239], v[76:79], v[56:59], v[224:239]
    s_add_u32 m0, s61, 16384
    s_mov_b32 s62, 524288
    buffer_load_dwordx4 v11, s[4:7], s62 offen lds
    ds_read_b64_tr_b16 v[52:53], v23 offset:16384
    v_mfma_f32_32x32x16_bf16 v[240:255], v[76:79], v[60:63], v[240:255]
    s_add_u32 m0, s61, 24576
    s_mov_b32 s62, 786432
    buffer_load_dwordx4 v11, s[4:7], s62 offen lds
    ds_read_b64_tr_b16 v[54:55], v23 offset:17408
    s_waitcnt lgkmcnt(7)
    v_mfma_f32_32x32x16_bf16 v[128:143], v[40:43], v[32:35], v[128:143]
    ds_read_b128 v[56:59], v17 offset:32768
    ds_read_b64_tr_b16 v[64:65], v20 offset:20480
    s_waitcnt lgkmcnt(8)
    v_mfma_f32_32x32x16_bf16 v[144:159], v[40:43], v[36:39], v[144:159]
    ds_read_b64_tr_b16 v[66:67], v20 offset:21504
    ds_read_b128 v[60:63], v17 offset:36864
    s_waitcnt lgkmcnt(8)
    v_mfma_f32_32x32x16_bf16 v[160:175], v[44:47], v[32:35], v[160:175]
    ds_read_b64_tr_b16 v[68:69], v21 offset:20480
    ds_read_b64_tr_b16 v[70:71], v21 offset:21504
    v_mfma_f32_32x32x16_bf16 v[176:191], v[44:47], v[36:39], v[176:191]
    ds_read_b64_tr_b16 v[72:73], v22 offset:20480
    ds_read_b64_tr_b16 v[74:75], v22 offset:21504
    buffer_load_dwordx4 v[96:99], v4, s[32:35], s42 offen offset:0 sc1
    s_waitcnt lgkmcnt(10)
    v_mfma_f32_32x32x16_bf16 v[192:207], v[48:51], v[32:35], v[192:207]
    ds_read_b64_tr_b16 v[76:77], v23 offset:20480
    ds_read_b64_tr_b16 v[78:79], v23 offset:21504
    v_mfma_f32_32x32x16_bf16 v[208:223], v[48:51], v[36:39], v[208:223]
    s_waitcnt lgkmcnt(10)
    v_mfma_f32_32x32x16_bf16 v[224:239], v[52:55], v[32:35], v[224:239]
    v_mfma_f32_32x32x16_bf16 v[240:255], v[52:55], v[36:39], v[240:255]
    buffer_load_dwordx4 v[100:103], v4, s[32:35], s42 offen offset:1024 sc1
    s_waitcnt lgkmcnt(0)
    v_mfma_f32_32x32x16_bf16 v[128:143], v[64:67], v[56:59], v[128:143]
    v_mfma_f32_32x32x16_bf16 v[144:159], v[64:67], v[60:63], v[144:159]
    s_waitcnt vmcnt(16)
    s_waitcnt vmcnt(14)
    s_barrier
    ds_read_b128 v[32:35], v24 offset:0
    buffer_load_dwordx4 v[104:107], v4, s[32:35], s42 offen offset:2048 sc1
    ds_read_b64_tr_b16 v[40:41], v20 offset:32768
    v_mfma_f32_32x32x16_bf16 v[160:175], v[68:71], v[56:59], v[160:175]
    ds_read_b64_tr_b16 v[42:43], v20 offset:33792
    ds_read_b128 v[36:39], v24 offset:4096
    v_mfma_f32_32x32x16_bf16 v[176:191], v[68:71], v[60:63], v[176:191]
    ds_read_b64_tr_b16 v[44:45], v21 offset:32768
    ds_read_b64_tr_b16 v[46:47], v21 offset:33792
    v_mfma_f32_32x32x16_bf16 v[192:207], v[72:75], v[56:59], v[192:207]
    s_add_u32 m0, s61, 114688
    s_mov_b32 s62, 2621440
    buffer_load_dwordx4 v11, s[4:7], s62 offen lds
    ds_read_b64_tr_b16 v[48:49], v22 offset:32768
    buffer_load_dwordx4 v[108:111], v4, s[32:35], s42 offen offset:3072 sc1
    s_add_u32 s42, s42, 4096
    v_mfma_f32_32x32x16_bf16 v[208:223], v[72:75], v[60:63], v[208:223]
    s_add_u32 m0, s61, 122880
    s_mov_b32 s62, 2883584
    buffer_load_dwordx4 v11, s[4:7], s62 offen lds
    ds_read_b64_tr_b16 v[50:51], v22 offset:33792
    v_mfma_f32_32x32x16_bf16 v[224:239], v[76:79], v[56:59], v[224:239]
    s_add_u32 m0, s61, 32768
    s_mov_b32 s62, 1048576
    buffer_load_dwordx4 v11, s[4:7], s62 offen lds
    ds_read_b64_tr_b16 v[52:53], v23 offset:32768
    v_mfma_f32_32x32x16_bf16 v[240:255], v[76:79], v[60:63], v[240:255]
    s_add_u32 m0, s61, 40960
    s_mov_b32 s62, 1310720
    buffer_load_dwordx4 v11, s[4:7], s62 offen lds
    ds_read_b64_tr_b16 v[54:55], v23 offset:33792
    s_waitcnt lgkmcnt(7)
    v_mfma_f32_32x32x16_bf16 v[128:143], v[40:43], v[32:35], v[128:143]
    ds_read_b128 v[56:59], v25 offset:0
    ds_read_b64_tr_b16 v[64:65], v20 offset:36864
    s_waitcnt lgkmcnt(8)
    v_mfma_f32_32x32x16_bf16 v[144:159], v[40:43], v[36:39], v[144:159]
    ds_read_b64_tr_b16 v[66:67], v20 offset:37888
    ds_read_b128 v[60:63], v25 offset:4096
    s_waitcnt lgkmcnt(8)
    v_mfma_f32_32x32x16_bf16 v[160:175], v[44:47], v[32:35], v[160:175]
    ds_read_b64_tr_b16 v[68:69], v21 offset:36864
    ds_read_b64_tr_b16 v[70:71], v21 offset:37888
    v_mfma_f32_32x32x16_bf16 v[176:191], v[44:47], v[36:39], v[176:191]
    ds_read_b64_tr_b16 v[72:73], v22 offset:36864
    ds_read_b64_tr_b16 v[74:75], v22 offset:37888
    buffer_load_dwordx4 v[112:115], v4, s[32:35], s42 offen offset:0 sc1
    s_waitcnt lgkmcnt(10)
    v_mfma_f32_32x32x16_bf16 v[192:207], v[48:51], v[32:35], v[192:207]
    ds_read_b64_tr_b16 v[76:77], v23 offset:36864
    ds_read_b64_tr_b16 v[78:79], v23 offset:37888
    v_mfma_f32_32x32x16_bf16 v[208:223], v[48:51], v[36:39], v[208:223]
    s_waitcnt lgkmcnt(10)
    v_mfma_f32_32x32x16_bf16 v[224:239], v[52:55], v[32:35], v[224:239]
    v_mfma_f32_32x32x16_bf16 v[240:255], v[52:55], v[36:39], v[240:255]
    buffer_load_dwordx4 v[116:119], v4, s[32:35], s42 offen offset:1024 sc1
    s_waitcnt lgkmcnt(0)
    v_mfma_f32_32x32x16_bf16 v[128:143], v[64:67], v[56:59], v[128:143]
    v_mfma_f32_32x32x16_bf16 v[144:159], v[64:67], v[60:63], v[144:159]
    s_waitcnt vmcnt(20)
    s_barrier
    ds_read_b128 v[32:35], v26 offset:0
    buffer_load_dwordx4 v[120:123], v4, s[32:35], s42 offen offset:2048 sc1
    ds_read_b64_tr_b16 v[40:41], v20 offset:49152
    v_mfma_f32_32x32x16_bf16 v[160:175], v[68:71], v[56:59], v[160:175]
    ds_read_b64_tr_b16 v[42:43], v20 offset:50176
    ds_read_b128 v[36:39], v26 offset:4096
    v_mfma_f32_32x32x16_bf16 v[176:191], v[68:71], v[60:63], v[176:191]
    ds_read_b64_tr_b16 v[44:45], v21 offset:49152
    ds_read_b64_tr_b16 v[46:47], v21 offset:50176
    v_mfma_f32_32x32x16_bf16 v[192:207], v[72:75], v[56:59], v[192:207]
    s_add_u32 m0, s61, 131072
    s_mov_b32 s62, 3145728
    buffer_load_dwordx4 v11, s[4:7], s62 offen lds
    ds_read_b64_tr_b16 v[48:49], v22 offset:49152
    buffer_load_dwordx4 v[124:127], v4, s[32:35], s42 offen offset:3072 sc1
    s_add_u32 s42, s42, 4096
    v_mfma_f32_32x32x16_bf16 v[208:223], v[72:75], v[60:63], v[208:223]
    s_add_u32 m0, s61, 139264
    s_mov_b32 s62, 3407872
    buffer_load_dwordx4 v11, s[4:7], s62 offen lds
    ds_read_b64_tr_b16 v[50:51], v22 offset:50176
    v_mfma_f32_32x32x16_bf16 v[224:239], v[76:79], v[56:59], v[224:239]
    s_add_u32 m0, s61, 49152
    s_mov_b32 s62, 1572864
    buffer_load_dwordx4 v11, s[4:7], s62 offen lds
    ds_read_b64_tr_b16 v[52:53], v23 offset:49152
    v_mfma_f32_32x32x16_bf16 v[240:255], v[76:79], v[60:63], v[240:255]
    s_add_u32 m0, s61, 57344
    s_mov_b32 s62, 1835008
    buffer_load_dwordx4 v11, s[4:7], s62 offen lds
    ds_read_b64_tr_b16 v[54:55], v23 offset:50176
    s_waitcnt lgkmcnt(7)
    v_mfma_f32_32x32x16_bf16 v[128:143], v[40:43], v[32:35], v[128:143]
    ds_read_b128 v[56:59], v27 offset:0
    ds_read_b64_tr_b16 v[64:65], v20 offset:53248
    s_waitcnt lgkmcnt(8)
    v_mfma_f32_32x32x16_bf16 v[144:159], v[40:43], v[36:39], v[144:159]
    ds_read_b64_tr_b16 v[66:67], v20 offset:54272
    ds_read_b128 v[60:63], v27 offset:4096
    s_waitcnt lgkmcnt(8)
    v_mfma_f32_32x32x16_bf16 v[160:175], v[44:47], v[32:35], v[160:175]
    ds_read_b64_tr_b16 v[68:69], v21 offset:53248
    ds_read_b64_tr_b16 v[70:71], v21 offset:54272
    v_mfma_f32_32x32x16_bf16 v[176:191], v[44:47], v[36:39], v[176:191]
    ds_read_b64_tr_b16 v[72:73], v22 offset:53248
    ds_read_b64_tr_b16 v[74:75], v22 offset:54272
    s_waitcnt lgkmcnt(10)
    v_mfma_f32_32x32x16_bf16 v[192:207], v[48:51], v[32:35], v[192:207]
    ds_read_b64_tr_b16 v[76:77], v23 offset:53248
    ds_read_b64_tr_b16 v[78:79], v23 offset:54272
    v_mfma_f32_32x32x16_bf16 v[208:223], v[48:51], v[36:39], v[208:223]
    s_waitcnt lgkmcnt(10)
    v_mfma_f32_32x32x16_bf16 v[224:239], v[52:55], v[32:35], v[224:239]
    v_mfma_f32_32x32x16_bf16 v[240:255], v[52:55], v[36:39], v[240:255]
    s_waitcnt lgkmcnt(0)
    v_mfma_f32_32x32x16_bf16 v[128:143], v[64:67], v[56:59], v[128:143]
    v_mfma_f32_32x32x16_bf16 v[144:159], v[64:67], v[60:63], v[144:159]
    s_waitcnt vmcnt(16)
    s_barrier
    v_subrev_u32 v20, s67, v20
    v_subrev_u32 v21, s67, v21
    v_subrev_u32 v22, s67, v22
    v_subrev_u32 v23, s67, v23
    v_add_u32 v24, 4294868992, v20
    v_add_u32 v25, 4294868992, v21
    v_add_u32 v26, 4294868992, v22
    v_add_u32 v27, 4294868992, v23
    ds_read_b64_tr_b16 v[32:33], v24 offset:0
    v_mfma_f32_32x32x16_bf16 v[160:175], v[68:71], v[56:59], v[160:175]
    ds_read_b64_tr_b16 v[34:35], v24 offset:1024
    ds_read_b64_tr_b16 v[36:37], v25 offset:0
    v_mfma_f32_32x32x16_bf16 v[176:191], v[68:71], v[60:63], v[176:191]
    ds_read_b64_tr_b16 v[38:39], v25 offset:1024
    ds_read_b64_tr_b16 v[40:41], v26 offset:0
    v_mfma_f32_32x32x16_bf16 v[192:207], v[72:75], v[56:59], v[192:207]
    s_add_u32 m0, s61, 147456
    s_mov_b32 s62, 3670016
    buffer_load_dwordx4 v11, s[4:7], s62 offen lds
    v_mfma_f32_32x32x16_bf16 v[208:223], v[72:75], v[60:63], v[208:223]
    ds_read_b64_tr_b16 v[42:43], v26 offset:1024
    ds_read_b64_tr_b16 v[44:45], v27 offset:0
    v_mfma_f32_32x32x16_bf16 v[224:239], v[76:79], v[56:59], v[224:239]
    s_add_u32 m0, s61, 155648
    s_mov_b32 s62, 3932160
    buffer_load_dwordx4 v11, s[4:7], s62 offen lds
    ds_read_b64_tr_b16 v[46:47], v27 offset:1024
    v_mfma_f32_32x32x16_bf16 v[240:255], v[76:79], v[60:63], v[240:255]
    s_lshl_b32 s48, s45, 6
    s_lshl_b32 s49, s46, 3
    s_add_u32 s48, s48, s49
    s_lshl_b32 s49, s41, 1
    s_add_u32 s48, s48, s49
    s_lshl_b32 s48, s48, 13
    s_add_u32 s17, s48, 0
    s_add_u32 s18, s17, 1024
    s_mov_b32 s19, 2048
    s_load_dwordx2 s[20:21], s[0:1], 0
    s_load_dwordx2 s[24:25], s[0:1], 72
    s_load_dwordx2 s[28:29], s[0:1], 40
    v_cvt_pk_bf16_f32 v128, v128, v129
    v_cvt_pk_bf16_f32 v129, v130, v131
    v_cvt_pk_bf16_f32 v130, v132, v133
    v_cvt_pk_bf16_f32 v131, v134, v135
    v_cvt_pk_bf16_f32 v132, v136, v137
    v_cvt_pk_bf16_f32 v133, v138, v139
    v_cvt_pk_bf16_f32 v134, v140, v141
    v_cvt_pk_bf16_f32 v135, v142, v143
    v_cvt_pk_bf16_f32 v136, v144, v145
    v_cvt_pk_bf16_f32 v137, v146, v147
    v_cvt_pk_bf16_f32 v138, v148, v149
    v_cvt_pk_bf16_f32 v139, v150, v151
    v_cvt_pk_bf16_f32 v140, v152, v153
    v_cvt_pk_bf16_f32 v141, v154, v155
    v_cvt_pk_bf16_f32 v142, v156, v157
    v_cvt_pk_bf16_f32 v143, v158, v159
    v_cvt_pk_bf16_f32 v160, v160, v161
    v_cvt_pk_bf16_f32 v161, v162, v163
    v_cvt_pk_bf16_f32 v162, v164, v165
    v_cvt_pk_bf16_f32 v163, v166, v167
    v_cvt_pk_bf16_f32 v164, v168, v169
    v_cvt_pk_bf16_f32 v165, v170, v171
    v_cvt_pk_bf16_f32 v166, v172, v173
    v_cvt_pk_bf16_f32 v167, v174, v175
    v_cvt_pk_bf16_f32 v168, v176, v177
    v_cvt_pk_bf16_f32 v169, v178, v179
    v_cvt_pk_bf16_f32 v170, v180, v181
    v_cvt_pk_bf16_f32 v171, v182, v183
    v_cvt_pk_bf16_f32 v172, v184, v185
    v_cvt_pk_bf16_f32 v173, v186, v187
    v_cvt_pk_bf16_f32 v174, v188, v189
    v_cvt_pk_bf16_f32 v175, v190, v191
    buffer_load_dwordx4 v[64:67], v4, s[32:35], s42 offen offset:0 sc1
    buffer_load_dwordx4 v[68:71], v4, s[32:35], s42 offen offset:1024 sc1
    buffer_load_dwordx4 v[72:75], v4, s[32:35], s42 offen offset:2048 sc1
    buffer_load_dwordx4 v[76:79], v4, s[32:35], s42 offen offset:3072 sc1
    s_add_u32 s42, s42, 4096
    v_cvt_pk_bf16_f32 v192, v192, v193
    v_cvt_pk_bf16_f32 v193, v194, v195
    v_cvt_pk_bf16_f32 v194, v196, v197
    v_cvt_pk_bf16_f32 v195, v198, v199
    v_cvt_pk_bf16_f32 v196, v200, v201
    v_cvt_pk_bf16_f32 v197, v202, v203
    v_cvt_pk_bf16_f32 v198, v204, v205
    v_cvt_pk_bf16_f32 v199, v206, v207
    v_cvt_pk_bf16_f32 v200, v208, v209
    v_cvt_pk_bf16_f32 v201, v210, v211
    v_cvt_pk_bf16_f32 v202, v212, v213
    v_cvt_pk_bf16_f32 v203, v214, v215
    v_cvt_pk_bf16_f32 v204, v216, v217
    v_cvt_pk_bf16_f32 v205, v218, v219
    v_cvt_pk_bf16_f32 v206, v220, v221
    v_cvt_pk_bf16_f32 v207, v222, v223
    v_cvt_pk_bf16_f32 v224, v224, v225
    v_cvt_pk_bf16_f32 v225, v226, v227
    v_cvt_pk_bf16_f32 v226, v228, v229
    v_cvt_pk_bf16_f32 v227, v230, v231
    v_cvt_pk_bf16_f32 v228, v232, v233
    v_cvt_pk_bf16_f32 v229, v234, v235
    v_cvt_pk_bf16_f32 v230, v236, v237
    v_cvt_pk_bf16_f32 v231, v238, v239
    v_cvt_pk_bf16_f32 v232, v240, v241
    v_cvt_pk_bf16_f32 v233, v242, v243
    v_cvt_pk_bf16_f32 v234, v244, v245
    v_cvt_pk_bf16_f32 v235, v246, v247
    v_cvt_pk_bf16_f32 v236, v248, v249
    v_cvt_pk_bf16_f32 v237, v250, v251
    v_cvt_pk_bf16_f32 v238, v252, v253
    v_cvt_pk_bf16_f32 v239, v254, v255
    s_waitcnt lgkmcnt(0)
    v_mfma_f32_32x32x16_bf16 v[144:159], v[32:35], v[80:83], 0
    ds_read_b64_tr_b16 v[48:49], v24 offset:4096
    ds_read_b64_tr_b16 v[50:51], v24 offset:5120
    buffer_store_dwordx4 v[128:131], v4, s[32:35], s17 offen sc1
    v_mfma_f32_32x32x16_bf16 v[176:191], v[36:39], v[80:83], 0
    ds_read_b64_tr_b16 v[52:53], v25 offset:4096
    ds_read_b64_tr_b16 v[54:55], v25 offset:5120
    v_mfma_f32_32x32x16_bf16 v[208:223], v[40:43], v[80:83], 0
    ds_read_b64_tr_b16 v[56:57], v26 offset:4096
    ds_read_b64_tr_b16 v[58:59], v26 offset:5120
    v_mfma_f32_32x32x16_bf16 v[240:255], v[44:47], v[80:83], 0
    ds_read_b64_tr_b16 v[60:61], v27 offset:4096
    ds_read_b64_tr_b16 v[62:63], v27 offset:5120
    s_waitcnt lgkmcnt(6)
    v_mfma_f32_32x32x16_bf16 v[144:159], v[48:51], v[84:87], v[144:159]
    ds_read_b64_tr_b16 v[32:33], v24 offset:8192
    ds_read_b64_tr_b16 v[34:35], v24 offset:9216
    buffer_load_dwordx4 v[80:83], v4, s[32:35], s42 offen offset:0 sc1
    s_waitcnt lgkmcnt(6)
    v_mfma_f32_32x32x16_bf16 v[176:191], v[52:55], v[84:87], v[176:191]
    ds_read_b64_tr_b16 v[36:37], v25 offset:8192
    ds_read_b64_tr_b16 v[38:39], v25 offset:9216
    buffer_store_dwordx4 v[132:135], v4, s[32:35], s18 offen sc1
    s_waitcnt lgkmcnt(6)
    v_mfma_f32_32x32x16_bf16 v[208:223], v[56:59], v[84:87], v[208:223]
    ds_read_b64_tr_b16 v[40:41], v26 offset:8192
    ds_read_b64_tr_b16 v[42:43], v26 offset:9216
    s_mov_b32 s22, 0x200000
    s_mov_b32 s26, 0x200000
    s_mov_b32 s30, 0x400000
    s_waitcnt lgkmcnt(6)
    v_mfma_f32_32x32x16_bf16 v[240:255], v[60:63], v[84:87], v[240:255]
    ds_read_b64_tr_b16 v[44:45], v27 offset:8192
    ds_read_b64_tr_b16 v[46:47], v27 offset:9216
    s_waitcnt lgkmcnt(6)
    v_mfma_f32_32x32x16_bf16 v[144:159], v[32:35], v[88:91], v[144:159]
    ds_read_b64_tr_b16 v[48:49], v24 offset:12288
    ds_read_b64_tr_b16 v[50:51], v24 offset:13312
    buffer_load_dwordx4 v[84:87], v4, s[32:35], s42 offen offset:1024 sc1
    s_waitcnt lgkmcnt(6)
    v_mfma_f32_32x32x16_bf16 v[176:191], v[36:39], v[88:91], v[176:191]
    ds_read_b64_tr_b16 v[52:53], v25 offset:12288
    ds_read_b64_tr_b16 v[54:55], v25 offset:13312
    s_waitcnt lgkmcnt(6)
    v_mfma_f32_32x32x16_bf16 v[208:223], v[40:43], v[88:91], v[208:223]
    ds_read_b64_tr_b16 v[56:57], v26 offset:12288
    ds_read_b64_tr_b16 v[58:59], v26 offset:13312
    buffer_store_dwordx4 v[136:139], v9, s[32:35], s17 offen sc1
    s_waitcnt lgkmcnt(6)
    v_mfma_f32_32x32x16_bf16 v[240:255], v[44:47], v[88:91], v[240:255]
    ds_read_b64_tr_b16 v[60:61], v27 offset:12288
    ds_read_b64_tr_b16 v[62:63], v27 offset:13312
    s_waitcnt lgkmcnt(6)
    v_mfma_f32_32x32x16_bf16 v[144:159], v[48:51], v[92:95], v[144:159]
    ds_read_b64_tr_b16 v[32:33], v24 offset:16384
    ds_read_b64_tr_b16 v[34:35], v24 offset:17408
    buffer_load_dwordx4 v[88:91], v4, s[32:35], s42 offen offset:2048 sc1
    s_waitcnt lgkmcnt(6)
    v_mfma_f32_32x32x16_bf16 v[176:191], v[52:55], v[92:95], v[176:191]
    ds_read_b64_tr_b16 v[36:37], v25 offset:16384
    ds_read_b64_tr_b16 v[38:39], v25 offset:17408
    s_waitcnt lgkmcnt(6)
    v_mfma_f32_32x32x16_bf16 v[208:223], v[56:59], v[92:95], v[208:223]
    ds_read_b64_tr_b16 v[40:41], v26 offset:16384
    ds_read_b64_tr_b16 v[42:43], v26 offset:17408
    buffer_store_dwordx4 v[140:143], v9, s[32:35], s18 offen sc1
    s_add_u32 s17, s17, s19
    s_add_u32 s18, s18, s19
    s_waitcnt lgkmcnt(6)
    v_mfma_f32_32x32x16_bf16 v[240:255], v[60:63], v[92:95], v[240:255]
    ds_read_b64_tr_b16 v[44:45], v27 offset:16384
    ds_read_b64_tr_b16 v[46:47], v27 offset:17408
    s_waitcnt vmcnt(28) lgkmcnt(6)
    v_mfma_f32_32x32x16_bf16 v[144:159], v[32:35], v[96:99], v[144:159]
    ds_read_b64_tr_b16 v[48:49], v24 offset:20480
    ds_read_b64_tr_b16 v[50:51], v24 offset:21504
    buffer_load_dwordx4 v[92:95], v4, s[32:35], s42 offen offset:3072 sc1
    s_add_u32 s42, s42, 4096
    s_waitcnt lgkmcnt(6)
    v_mfma_f32_32x32x16_bf16 v[176:191], v[36:39], v[96:99], v[176:191]
    ds_read_b64_tr_b16 v[52:53], v25 offset:20480
    ds_read_b64_tr_b16 v[54:55], v25 offset:21504
    s_waitcnt lgkmcnt(6)
    v_mfma_f32_32x32x16_bf16 v[208:223], v[40:43], v[96:99], v[208:223]
    ds_read_b64_tr_b16 v[56:57], v26 offset:20480
    ds_read_b64_tr_b16 v[58:59], v26 offset:21504
    buffer_store_dwordx4 v[160:163], v4, s[32:35], s17 offen sc1
    s_waitcnt lgkmcnt(6)
    v_mfma_f32_32x32x16_bf16 v[240:255], v[44:47], v[96:99], v[240:255]
    ds_read_b64_tr_b16 v[60:61], v27 offset:20480
    ds_read_b64_tr_b16 v[62:63], v27 offset:21504
    s_waitcnt vmcnt(29) lgkmcnt(6)
    v_mfma_f32_32x32x16_bf16 v[144:159], v[48:51], v[100:103], v[144:159]
    ds_read_b64_tr_b16 v[32:33], v24 offset:24576
    ds_read_b64_tr_b16 v[34:35], v24 offset:25600
    buffer_load_dwordx4 v[96:99], v4, s[32:35], s42 offen offset:0 sc1
    s_waitcnt lgkmcnt(6)
    v_mfma_f32_32x32x16_bf16 v[176:191], v[52:55], v[100:103], v[176:191]
    ds_read_b64_tr_b16 v[36:37], v25 offset:24576
    ds_read_b64_tr_b16 v[38:39], v25 offset:25600
    s_waitcnt lgkmcnt(6)
    v_mfma_f32_32x32x16_bf16 v[208:223], v[56:59], v[100:103], v[208:223]
    ds_read_b64_tr_b16 v[40:41], v26 offset:24576
    ds_read_b64_tr_b16 v[42:43], v26 offset:25600
    buffer_store_dwordx4 v[164:167], v4, s[32:35], s18 offen sc1
    s_waitcnt lgkmcnt(6)
    v_mfma_f32_32x32x16_bf16 v[240:255], v[60:63], v[100:103], v[240:255]
    ds_read_b64_tr_b16 v[44:45], v27 offset:24576
    ds_read_b64_tr_b16 v[46:47], v27 offset:25600
    s_waitcnt vmcnt(30) lgkmcnt(6)
    v_mfma_f32_32x32x16_bf16 v[144:159], v[32:35], v[104:107], v[144:159]
    ds_read_b64_tr_b16 v[48:49], v24 offset:28672
    ds_read_b64_tr_b16 v[50:51], v24 offset:29696
    buffer_load_dwordx4 v[100:103], v4, s[32:35], s42 offen offset:1024 sc1
    s_waitcnt lgkmcnt(6)
    v_mfma_f32_32x32x16_bf16 v[176:191], v[36:39], v[104:107], v[176:191]
    ds_read_b64_tr_b16 v[52:53], v25 offset:28672
    ds_read_b64_tr_b16 v[54:55], v25 offset:29696
    s_waitcnt lgkmcnt(6)
    v_mfma_f32_32x32x16_bf16 v[208:223], v[40:43], v[104:107], v[208:223]
    ds_read_b64_tr_b16 v[56:57], v26 offset:28672
    ds_read_b64_tr_b16 v[58:59], v26 offset:29696
    buffer_store_dwordx4 v[168:171], v9, s[32:35], s17 offen sc1
    s_waitcnt lgkmcnt(6)
    v_mfma_f32_32x32x16_bf16 v[240:255], v[44:47], v[104:107], v[240:255]
    ds_read_b64_tr_b16 v[60:61], v27 offset:28672
    ds_read_b64_tr_b16 v[62:63], v27 offset:29696
    s_waitcnt lgkmcnt(0)
    s_waitcnt vmcnt(30)
    v_mfma_f32_32x32x16_bf16 v[144:159], v[48:51], v[108:111], v[144:159]
    s_waitcnt vmcnt(19)
    s_barrier
    ds_read_b64_tr_b16 v[32:33], v24 offset:32768
    ds_read_b64_tr_b16 v[34:35], v24 offset:33792
    buffer_load_dwordx4 v[104:107], v4, s[32:35], s42 offen offset:2048 sc1
    v_mfma_f32_32x32x16_bf16 v[176:191], v[52:55], v[108:111], v[176:191]
    ds_read_b64_tr_b16 v[36:37], v25 offset:32768
    ds_read_b64_tr_b16 v[38:39], v25 offset:33792
    v_mfma_f32_32x32x16_bf16 v[208:223], v[56:59], v[108:111], v[208:223]
    ds_read_b64_tr_b16 v[40:41], v26 offset:32768
    ds_read_b64_tr_b16 v[42:43], v26 offset:33792
    buffer_store_dwordx4 v[172:175], v9, s[32:35], s18 offen sc1
    s_add_u32 s17, s17, s19
    s_add_u32 s18, s18, s19
    v_mfma_f32_32x32x16_bf16 v[240:255], v[60:63], v[108:111], v[240:255]
    ds_read_b64_tr_b16 v[44:45], v27 offset:32768
    ds_read_b64_tr_b16 v[46:47], v27 offset:33792
    s_waitcnt lgkmcnt(6)
    v_mfma_f32_32x32x16_bf16 v[144:159], v[32:35], v[112:115], v[144:159]
    ds_read_b64_tr_b16 v[48:49], v24 offset:36864
    ds_read_b64_tr_b16 v[50:51], v24 offset:37888
    buffer_load_dwordx4 v[108:111], v4, s[32:35], s42 offen offset:3072 sc1
    s_add_u32 s42, s42, 4096
    s_waitcnt lgkmcnt(6)
    v_mfma_f32_32x32x16_bf16 v[176:191], v[36:39], v[112:115], v[176:191]
    ds_read_b64_tr_b16 v[52:53], v25 offset:36864
    ds_read_b64_tr_b16 v[54:55], v25 offset:37888
    s_waitcnt lgkmcnt(6)
    v_mfma_f32_32x32x16_bf16 v[208:223], v[40:43], v[112:115], v[208:223]
    ds_read_b64_tr_b16 v[56:57], v26 offset:36864
    ds_read_b64_tr_b16 v[58:59], v26 offset:37888
    buffer_store_dwordx4 v[192:195], v4, s[32:35], s17 offen sc1
    s_waitcnt lgkmcnt(6)
    v_mfma_f32_32x32x16_bf16 v[240:255], v[44:47], v[112:115], v[240:255]
    ds_read_b64_tr_b16 v[60:61], v27 offset:36864
    ds_read_b64_tr_b16 v[62:63], v27 offset:37888
    s_waitcnt lgkmcnt(6)
    v_mfma_f32_32x32x16_bf16 v[144:159], v[48:51], v[116:119], v[144:159]
    ds_read_b64_tr_b16 v[32:33], v24 offset:40960
    ds_read_b64_tr_b16 v[34:35], v24 offset:41984
    buffer_load_dwordx4 v[112:115], v4, s[32:35], s42 offen offset:0 sc1
    buffer_store_dwordx4 v[196:199], v4, s[32:35], s18 offen sc1
    s_waitcnt lgkmcnt(6)
    v_mfma_f32_32x32x16_bf16 v[176:191], v[52:55], v[116:119], v[176:191]
    ds_read_b64_tr_b16 v[36:37], v25 offset:40960
    ds_read_b64_tr_b16 v[38:39], v25 offset:41984
    s_lshl_b32 s60, s44, 11
    s_mov_b32 s50, 0
    s_lshl_b32 s51, s46, 1
    s_add_u32 s51, s51, 2
    s_lshl_b32 s52, s47, 1
    s_add_u32 s52, s52, 2
    s_waitcnt lgkmcnt(6)
    v_mfma_f32_32x32x16_bf16 v[208:223], v[56:59], v[116:119], v[208:223]
    ds_read_b64_tr_b16 v[40:41], v26 offset:40960
    ds_read_b64_tr_b16 v[42:43], v26 offset:41984
    s_add_u32 s53, s60, 32768
    s_lshl_b32 s54, s45, 19
    s_add_u32 s55, s54, 16777216
    s_add_u32 s59, s60, 98304
    s_mov_b32 s57, s58
    s_mov_b32 s73, s58
    s_waitcnt lgkmcnt(6)
    v_mfma_f32_32x32x16_bf16 v[240:255], v[60:63], v[116:119], v[240:255]
    ds_read_b64_tr_b16 v[44:45], v27 offset:40960
    ds_read_b64_tr_b16 v[46:47], v27 offset:41984
    s_mov_b32 s75, -1
    s_waitcnt lgkmcnt(6)
    v_mfma_f32_32x32x16_bf16 v[144:159], v[32:35], v[120:123], v[144:159]
    ds_read_b64_tr_b16 v[48:49], v24 offset:45056
    ds_read_b64_tr_b16 v[50:51], v24 offset:46080
    buffer_load_dwordx4 v[116:119], v4, s[32:35], s42 offen offset:1024 sc1
    s_waitcnt lgkmcnt(6)
    v_mfma_f32_32x32x16_bf16 v[176:191], v[36:39], v[120:123], v[176:191]
    ds_read_b64_tr_b16 v[52:53], v25 offset:45056
    ds_read_b64_tr_b16 v[54:55], v25 offset:46080
    s_waitcnt lgkmcnt(6)
    v_mfma_f32_32x32x16_bf16 v[208:223], v[40:43], v[120:123], v[208:223]
    ds_read_b64_tr_b16 v[56:57], v26 offset:45056
    ds_read_b64_tr_b16 v[58:59], v26 offset:46080
    buffer_store_dwordx4 v[200:203], v9, s[32:35], s17 offen sc1
    s_waitcnt lgkmcnt(6)
    v_mfma_f32_32x32x16_bf16 v[240:255], v[44:47], v[120:123], v[240:255]
    ds_read_b64_tr_b16 v[60:61], v27 offset:45056
    ds_read_b64_tr_b16 v[62:63], v27 offset:46080
    s_waitcnt lgkmcnt(6)
    v_mfma_f32_32x32x16_bf16 v[144:159], v[48:51], v[124:127], v[144:159]
    ds_read_b64_tr_b16 v[32:33], v24 offset:49152
    ds_read_b64_tr_b16 v[34:35], v24 offset:50176
    buffer_load_dwordx4 v[120:123], v4, s[32:35], s42 offen offset:2048 sc1
    s_waitcnt lgkmcnt(6)
    v_mfma_f32_32x32x16_bf16 v[176:191], v[52:55], v[124:127], v[176:191]
    ds_read_b64_tr_b16 v[36:37], v25 offset:49152
    ds_read_b64_tr_b16 v[38:39], v25 offset:50176
    s_waitcnt lgkmcnt(6)
    v_mfma_f32_32x32x16_bf16 v[208:223], v[56:59], v[124:127], v[208:223]
    ds_read_b64_tr_b16 v[40:41], v26 offset:49152
    ds_read_b64_tr_b16 v[42:43], v26 offset:50176
    buffer_store_dwordx4 v[204:207], v9, s[32:35], s18 offen sc1
    s_add_u32 s17, s17, s19
    s_add_u32 s18, s18, s19
    s_waitcnt lgkmcnt(6)
    v_mfma_f32_32x32x16_bf16 v[240:255], v[60:63], v[124:127], v[240:255]
    ds_read_b64_tr_b16 v[44:45], v27 offset:49152
    ds_read_b64_tr_b16 v[46:47], v27 offset:50176
    s_waitcnt vmcnt(26) lgkmcnt(6)
    v_mfma_f32_32x32x16_bf16 v[144:159], v[32:35], v[64:67], v[144:159]
    ds_read_b64_tr_b16 v[48:49], v24 offset:53248
    ds_read_b64_tr_b16 v[50:51], v24 offset:54272
    buffer_load_dwordx4 v[124:127], v4, s[32:35], s42 offen offset:3072 sc1
    s_add_u32 s42, s42, 4096
    s_waitcnt lgkmcnt(6)
    v_mfma_f32_32x32x16_bf16 v[176:191], v[36:39], v[64:67], v[176:191]
    ds_read_b64_tr_b16 v[52:53], v25 offset:53248
    ds_read_b64_tr_b16 v[54:55], v25 offset:54272
    s_waitcnt lgkmcnt(6)
    v_mfma_f32_32x32x16_bf16 v[208:223], v[40:43], v[64:67], v[208:223]
    ds_read_b64_tr_b16 v[56:57], v26 offset:53248
    ds_read_b64_tr_b16 v[58:59], v26 offset:54272
    buffer_store_dwordx4 v[224:227], v4, s[32:35], s17 offen sc1
    s_waitcnt lgkmcnt(6)
    v_mfma_f32_32x32x16_bf16 v[240:255], v[44:47], v[64:67], v[240:255]
    ds_read_b64_tr_b16 v[60:61], v27 offset:53248
    ds_read_b64_tr_b16 v[62:63], v27 offset:54272
    s_waitcnt vmcnt(27) lgkmcnt(6)
    v_mfma_f32_32x32x16_bf16 v[144:159], v[48:51], v[68:71], v[144:159]
    ds_read_b64_tr_b16 v[32:33], v24 offset:57344
    ds_read_b64_tr_b16 v[34:35], v24 offset:58368
    buffer_load_dwordx4 v[64:67], v4, s[32:35], s42 offen offset:0 sc1
    s_waitcnt lgkmcnt(6)
    v_mfma_f32_32x32x16_bf16 v[176:191], v[52:55], v[68:71], v[176:191]
    ds_read_b64_tr_b16 v[36:37], v25 offset:57344
    ds_read_b64_tr_b16 v[38:39], v25 offset:58368
    s_waitcnt lgkmcnt(6)
    v_mfma_f32_32x32x16_bf16 v[208:223], v[56:59], v[68:71], v[208:223]
    ds_read_b64_tr_b16 v[40:41], v26 offset:57344
    ds_read_b64_tr_b16 v[42:43], v26 offset:58368
    buffer_store_dwordx4 v[228:231], v4, s[32:35], s18 offen sc1
    s_waitcnt lgkmcnt(6)
    v_mfma_f32_32x32x16_bf16 v[240:255], v[60:63], v[68:71], v[240:255]
    ds_read_b64_tr_b16 v[44:45], v27 offset:57344
    ds_read_b64_tr_b16 v[46:47], v27 offset:58368
    s_waitcnt vmcnt(28) lgkmcnt(6)
    v_mfma_f32_32x32x16_bf16 v[144:159], v[32:35], v[72:75], v[144:159]
    ds_read_b64_tr_b16 v[48:49], v24 offset:61440
    ds_read_b64_tr_b16 v[50:51], v24 offset:62464
    buffer_load_dwordx4 v[68:71], v4, s[32:35], s42 offen offset:1024 sc1
    s_waitcnt lgkmcnt(6)
    v_mfma_f32_32x32x16_bf16 v[176:191], v[36:39], v[72:75], v[176:191]
    ds_read_b64_tr_b16 v[52:53], v25 offset:61440
    ds_read_b64_tr_b16 v[54:55], v25 offset:62464
    s_waitcnt lgkmcnt(6)
    v_mfma_f32_32x32x16_bf16 v[208:223], v[40:43], v[72:75], v[208:223]
    ds_read_b64_tr_b16 v[56:57], v26 offset:61440
    ds_read_b64_tr_b16 v[58:59], v26 offset:62464
    buffer_store_dwordx4 v[232:235], v9, s[32:35], s17 offen sc1
    s_waitcnt lgkmcnt(6)
    v_mfma_f32_32x32x16_bf16 v[240:255], v[44:47], v[72:75], v[240:255]
    ds_read_b64_tr_b16 v[60:61], v27 offset:61440
    ds_read_b64_tr_b16 v[62:63], v27 offset:62464
    s_waitcnt lgkmcnt(0)
    s_waitcnt vmcnt(29)
    v_mfma_f32_32x32x16_bf16 v[144:159], v[48:51], v[76:79], v[144:159]
    s_barrier
    ds_read_b64_tr_b16 v[32:33], v20 offset:0
    ds_read_b64_tr_b16 v[34:35], v20 offset:1024
    buffer_load_dwordx4 v[72:75], v4, s[32:35], s42 offen offset:2048 sc1
    v_mfma_f32_32x32x16_bf16 v[176:191], v[52:55], v[76:79], v[176:191]
    ds_read_b64_tr_b16 v[36:37], v21 offset:0
    ds_read_b64_tr_b16 v[38:39], v21 offset:1024
    v_mfma_f32_32x32x16_bf16 v[208:223], v[56:59], v[76:79], v[208:223]
    ds_read_b64_tr_b16 v[40:41], v22 offset:0
    ds_read_b64_tr_b16 v[42:43], v22 offset:1024
    buffer_store_dwordx4 v[236:239], v9, s[32:35], s18 offen sc1
    s_add_u32 s17, s17, s19
    s_add_u32 s18, s18, s19
    v_mfma_f32_32x32x16_bf16 v[240:255], v[60:63], v[76:79], v[240:255]
    ds_read_b64_tr_b16 v[44:45], v23 offset:0
    ds_read_b64_tr_b16 v[46:47], v23 offset:1024
    s_waitcnt vmcnt(29) lgkmcnt(6)
    v_mfma_f32_32x32x16_bf16 v[144:159], v[32:35], v[80:83], v[144:159]
    ds_read_b64_tr_b16 v[48:49], v20 offset:4096
    ds_read_b64_tr_b16 v[50:51], v20 offset:5120
    buffer_load_dwordx4 v[76:79], v4, s[32:35], s42 offen offset:3072 sc1
    s_add_u32 s42, s42, 4096
    s_waitcnt lgkmcnt(6)
    v_mfma_f32_32x32x16_bf16 v[176:191], v[36:39], v[80:83], v[176:191]
    ds_read_b64_tr_b16 v[52:53], v21 offset:4096
    ds_read_b64_tr_b16 v[54:55], v21 offset:5120
    v_lshrrev_b32 v29, 5, v1
    v_lshlrev_b32 v29, 10, v29
    s_waitcnt lgkmcnt(6)
    v_mfma_f32_32x32x16_bf16 v[208:223], v[40:43], v[80:83], v[208:223]
    ds_read_b64_tr_b16 v[56:57], v22 offset:4096
    ds_read_b64_tr_b16 v[58:59], v22 offset:5120
    v_sub_u32 v24, v24, v29
    v_sub_u32 v25, v25, v29
    v_sub_u32 v26, v26, v29
    v_sub_u32 v27, v27, v29
    s_waitcnt lgkmcnt(6)
    v_mfma_f32_32x32x16_bf16 v[240:255], v[44:47], v[80:83], v[240:255]
    ds_read_b64_tr_b16 v[60:61], v23 offset:4096
    ds_read_b64_tr_b16 v[62:63], v23 offset:5120
    s_waitcnt vmcnt(28) lgkmcnt(6)
    v_mfma_f32_32x32x16_bf16 v[144:159], v[48:51], v[84:87], v[144:159]
    ds_read_b64_tr_b16 v[32:33], v20 offset:8192
    ds_read_b64_tr_b16 v[34:35], v20 offset:9216
    s_waitcnt lgkmcnt(6)
    v_mfma_f32_32x32x16_bf16 v[176:191], v[52:55], v[84:87], v[176:191]
    ds_read_b64_tr_b16 v[36:37], v21 offset:8192
    ds_read_b64_tr_b16 v[38:39], v21 offset:9216
    s_waitcnt lgkmcnt(6)
    v_mfma_f32_32x32x16_bf16 v[208:223], v[56:59], v[84:87], v[208:223]
    ds_read_b64_tr_b16 v[40:41], v22 offset:8192
    ds_read_b64_tr_b16 v[42:43], v22 offset:9216
    s_waitcnt lgkmcnt(6)
    v_mfma_f32_32x32x16_bf16 v[240:255], v[60:63], v[84:87], v[240:255]
    ds_read_b64_tr_b16 v[44:45], v23 offset:8192
    ds_read_b64_tr_b16 v[46:47], v23 offset:9216
    s_waitcnt vmcnt(26) lgkmcnt(6)
    v_mfma_f32_32x32x16_bf16 v[144:159], v[32:35], v[88:91], v[144:159]
    ds_read_b64_tr_b16 v[48:49], v20 offset:12288
    ds_read_b64_tr_b16 v[50:51], v20 offset:13312
    s_waitcnt lgkmcnt(6)
    v_mfma_f32_32x32x16_bf16 v[176:191], v[36:39], v[88:91], v[176:191]
    ds_read_b64_tr_b16 v[52:53], v21 offset:12288
    ds_read_b64_tr_b16 v[54:55], v21 offset:13312
    s_waitcnt lgkmcnt(6)
    v_mfma_f32_32x32x16_bf16 v[208:223], v[40:43], v[88:91], v[208:223]
    ds_read_b64_tr_b16 v[56:57], v22 offset:12288
    ds_read_b64_tr_b16 v[58:59], v22 offset:13312
    s_waitcnt lgkmcnt(6)
    v_mfma_f32_32x32x16_bf16 v[240:255], v[44:47], v[88:91], v[240:255]
    ds_read_b64_tr_b16 v[60:61], v23 offset:12288
    ds_read_b64_tr_b16 v[62:63], v23 offset:13312
    s_waitcnt vmcnt(24) lgkmcnt(6)
    v_mfma_f32_32x32x16_bf16 v[144:159], v[48:51], v[92:95], v[144:159]
    ds_read_b64_tr_b16 v[32:33], v20 offset:16384
    ds_read_b64_tr_b16 v[34:35], v20 offset:17408
    s_waitcnt lgkmcnt(6)
    v_mfma_f32_32x32x16_bf16 v[176:191], v[52:55], v[92:95], v[176:191]
    ds_read_b64_tr_b16 v[36:37], v21 offset:16384
    ds_read_b64_tr_b16 v[38:39], v21 offset:17408
    s_waitcnt lgkmcnt(6)
    v_mfma_f32_32x32x16_bf16 v[208:223], v[56:59], v[92:95], v[208:223]
    ds_read_b64_tr_b16 v[40:41], v22 offset:16384
    ds_read_b64_tr_b16 v[42:43], v22 offset:17408
    s_waitcnt lgkmcnt(6)
    v_mfma_f32_32x32x16_bf16 v[240:255], v[60:63], v[92:95], v[240:255]
    ds_read_b64_tr_b16 v[44:45], v23 offset:16384
    ds_read_b64_tr_b16 v[46:47], v23 offset:17408
    s_waitcnt vmcnt(22) lgkmcnt(6)
    v_mfma_f32_32x32x16_bf16 v[144:159], v[32:35], v[96:99], v[144:159]
    ds_read_b64_tr_b16 v[48:49], v20 offset:20480
    ds_read_b64_tr_b16 v[50:51], v20 offset:21504
    s_waitcnt lgkmcnt(6)
    v_mfma_f32_32x32x16_bf16 v[176:191], v[36:39], v[96:99], v[176:191]
    ds_read_b64_tr_b16 v[52:53], v21 offset:20480
    ds_read_b64_tr_b16 v[54:55], v21 offset:21504
    s_waitcnt lgkmcnt(6)
    v_mfma_f32_32x32x16_bf16 v[208:223], v[40:43], v[96:99], v[208:223]
    ds_read_b64_tr_b16 v[56:57], v22 offset:20480
    ds_read_b64_tr_b16 v[58:59], v22 offset:21504
    s_waitcnt lgkmcnt(6)
    v_mfma_f32_32x32x16_bf16 v[240:255], v[44:47], v[96:99], v[240:255]
    ds_read_b64_tr_b16 v[60:61], v23 offset:20480
    ds_read_b64_tr_b16 v[62:63], v23 offset:21504
    s_waitcnt vmcnt(20) lgkmcnt(6)
    v_mfma_f32_32x32x16_bf16 v[144:159], v[48:51], v[100:103], v[144:159]
    ds_read_b64_tr_b16 v[32:33], v20 offset:24576
    ds_read_b64_tr_b16 v[34:35], v20 offset:25600
    s_waitcnt lgkmcnt(6)
    v_mfma_f32_32x32x16_bf16 v[176:191], v[52:55], v[100:103], v[176:191]
    ds_read_b64_tr_b16 v[36:37], v21 offset:24576
    ds_read_b64_tr_b16 v[38:39], v21 offset:25600
    s_waitcnt lgkmcnt(6)
    v_mfma_f32_32x32x16_bf16 v[208:223], v[56:59], v[100:103], v[208:223]
    ds_read_b64_tr_b16 v[40:41], v22 offset:24576
    ds_read_b64_tr_b16 v[42:43], v22 offset:25600
    s_waitcnt lgkmcnt(6)
    v_mfma_f32_32x32x16_bf16 v[240:255], v[60:63], v[100:103], v[240:255]
    ds_read_b64_tr_b16 v[44:45], v23 offset:24576
    ds_read_b64_tr_b16 v[46:47], v23 offset:25600
    s_waitcnt vmcnt(18) lgkmcnt(6)
    v_mfma_f32_32x32x16_bf16 v[144:159], v[32:35], v[104:107], v[144:159]
    ds_read_b64_tr_b16 v[48:49], v20 offset:28672
    ds_read_b64_tr_b16 v[50:51], v20 offset:29696
    s_waitcnt lgkmcnt(6)
    v_mfma_f32_32x32x16_bf16 v[176:191], v[36:39], v[104:107], v[176:191]
    ds_read_b64_tr_b16 v[52:53], v21 offset:28672
    ds_read_b64_tr_b16 v[54:55], v21 offset:29696
    s_waitcnt lgkmcnt(6)
    v_mfma_f32_32x32x16_bf16 v[208:223], v[40:43], v[104:107], v[208:223]
    ds_read_b64_tr_b16 v[56:57], v22 offset:28672
    ds_read_b64_tr_b16 v[58:59], v22 offset:29696
    s_waitcnt lgkmcnt(6)
    v_mfma_f32_32x32x16_bf16 v[240:255], v[44:47], v[104:107], v[240:255]
    ds_read_b64_tr_b16 v[60:61], v23 offset:28672
    ds_read_b64_tr_b16 v[62:63], v23 offset:29696
    s_waitcnt lgkmcnt(0)
    s_waitcnt vmcnt(16)
    v_mfma_f32_32x32x16_bf16 v[144:159], v[48:51], v[108:111], v[144:159]
    s_waitcnt vmcnt(1)
    s_barrier
    ds_read_b64_tr_b16 v[32:33], v20 offset:32768
    ds_read_b64_tr_b16 v[34:35], v20 offset:33792
    v_mov_b32 v19, 1
    buffer_store_dword v19, v28, s[32:35], s16 offen sc1
    v_mfma_f32_32x32x16_bf16 v[176:191], v[52:55], v[108:111], v[176:191]
    ds_read_b64_tr_b16 v[36:37], v21 offset:32768
    ds_read_b64_tr_b16 v[38:39], v21 offset:33792
    v_mfma_f32_32x32x16_bf16 v[208:223], v[56:59], v[108:111], v[208:223]
    ds_read_b64_tr_b16 v[40:41], v22 offset:32768
    ds_read_b64_tr_b16 v[42:43], v22 offset:33792
    v_mfma_f32_32x32x16_bf16 v[240:255], v[60:63], v[108:111], v[240:255]
    ds_read_b64_tr_b16 v[44:45], v23 offset:32768
    ds_read_b64_tr_b16 v[46:47], v23 offset:33792
    s_waitcnt lgkmcnt(6)
    v_mfma_f32_32x32x16_bf16 v[144:159], v[32:35], v[112:115], v[144:159]
    ds_read_b64_tr_b16 v[48:49], v20 offset:36864
    ds_read_b64_tr_b16 v[50:51], v20 offset:37888
    s_waitcnt lgkmcnt(6)
    v_mfma_f32_32x32x16_bf16 v[176:191], v[36:39], v[112:115], v[176:191]
    ds_read_b64_tr_b16 v[52:53], v21 offset:36864
    ds_read_b64_tr_b16 v[54:55], v21 offset:37888
    s_waitcnt lgkmcnt(6)
    v_mfma_f32_32x32x16_bf16 v[208:223], v[40:43], v[112:115], v[208:223]
    ds_read_b64_tr_b16 v[56:57], v22 offset:36864
    ds_read_b64_tr_b16 v[58:59], v22 offset:37888
    s_waitcnt lgkmcnt(6)
    v_mfma_f32_32x32x16_bf16 v[240:255], v[44:47], v[112:115], v[240:255]
    ds_read_b64_tr_b16 v[60:61], v23 offset:36864
    ds_read_b64_tr_b16 v[62:63], v23 offset:37888
    s_waitcnt lgkmcnt(6)
    v_mfma_f32_32x32x16_bf16 v[144:159], v[48:51], v[116:119], v[144:159]
    ds_read_b64_tr_b16 v[32:33], v20 offset:40960
    ds_read_b64_tr_b16 v[34:35], v20 offset:41984
    s_waitcnt lgkmcnt(6)
    v_mfma_f32_32x32x16_bf16 v[176:191], v[52:55], v[116:119], v[176:191]
    ds_read_b64_tr_b16 v[36:37], v21 offset:40960
    ds_read_b64_tr_b16 v[38:39], v21 offset:41984
    s_waitcnt lgkmcnt(6)
    v_mfma_f32_32x32x16_bf16 v[208:223], v[56:59], v[116:119], v[208:223]
    ds_read_b64_tr_b16 v[40:41], v22 offset:40960
    ds_read_b64_tr_b16 v[42:43], v22 offset:41984
    s_waitcnt lgkmcnt(6)
    v_mfma_f32_32x32x16_bf16 v[240:255], v[60:63], v[116:119], v[240:255]
    ds_read_b64_tr_b16 v[44:45], v23 offset:40960
    ds_read_b64_tr_b16 v[46:47], v23 offset:41984
    s_waitcnt lgkmcnt(6)
    v_mfma_f32_32x32x16_bf16 v[144:159], v[32:35], v[120:123], v[144:159]
    ds_read_b64_tr_b16 v[48:49], v20 offset:45056
    ds_read_b64_tr_b16 v[50:51], v20 offset:46080
    s_waitcnt lgkmcnt(6)
    v_mfma_f32_32x32x16_bf16 v[176:191], v[36:39], v[120:123], v[176:191]
    ds_read_b64_tr_b16 v[52:53], v21 offset:45056
    ds_read_b64_tr_b16 v[54:55], v21 offset:46080
    s_waitcnt lgkmcnt(6)
    v_mfma_f32_32x32x16_bf16 v[208:223], v[40:43], v[120:123], v[208:223]
    ds_read_b64_tr_b16 v[56:57], v22 offset:45056
    ds_read_b64_tr_b16 v[58:59], v22 offset:46080
    s_waitcnt lgkmcnt(6)
    v_mfma_f32_32x32x16_bf16 v[240:255], v[44:47], v[120:123], v[240:255]
    ds_read_b64_tr_b16 v[60:61], v23 offset:45056
    ds_read_b64_tr_b16 v[62:63], v23 offset:46080
    s_waitcnt lgkmcnt(6)
    v_mfma_f32_32x32x16_bf16 v[144:159], v[48:51], v[124:127], v[144:159]
    ds_read_b64_tr_b16 v[32:33], v20 offset:49152
    ds_read_b64_tr_b16 v[34:35], v20 offset:50176
    s_waitcnt lgkmcnt(6)
    v_mfma_f32_32x32x16_bf16 v[176:191], v[52:55], v[124:127], v[176:191]
    ds_read_b64_tr_b16 v[36:37], v21 offset:49152
    ds_read_b64_tr_b16 v[38:39], v21 offset:50176
    s_waitcnt lgkmcnt(6)
    v_mfma_f32_32x32x16_bf16 v[208:223], v[56:59], v[124:127], v[208:223]
    ds_read_b64_tr_b16 v[40:41], v22 offset:49152
    ds_read_b64_tr_b16 v[42:43], v22 offset:50176
    s_waitcnt lgkmcnt(6)
    v_mfma_f32_32x32x16_bf16 v[240:255], v[60:63], v[124:127], v[240:255]
    ds_read_b64_tr_b16 v[44:45], v23 offset:49152
    ds_read_b64_tr_b16 v[46:47], v23 offset:50176
    s_waitcnt lgkmcnt(6)
    v_mfma_f32_32x32x16_bf16 v[144:159], v[32:35], v[64:67], v[144:159]
    ds_read_b64_tr_b16 v[48:49], v20 offset:53248
    ds_read_b64_tr_b16 v[50:51], v20 offset:54272
    buffer_load_dword v13, v18, s[32:35], s16 offen sc1
    s_waitcnt lgkmcnt(6)
    v_mfma_f32_32x32x16_bf16 v[176:191], v[36:39], v[64:67], v[176:191]
    ds_read_b64_tr_b16 v[52:53], v21 offset:53248
    ds_read_b64_tr_b16 v[54:55], v21 offset:54272
    s_waitcnt lgkmcnt(6)
    v_mfma_f32_32x32x16_bf16 v[208:223], v[40:43], v[64:67], v[208:223]
    ds_read_b64_tr_b16 v[56:57], v22 offset:53248
    ds_read_b64_tr_b16 v[58:59], v22 offset:54272
    s_waitcnt lgkmcnt(6)
    v_mfma_f32_32x32x16_bf16 v[240:255], v[44:47], v[64:67], v[240:255]
    ds_read_b64_tr_b16 v[60:61], v23 offset:53248
    ds_read_b64_tr_b16 v[62:63], v23 offset:54272
    s_waitcnt lgkmcnt(6)
    v_mfma_f32_32x32x16_bf16 v[144:159], v[48:51], v[68:71], v[144:159]
    ds_read_b64_tr_b16 v[32:33], v20 offset:57344
    ds_read_b64_tr_b16 v[34:35], v20 offset:58368
    s_waitcnt lgkmcnt(6)
    v_mfma_f32_32x32x16_bf16 v[176:191], v[52:55], v[68:71], v[176:191]
    ds_read_b64_tr_b16 v[36:37], v21 offset:57344
    ds_read_b64_tr_b16 v[38:39], v21 offset:58368
    s_waitcnt lgkmcnt(6)
    v_mfma_f32_32x32x16_bf16 v[208:223], v[56:59], v[68:71], v[208:223]
    ds_read_b64_tr_b16 v[40:41], v22 offset:57344
    ds_read_b64_tr_b16 v[42:43], v22 offset:58368
    s_waitcnt lgkmcnt(6)
    v_mfma_f32_32x32x16_bf16 v[240:255], v[60:63], v[68:71], v[240:255]
    ds_read_b64_tr_b16 v[44:45], v23 offset:57344
    ds_read_b64_tr_b16 v[46:47], v23 offset:58368
    s_waitcnt lgkmcnt(6)
    v_mfma_f32_32x32x16_bf16 v[144:159], v[32:35], v[72:75], v[144:159]
    ds_read_b64_tr_b16 v[48:49], v20 offset:61440
    ds_read_b64_tr_b16 v[50:51], v20 offset:62464
    s_waitcnt lgkmcnt(6)
    v_mfma_f32_32x32x16_bf16 v[176:191], v[36:39], v[72:75], v[176:191]
    ds_read_b64_tr_b16 v[52:53], v21 offset:61440
    ds_read_b64_tr_b16 v[54:55], v21 offset:62464
    s_waitcnt lgkmcnt(6)
    v_mfma_f32_32x32x16_bf16 v[208:223], v[40:43], v[72:75], v[208:223]
    ds_read_b64_tr_b16 v[56:57], v22 offset:61440
    ds_read_b64_tr_b16 v[58:59], v22 offset:62464
    s_waitcnt lgkmcnt(6)
    v_mfma_f32_32x32x16_bf16 v[240:255], v[44:47], v[72:75], v[240:255]
    ds_read_b64_tr_b16 v[60:61], v23 offset:61440
    ds_read_b64_tr_b16 v[62:63], v23 offset:62464
    s_waitcnt vmcnt(2) lgkmcnt(6)
    v_mfma_f32_32x32x16_bf16 v[144:159], v[48:51], v[76:79], v[144:159]
    s_waitcnt lgkmcnt(4)
    v_mfma_f32_32x32x16_bf16 v[176:191], v[52:55], v[76:79], v[176:191]
    s_waitcnt lgkmcnt(2)
    v_mfma_f32_32x32x16_bf16 v[208:223], v[56:59], v[76:79], v[208:223]
    s_waitcnt lgkmcnt(0)
    v_mfma_f32_32x32x16_bf16 v[240:255], v[60:63], v[76:79], v[240:255]
    s_waitcnt vmcnt(0)
    v_and_b32 v13, v13, v12
    v_cmp_ne_u32 vcc, v13, v12
    s_cbranch_vccnz spin_12
spb_13:
    s_mov_b32 s48, 1040356334
    s_nop 0
    v_mul_f32 v144, s48, v144
    v_mul_f32 v145, s48, v145
    v_mul_f32 v146, s48, v146
    v_mul_f32 v147, s48, v147
    v_mul_f32 v148, s48, v148
    v_mul_f32 v149, s48, v149
    v_mul_f32 v150, s48, v150
    v_mul_f32 v151, s48, v151
    v_mul_f32 v152, s48, v152
    v_mul_f32 v153, s48, v153
    v_mul_f32 v154, s48, v154
    v_mul_f32 v155, s48, v155
    v_mul_f32 v156, s48, v156
    v_mul_f32 v157, s48, v157
    v_mul_f32 v158, s48, v158
    v_mul_f32 v159, s48, v159
    v_cvt_pk_bf16_f32 v80, v144, v145
    v_cvt_pk_bf16_f32 v81, v146, v147
    v_cvt_pk_bf16_f32 v82, v148, v149
    v_cvt_pk_bf16_f32 v83, v150, v151
    v_cvt_pk_bf16_f32 v84, v152, v153
    v_cvt_pk_bf16_f32 v85, v154, v155
    v_cvt_pk_bf16_f32 v86, v156, v157
    v_cvt_pk_bf16_f32 v87, v158, v159
    v_mul_f32 v176, s48, v176
    v_mul_f32 v177, s48, v177
    v_mul_f32 v178, s48, v178
    v_mul_f32 v179, s48, v179
    v_mul_f32 v180, s48, v180
    v_mul_f32 v181, s48, v181
    v_mul_f32 v182, s48, v182
    v_mul_f32 v183, s48, v183
    v_mul_f32 v184, s48, v184
    v_mul_f32 v185, s48, v185
    v_mul_f32 v186, s48, v186
    v_mul_f32 v187, s48, v187
    v_mul_f32 v188, s48, v188
    v_mul_f32 v189, s48, v189
    v_mul_f32 v190, s48, v190
    v_mul_f32 v191, s48, v191
    v_cvt_pk_bf16_f32 v88, v176, v177
    v_cvt_pk_bf16_f32 v89, v178, v179
    v_cvt_pk_bf16_f32 v90, v180, v181
    v_cvt_pk_bf16_f32 v91, v182, v183
    v_cvt_pk_bf16_f32 v92, v184, v185
    v_cvt_pk_bf16_f32 v93, v186, v187
    v_cvt_pk_bf16_f32 v94, v188, v189
    v_cvt_pk_bf16_f32 v95, v190, v191
    v_mul_f32 v208, s48, v208
    v_mul_f32 v209, s48, v209
    v_mul_f32 v210, s48, v210
    v_mul_f32 v211, s48, v211
    v_mul_f32 v212, s48, v212
    v_mul_f32 v213, s48, v213
    v_mul_f32 v214, s48, v214
    v_mul_f32 v215, s48, v215
    v_mul_f32 v216, s48, v216
    v_mul_f32 v217, s48, v217
    v_mul_f32 v218, s48, v218
    v_mul_f32 v219, s48, v219
    v_mul_f32 v220, s48, v220
    v_mul_f32 v221, s48, v221
    v_mul_f32 v222, s48, v222
    v_mul_f32 v223, s48, v223
    v_cvt_pk_bf16_f32 v96, v208, v209
    v_cvt_pk_bf16_f32 v97, v210, v211
    v_cvt_pk_bf16_f32 v98, v212, v213
    v_cvt_pk_bf16_f32 v99, v214, v215
    v_cvt_pk_bf16_f32 v100, v216, v217
    v_cvt_pk_bf16_f32 v101, v218, v219
    v_cvt_pk_bf16_f32 v102, v220, v221
    v_cvt_pk_bf16_f32 v103, v222, v223
    v_mul_f32 v240, s48, v240
    v_mul_f32 v241, s48, v241
    v_mul_f32 v242, s48, v242
    v_mul_f32 v243, s48, v243
    v_mul_f32 v244, s48, v244
    v_mul_f32 v245, s48, v245
    v_mul_f32 v246, s48, v246
    v_mul_f32 v247, s48, v247
    v_mul_f32 v248, s48, v248
    v_mul_f32 v249, s48, v249
    v_mul_f32 v250, s48, v250
    v_mul_f32 v251, s48, v251
    v_mul_f32 v252, s48, v252
    v_mul_f32 v253, s48, v253
    v_mul_f32 v254, s48, v254
    v_mul_f32 v255, s48, v255
    v_cvt_pk_bf16_f32 v104, v240, v241
    v_cvt_pk_bf16_f32 v105, v242, v243
    v_cvt_pk_bf16_f32 v106, v244, v245
    v_cvt_pk_bf16_f32 v107, v246, v247
    v_cvt_pk_bf16_f32 v108, v248, v249
    v_cvt_pk_bf16_f32 v109, v250, v251
    v_cvt_pk_bf16_f32 v110, v252, v253
    v_cvt_pk_bf16_f32 v111, v254, v255
    s_branch kq_9
kv_8:
    s_waitcnt lgkmcnt(7)
    v_mfma_f32_32x32x16_bf16 v[128:143], v[32:35], v[40:43], 0
    ds_read_b128 v[56:59], v15 offset:32768
    ds_read_b64_tr_b16 v[64:65], v20 offset:4096
    s_add_u32 m0, s60, 65536
    s_add_u32 s62, s100, 128
    s_and_b32 s62, s62, 1023
    buffer_load_dwordx4 v10, s[20:23], s62 offen lds
    s_waitcnt vmcnt(4)
    v_lshlrev_b32 v96, 16, v88
    v_and_b32 v97, 0xffff0000, v88
    v_lshlrev_b32 v98, 16, v89
    v_and_b32 v99, 0xffff0000, v89
    v_lshlrev_b32 v100, 16, v90
    v_and_b32 v101, 0xffff0000, v90
    v_lshlrev_b32 v102, 16, v91
    v_and_b32 v103, 0xffff0000, v91
    v_add_f32 v104, v96, v97
    s_waitcnt lgkmcnt(8)
    v_mfma_f32_32x32x16_bf16 v[144:159], v[36:39], v[40:43], 0
    ds_read_b64_tr_b16 v[66:67], v20 offset:5120
    ds_read_b128 v[60:63], v15 offset:36864
    s_add_u32 m0, s60, 66560
    s_add_u32 s62, s100, 128
    s_and_b32 s62, s62, 1023
    buffer_load_dwordx4 v13, s[20:23], s62 offen lds
    v_add_f32 v104, v104, v98
    v_add_f32 v104, v104, v99
    v_add_f32 v104, v104, v100
    v_add_f32 v104, v104, v101
    v_add_f32 v104, v104, v102
    v_add_f32 v104, v104, v103
    s_nop 1
    v_add_f32_dpp v104, v104, v104 quad_perm:[1,0,3,2] row_mask:0xf bank_mask:0xf
    s_nop 1
    v_add_f32_dpp v104, v104, v104 quad_perm:[2,3,0,1] row_mask:0xf bank_mask:0xf
    s_nop 1
    v_add_f32_dpp v104, v104, v104 row_half_mirror row_mask:0xf bank_mask:0xf
    s_waitcnt lgkmcnt(8)
    v_mfma_f32_32x32x16_bf16 v[160:175], v[32:35], v[44:47], 0
    ds_read_b64_tr_b16 v[68:69], v21 offset:4096
    ds_read_b64_tr_b16 v[70:71], v21 offset:5120
    s_add_u32 m0, s60, 67584
    s_add_u32 s62, s100, 128
    s_and_b32 s62, s62, 1023
    s_add_u32 s62, s62, 16384
    buffer_load_dwordx4 v10, s[20:23], s62 offen lds
    v_add_f32_dpp v104, v104, v104 row_mirror row_mask:0xf bank_mask:0xf
    s_nop 0
    v_readlane_b32 s68, v104, 0
    v_readlane_b32 s69, v104, 16
    v_readlane_b32 s70, v104, 32
    v_readlane_b32 s71, v104, 48
    v_mov_b32 v104, s68
    v_add_f32 v104, s69, v104
    v_add_f32 v104, s70, v104
    v_add_f32 v104, s71, v104
    s_add_u32 m0, s60, 68608
    s_add_u32 s62, s100, 128
    s_and_b32 s62, s62, 1023
    s_add_u32 s62, s62, 16384
    buffer_load_dwordx4 v13, s[20:23], s62 offen lds
    v_mfma_f32_32x32x16_bf16 v[176:191], v[36:39], v[44:47], 0
    ds_read_b64_tr_b16 v[72:73], v22 offset:4096
    ds_read_b64_tr_b16 v[74:75], v22 offset:5120
    v_mul_f32 v104, 0x3b000000, v104
    v_sub_f32 v96, v96, v104
    v_sub_f32 v97, v97, v104
    v_sub_f32 v98, v98, v104
    v_sub_f32 v99, v99, v104
    v_sub_f32 v100, v100, v104
    v_sub_f32 v101, v101, v104
    v_sub_f32 v102, v102, v104
    v_sub_f32 v103, v103, v104
    s_add_u32 m0, s61, 131072
    s_add_u32 s62, s101, 524288
    s_and_b32 s62, s62, 0x3fffff
    buffer_load_dwordx4 v11, s[24:27], s62 offen lds
    s_waitcnt lgkmcnt(10)
    v_mfma_f32_32x32x16_bf16 v[192:207], v[32:35], v[48:51], 0
    ds_read_b64_tr_b16 v[76:77], v23 offset:4096
    ds_read_b64_tr_b16 v[78:79], v23 offset:5120
    v_mul_f32 v105, v96, v96
    v_fmac_f32 v105, v97, v97
    v_fmac_f32 v105, v98, v98
    v_fmac_f32 v105, v99, v99
    v_fmac_f32 v105, v100, v100
    v_fmac_f32 v105, v101, v101
    v_fmac_f32 v105, v102, v102
    v_fmac_f32 v105, v103, v103
    s_nop 1
    v_add_f32_dpp v105, v105, v105 quad_perm:[1,0,3,2] row_mask:0xf bank_mask:0xf
    s_add_u32 m0, s61, 139264
    s_add_u32 s62, s101, 524288
    s_and_b32 s62, s62, 0x3fffff
    buffer_load_dwordx4 v11, s[28:31], s62 offen lds
    v_mfma_f32_32x32x16_bf16 v[208:223], v[36:39], v[48:51], 0
    v_add_f32_dpp v105, v105, v105 quad_perm:[2,3,0,1] row_mask:0xf bank_mask:0xf
    s_nop 1
    v_add_f32_dpp v105, v105, v105 row_half_mirror row_mask:0xf bank_mask:0xf
    s_nop 1
    v_add_f32_dpp v105, v105, v105 row_mirror row_mask:0xf bank_mask:0xf
    s_nop 0
    v_readlane_b32 s68, v105, 0
    v_readlane_b32 s69, v105, 16
    v_readlane_b32 s70, v105, 32
    v_readlane_b32 s71, v105, 48
    v_mov_b32 v105, s68
    v_add_f32 v105, s69, v105
    s_add_u32 m0, s61, 147456
    s_add_u32 s62, s101, 786432
    s_and_b32 s62, s62, 0x3fffff
    buffer_load_dwordx4 v11, s[24:27], s62 offen lds
    v_add_f32 v105, s70, v105
    v_add_f32 v105, s71, v105
    v_mov_b32 v106, 0x3727c5ac
    v_fmac_f32 v106, 0x3b000000, v105
    v_rsq_f32 v106, v106
    v_lshlrev_b32 v104, 7, v1
    s_lshl_b32 s48, s44, 4
    v_add_u32 v104, s48, v104
    v_mul_f32 v96, v96, v106
    s_waitcnt lgkmcnt(10)
    v_mfma_f32_32x32x16_bf16 v[224:239], v[32:35], v[52:55], 0
    s_add_u32 m0, s61, 155648
    s_add_u32 s62, s101, 786432
    s_and_b32 s62, s62, 0x3fffff
    buffer_load_dwordx4 v11, s[28:31], s62 offen lds
    v_mul_f32 v97, v97, v106
    v_mul_f32 v98, v98, v106
    v_mul_f32 v99, v99, v106
    v_mul_f32 v100, v100, v106
    v_mul_f32 v101, v101, v106
    v_mul_f32 v102, v102, v106
    v_mul_f32 v103, v103, v106
    v_cvt_pk_bf16_f32 v88, v96, v97
    v_cvt_pk_bf16_f32 v89, v98, v99
    v_mfma_f32_32x32x16_bf16 v[240:255], v[36:39], v[52:55], 0
    buffer_load_dword v127, v7, s[72:75], s64 offen
    v_cvt_pk_bf16_f32 v90, v100, v101
    v_cvt_pk_bf16_f32 v91, v102, v103
    ds_write_b128 v104, v[88:91]
    v_mov_b32 v124, 0
    buffer_store_dword v124, v28, s[32:35], s16 offen sc1
    s_waitcnt lgkmcnt(0)
    v_mfma_f32_32x32x16_bf16 v[128:143], v[56:59], v[64:67], v[128:143]
    v_mfma_f32_32x32x16_bf16 v[144:159], v[60:63], v[64:67], v[144:159]
    s_waitcnt vmcnt(10)
    s_barrier
    ds_read_b128 v[32:35], v16 offset:32768
    v_add_u32 v104, s61, v4
    ds_read_b128 v[88:91], v104
    v_lshlrev_b32 v105, 9, v82
    v_and_b32 v106, 7, v1
    v_lshlrev_b32 v106, 4, v106
    v_add_u32 v105, v105, v106
    v_mfma_f32_32x32x16_bf16 v[160:175], v[56:59], v[68:71], v[160:175]
    ds_read_b64_tr_b16 v[40:41], v20 offset:16384
    ds_read_b64_tr_b16 v[42:43], v20 offset:17408
    v_mfma_f32_32x32x16_bf16 v[176:191], v[60:63], v[68:71], v[176:191]
    ds_read_b128 v[36:39], v16 offset:36864
    ds_read_b64_tr_b16 v[44:45], v21 offset:16384
    v_mfma_f32_32x32x16_bf16 v[192:207], v[56:59], v[72:75], v[192:207]
    ds_read_b64_tr_b16 v[46:47], v21 offset:17408
    s_add_u32 m0, s61, 98304
    s_add_u32 s62, s101, 1048576
    s_and_b32 s62, s62, 0x3fffff
    buffer_load_dwordx4 v11, s[24:27], s62 offen lds
    v_mfma_f32_32x32x16_bf16 v[208:223], v[60:63], v[72:75], v[208:223]
    ds_read_b64_tr_b16 v[48:49], v22 offset:16384
    ds_read_b64_tr_b16 v[50:51], v22 offset:17408
    v_mfma_f32_32x32x16_bf16 v[224:239], v[56:59], v[76:79], v[224:239]
    s_add_u32 m0, s61, 106496
    s_add_u32 s62, s101, 1048576
    s_and_b32 s62, s62, 0x3fffff
    buffer_load_dwordx4 v11, s[28:31], s62 offen lds
    ds_read_b64_tr_b16 v[52:53], v23 offset:16384
    v_mfma_f32_32x32x16_bf16 v[240:255], v[60:63], v[76:79], v[240:255]
    ds_read_b64_tr_b16 v[54:55], v23 offset:17408
    s_waitcnt lgkmcnt(7)
    v_mfma_f32_32x32x16_bf16 v[128:143], v[32:35], v[40:43], v[128:143]
    ds_read_b128 v[56:59], v17 offset:32768
    ds_read_b64_tr_b16 v[64:65], v20 offset:20480
    s_waitcnt lgkmcnt(8)
    v_mfma_f32_32x32x16_bf16 v[144:159], v[36:39], v[40:43], v[144:159]
    ds_read_b64_tr_b16 v[66:67], v20 offset:21504
    ds_read_b128 v[60:63], v17 offset:36864
    s_waitcnt lgkmcnt(8)
    v_mfma_f32_32x32x16_bf16 v[160:175], v[32:35], v[44:47], v[160:175]
    ds_read_b64_tr_b16 v[68:69], v21 offset:20480
    ds_read_b64_tr_b16 v[70:71], v21 offset:21504
    v_mfma_f32_32x32x16_bf16 v[176:191], v[36:39], v[44:47], v[176:191]
    ds_read_b64_tr_b16 v[72:73], v22 offset:20480
    ds_read_b64_tr_b16 v[74:75], v22 offset:21504
    s_waitcnt lgkmcnt(10)
    v_mfma_f32_32x32x16_bf16 v[192:207], v[32:35], v[48:51], v[192:207]
    ds_read_b64_tr_b16 v[76:77], v23 offset:20480
    ds_read_b64_tr_b16 v[78:79], v23 offset:21504
    v_mfma_f32_32x32x16_bf16 v[208:223], v[36:39], v[48:51], v[208:223]
    s_waitcnt lgkmcnt(10)
    v_mfma_f32_32x32x16_bf16 v[224:239], v[32:35], v[52:55], v[224:239]
    v_mfma_f32_32x32x16_bf16 v[240:255], v[36:39], v[52:55], v[240:255]
    buffer_store_dwordx4 v[88:91], v105, s[32:35], s66 offen sc1
    s_waitcnt lgkmcnt(0)
    v_mfma_f32_32x32x16_bf16 v[128:143], v[56:59], v[64:67], v[128:143]
    v_mfma_f32_32x32x16_bf16 v[144:159], v[60:63], v[64:67], v[144:159]
    s_waitcnt vmcnt(7)
    s_barrier
    ds_read_b128 v[32:35], v24 offset:0
    buffer_load_dword v125, v7, s[72:75], s65 offen
    ds_read_b64_tr_b16 v[40:41], v20 offset:32768
    v_mfma_f32_32x32x16_bf16 v[160:175], v[56:59], v[68:71], v[160:175]
    ds_read_b64_tr_b16 v[42:43], v20 offset:33792
    ds_read_b128 v[36:39], v24 offset:4096
    ds_read_b64_tr_b16 v[44:45], v21 offset:32768
    v_mfma_f32_32x32x16_bf16 v[176:191], v[60:63], v[68:71], v[176:191]
    ds_read_b64_tr_b16 v[46:47], v21 offset:33792
    s_add_u32 m0, s60, 0
    s_add_u32 s62, s100, 256
    s_and_b32 s62, s62, 1023
    buffer_load_dwordx4 v10, s[20:23], s62 offen lds
    s_add_u32 m0, s60, 1024
    s_add_u32 s62, s100, 256
    s_and_b32 s62, s62, 1023
    buffer_load_dwordx4 v13, s[20:23], s62 offen lds
    v_mfma_f32_32x32x16_bf16 v[192:207], v[56:59], v[72:75], v[192:207]
    ds_read_b64_tr_b16 v[48:49], v22 offset:32768
    s_add_u32 m0, s60, 2048
    s_add_u32 s62, s100, 256
    s_and_b32 s62, s62, 1023
    s_add_u32 s62, s62, 16384
    buffer_load_dwordx4 v10, s[20:23], s62 offen lds
    v_mfma_f32_32x32x16_bf16 v[208:223], v[60:63], v[72:75], v[208:223]
    s_add_u32 m0, s60, 3072
    s_add_u32 s62, s100, 256
    s_and_b32 s62, s62, 1023
    s_add_u32 s62, s62, 16384
    buffer_load_dwordx4 v13, s[20:23], s62 offen lds
    ds_read_b64_tr_b16 v[50:51], v22 offset:33792
    s_add_u32 m0, s61, 114688
    s_add_u32 s62, s101, 1310720
    s_and_b32 s62, s62, 0x3fffff
    buffer_load_dwordx4 v11, s[24:27], s62 offen lds
    v_mfma_f32_32x32x16_bf16 v[224:239], v[56:59], v[76:79], v[224:239]
    ds_read_b64_tr_b16 v[52:53], v23 offset:32768
    s_add_u32 m0, s61, 122880
    s_add_u32 s62, s101, 1310720
    s_and_b32 s62, s62, 0x3fffff
    buffer_load_dwordx4 v11, s[28:31], s62 offen lds
    s_add_u32 m0, s60, 32768
    s_add_u32 s62, s100, 384
    s_and_b32 s62, s62, 1023
    buffer_load_dwordx4 v10, s[20:23], s62 offen lds
    v_mfma_f32_32x32x16_bf16 v[240:255], v[60:63], v[76:79], v[240:255]
    ds_read_b64_tr_b16 v[54:55], v23 offset:33792
    s_add_u32 m0, s60, 33792
    s_add_u32 s62, s100, 384
    s_and_b32 s62, s62, 1023
    buffer_load_dwordx4 v13, s[20:23], s62 offen lds
    s_waitcnt lgkmcnt(7)
    v_mfma_f32_32x32x16_bf16 v[128:143], v[32:35], v[40:43], v[128:143]
    ds_read_b128 v[56:59], v25 offset:0
    ds_read_b64_tr_b16 v[64:65], v20 offset:36864
    s_waitcnt lgkmcnt(8)
    v_mfma_f32_32x32x16_bf16 v[144:159], v[36:39], v[40:43], v[144:159]
    ds_read_b64_tr_b16 v[66:67], v20 offset:37888
    ds_read_b128 v[60:63], v25 offset:4096
    s_waitcnt lgkmcnt(8)
    v_mfma_f32_32x32x16_bf16 v[160:175], v[32:35], v[44:47], v[160:175]
    ds_read_b64_tr_b16 v[68:69], v21 offset:36864
    ds_read_b64_tr_b16 v[70:71], v21 offset:37888
    v_mfma_f32_32x32x16_bf16 v[176:191], v[36:39], v[44:47], v[176:191]
    ds_read_b64_tr_b16 v[72:73], v22 offset:36864
    ds_read_b64_tr_b16 v[74:75], v22 offset:37888
    s_waitcnt lgkmcnt(10)
    v_mfma_f32_32x32x16_bf16 v[192:207], v[32:35], v[48:51], v[192:207]
    ds_read_b64_tr_b16 v[76:77], v23 offset:36864
    ds_read_b64_tr_b16 v[78:79], v23 offset:37888
    v_mfma_f32_32x32x16_bf16 v[208:223], v[36:39], v[48:51], v[208:223]
    s_waitcnt lgkmcnt(10)
    v_mfma_f32_32x32x16_bf16 v[224:239], v[32:35], v[52:55], v[224:239]
    v_mfma_f32_32x32x16_bf16 v[240:255], v[36:39], v[52:55], v[240:255]
    s_waitcnt lgkmcnt(0)
    v_mfma_f32_32x32x16_bf16 v[128:143], v[56:59], v[64:67], v[128:143]
    v_mfma_f32_32x32x16_bf16 v[144:159], v[60:63], v[64:67], v[144:159]
    s_waitcnt vmcnt(14)
    s_barrier
    ds_read_b128 v[32:35], v26 offset:0
    ds_read_b64_tr_b16 v[40:41], v20 offset:49152
    v_mfma_f32_32x32x16_bf16 v[160:175], v[56:59], v[68:71], v[160:175]
    ds_read_b64_tr_b16 v[42:43], v20 offset:50176
    ds_read_b128 v[36:39], v26 offset:4096
    v_mfma_f32_32x32x16_bf16 v[176:191], v[60:63], v[68:71], v[176:191]
    ds_read_b64_tr_b16 v[44:45], v21 offset:49152
    ds_read_b64_tr_b16 v[46:47], v21 offset:50176
    v_mfma_f32_32x32x16_bf16 v[192:207], v[56:59], v[72:75], v[192:207]
    s_add_u32 m0, s61, 131072
    s_add_u32 s62, s101, 1572864
    s_and_b32 s62, s62, 0x3fffff
    buffer_load_dwordx4 v11, s[24:27], s62 offen lds
    ds_read_b64_tr_b16 v[48:49], v22 offset:49152
    v_mfma_f32_32x32x16_bf16 v[208:223], v[60:63], v[72:75], v[208:223]
    s_add_u32 m0, s61, 139264
    s_add_u32 s62, s101, 1572864
    s_and_b32 s62, s62, 0x3fffff
    buffer_load_dwordx4 v11, s[28:31], s62 offen lds
    ds_read_b64_tr_b16 v[50:51], v22 offset:50176
    v_mfma_f32_32x32x16_bf16 v[224:239], v[56:59], v[76:79], v[224:239]
    s_add_u32 m0, s60, 34816
    s_add_u32 s62, s100, 384
    s_and_b32 s62, s62, 1023
    s_add_u32 s62, s62, 16384
    buffer_load_dwordx4 v10, s[20:23], s62 offen lds
    ds_read_b64_tr_b16 v[52:53], v23 offset:49152
    v_mfma_f32_32x32x16_bf16 v[240:255], v[60:63], v[76:79], v[240:255]
    s_add_u32 m0, s60, 35840
    s_add_u32 s62, s100, 384
    s_and_b32 s62, s62, 1023
    s_add_u32 s62, s62, 16384
    buffer_load_dwordx4 v13, s[20:23], s62 offen lds
    ds_read_b64_tr_b16 v[54:55], v23 offset:50176
    s_waitcnt lgkmcnt(7)
    v_mfma_f32_32x32x16_bf16 v[128:143], v[32:35], v[40:43], v[128:143]
    ds_read_b128 v[56:59], v27 offset:0
    ds_read_b64_tr_b16 v[64:65], v20 offset:53248
    s_waitcnt lgkmcnt(8)
    v_mfma_f32_32x32x16_bf16 v[144:159], v[36:39], v[40:43], v[144:159]
    ds_read_b64_tr_b16 v[66:67], v20 offset:54272
    ds_read_b128 v[60:63], v27 offset:4096
    s_waitcnt lgkmcnt(8)
    v_mfma_f32_32x32x16_bf16 v[160:175], v[32:35], v[44:47], v[160:175]
    ds_read_b64_tr_b16 v[68:69], v21 offset:53248
    ds_read_b64_tr_b16 v[70:71], v21 offset:54272
    v_mfma_f32_32x32x16_bf16 v[176:191], v[36:39], v[44:47], v[176:191]
    ds_read_b64_tr_b16 v[72:73], v22 offset:53248
    ds_read_b64_tr_b16 v[74:75], v22 offset:54272
    s_waitcnt lgkmcnt(10)
    v_mfma_f32_32x32x16_bf16 v[192:207], v[32:35], v[48:51], v[192:207]
    ds_read_b64_tr_b16 v[76:77], v23 offset:53248
    ds_read_b64_tr_b16 v[78:79], v23 offset:54272
    v_mfma_f32_32x32x16_bf16 v[208:223], v[36:39], v[48:51], v[208:223]
    s_waitcnt lgkmcnt(10)
    v_mfma_f32_32x32x16_bf16 v[224:239], v[32:35], v[52:55], v[224:239]
    v_mfma_f32_32x32x16_bf16 v[240:255], v[36:39], v[52:55], v[240:255]
    s_waitcnt lgkmcnt(0)
    v_mfma_f32_32x32x16_bf16 v[128:143], v[56:59], v[64:67], v[128:143]
    v_mfma_f32_32x32x16_bf16 v[144:159], v[60:63], v[64:67], v[144:159]
    s_waitcnt vmcnt(14)
    s_waitcnt vmcnt(8)
    s_barrier
    ds_read_b128 v[32:35], v14 offset:0
    v_mov_b32 v124, 1
    buffer_store_byte v124, v8, s[8:11], 0 offen sc1
    ds_read_b64_tr_b16 v[40:41], v20 offset:0
    v_mfma_f32_32x32x16_bf16 v[160:175], v[56:59], v[68:71], v[160:175]
    ds_read_b64_tr_b16 v[42:43], v20 offset:1024
    ds_read_b128 v[36:39], v14 offset:4096
    v_mfma_f32_32x32x16_bf16 v[176:191], v[60:63], v[68:71], v[176:191]
    ds_read_b64_tr_b16 v[44:45], v21 offset:0
    ds_read_b64_tr_b16 v[46:47], v21 offset:1024
    v_mfma_f32_32x32x16_bf16 v[192:207], v[56:59], v[72:75], v[192:207]
    s_add_u32 m0, s61, 147456
    s_add_u32 s62, s101, 1835008
    s_and_b32 s62, s62, 0x3fffff
    buffer_load_dwordx4 v11, s[24:27], s62 offen lds
    ds_read_b64_tr_b16 v[48:49], v22 offset:0
    v_mfma_f32_32x32x16_bf16 v[208:223], v[60:63], v[72:75], v[208:223]
    s_add_u32 m0, s61, 155648
    s_add_u32 s62, s101, 1835008
    s_and_b32 s62, s62, 0x3fffff
    buffer_load_dwordx4 v11, s[28:31], s62 offen lds
    ds_read_b64_tr_b16 v[50:51], v22 offset:1024
    v_mfma_f32_32x32x16_bf16 v[224:239], v[56:59], v[76:79], v[224:239]
    s_add_u32 m0, s60, 65536
    s_add_u32 s62, s100, 512
    s_and_b32 s62, s62, 1023
    buffer_load_dwordx4 v10, s[20:23], s62 offen lds
    ds_read_b64_tr_b16 v[52:53], v23 offset:0
    v_mfma_f32_32x32x16_bf16 v[240:255], v[60:63], v[76:79], v[240:255]
    s_add_u32 m0, s60, 66560
    s_add_u32 s62, s100, 512
    s_and_b32 s62, s62, 1023
    buffer_load_dwordx4 v13, s[20:23], s62 offen lds
    ds_read_b64_tr_b16 v[54:55], v23 offset:1024
    s_waitcnt lgkmcnt(7)
    v_mfma_f32_32x32x16_bf16 v[128:143], v[32:35], v[40:43], v[128:143]
    ds_read_b128 v[56:59], v15 offset:0
    ds_read_b64_tr_b16 v[64:65], v20 offset:4096
    s_waitcnt lgkmcnt(8)
    v_mfma_f32_32x32x16_bf16 v[144:159], v[36:39], v[40:43], v[144:159]
    ds_read_b64_tr_b16 v[66:67], v20 offset:5120
    ds_read_b128 v[60:63], v15 offset:4096
    s_waitcnt lgkmcnt(8)
    v_mfma_f32_32x32x16_bf16 v[160:175], v[32:35], v[44:47], v[160:175]
    ds_read_b64_tr_b16 v[68:69], v21 offset:4096
    ds_read_b64_tr_b16 v[70:71], v21 offset:5120
    v_mfma_f32_32x32x16_bf16 v[176:191], v[36:39], v[44:47], v[176:191]
    ds_read_b64_tr_b16 v[72:73], v22 offset:4096
    ds_read_b64_tr_b16 v[74:75], v22 offset:5120
    s_waitcnt lgkmcnt(10)
    v_mfma_f32_32x32x16_bf16 v[192:207], v[32:35], v[48:51], v[192:207]
    ds_read_b64_tr_b16 v[76:77], v23 offset:4096
    ds_read_b64_tr_b16 v[78:79], v23 offset:5120
    v_mfma_f32_32x32x16_bf16 v[208:223], v[36:39], v[48:51], v[208:223]
    s_waitcnt lgkmcnt(10)
    v_mfma_f32_32x32x16_bf16 v[224:239], v[32:35], v[52:55], v[224:239]
    v_mfma_f32_32x32x16_bf16 v[240:255], v[36:39], v[52:55], v[240:255]
    s_waitcnt lgkmcnt(0)
    v_mfma_f32_32x32x16_bf16 v[128:143], v[56:59], v[64:67], v[128:143]
    v_mfma_f32_32x32x16_bf16 v[144:159], v[60:63], v[64:67], v[144:159]
    s_waitcnt vmcnt(11)
    s_barrier
    ds_read_b128 v[32:35], v16 offset:0
    ds_read_b64_tr_b16 v[40:41], v20 offset:16384
    v_mfma_f32_32x32x16_bf16 v[160:175], v[56:59], v[68:71], v[160:175]
    ds_read_b64_tr_b16 v[42:43], v20 offset:17408
    ds_read_b128 v[36:39], v16 offset:4096
    v_mfma_f32_32x32x16_bf16 v[176:191], v[60:63], v[68:71], v[176:191]
    ds_read_b64_tr_b16 v[44:45], v21 offset:16384
    ds_read_b64_tr_b16 v[46:47], v21 offset:17408
    v_mfma_f32_32x32x16_bf16 v[192:207], v[56:59], v[72:75], v[192:207]
    s_add_u32 m0, s61, 98304
    s_add_u32 s62, s101, 2097152
    s_and_b32 s62, s62, 0x3fffff
    buffer_load_dwordx4 v11, s[24:27], s62 offen lds
    ds_read_b64_tr_b16 v[48:49], v22 offset:16384
    v_mfma_f32_32x32x16_bf16 v[208:223], v[60:63], v[72:75], v[208:223]
    s_add_u32 m0, s61, 106496
    s_add_u32 s62, s101, 2097152
    s_and_b32 s62, s62, 0x3fffff
    buffer_load_dwordx4 v11, s[28:31], s62 offen lds
    ds_read_b64_tr_b16 v[50:51], v22 offset:17408
    v_mfma_f32_32x32x16_bf16 v[224:239], v[56:59], v[76:79], v[224:239]
    s_add_u32 m0, s60, 67584
    s_add_u32 s62, s100, 512
    s_and_b32 s62, s62, 1023
    s_add_u32 s62, s62, 16384
    buffer_load_dwordx4 v10, s[20:23], s62 offen lds
    ds_read_b64_tr_b16 v[52:53], v23 offset:16384
    v_mfma_f32_32x32x16_bf16 v[240:255], v[60:63], v[76:79], v[240:255]
    s_add_u32 m0, s60, 68608
    s_add_u32 s62, s100, 512
    s_and_b32 s62, s62, 1023
    s_add_u32 s62, s62, 16384
    buffer_load_dwordx4 v13, s[20:23], s62 offen lds
    ds_read_b64_tr_b16 v[54:55], v23 offset:17408
    s_waitcnt lgkmcnt(7)
    v_mfma_f32_32x32x16_bf16 v[128:143], v[32:35], v[40:43], v[128:143]
    ds_read_b128 v[56:59], v17 offset:0
    ds_read_b64_tr_b16 v[64:65], v20 offset:20480
    s_waitcnt lgkmcnt(8)
    v_mfma_f32_32x32x16_bf16 v[144:159], v[36:39], v[40:43], v[144:159]
    ds_read_b64_tr_b16 v[66:67], v20 offset:21504
    ds_read_b128 v[60:63], v17 offset:4096
    s_waitcnt lgkmcnt(8)
    v_mfma_f32_32x32x16_bf16 v[160:175], v[32:35], v[44:47], v[160:175]
    ds_read_b64_tr_b16 v[68:69], v21 offset:20480
    ds_read_b64_tr_b16 v[70:71], v21 offset:21504
    v_mfma_f32_32x32x16_bf16 v[176:191], v[36:39], v[44:47], v[176:191]
    ds_read_b64_tr_b16 v[72:73], v22 offset:20480
    ds_read_b64_tr_b16 v[74:75], v22 offset:21504
    s_waitcnt lgkmcnt(10)
    v_mfma_f32_32x32x16_bf16 v[192:207], v[32:35], v[48:51], v[192:207]
    ds_read_b64_tr_b16 v[76:77], v23 offset:20480
    ds_read_b64_tr_b16 v[78:79], v23 offset:21504
    v_mfma_f32_32x32x16_bf16 v[208:223], v[36:39], v[48:51], v[208:223]
    s_waitcnt lgkmcnt(10)
    v_mfma_f32_32x32x16_bf16 v[224:239], v[32:35], v[52:55], v[224:239]
    v_mfma_f32_32x32x16_bf16 v[240:255], v[36:39], v[52:55], v[240:255]
    s_waitcnt lgkmcnt(0)
    v_mfma_f32_32x32x16_bf16 v[128:143], v[56:59], v[64:67], v[128:143]
    v_mfma_f32_32x32x16_bf16 v[144:159], v[60:63], v[64:67], v[144:159]
    s_waitcnt vmcnt(11)
    s_waitcnt vmcnt(9)
    s_barrier
    ds_read_b128 v[32:35], v14 offset:32768
    ds_read_b64_tr_b16 v[40:41], v20 offset:32768
    v_mfma_f32_32x32x16_bf16 v[160:175], v[56:59], v[68:71], v[160:175]
    ds_read_b64_tr_b16 v[42:43], v20 offset:33792
    ds_read_b128 v[36:39], v14 offset:36864
    v_mfma_f32_32x32x16_bf16 v[176:191], v[60:63], v[68:71], v[176:191]
    ds_read_b64_tr_b16 v[44:45], v21 offset:32768
    ds_read_b64_tr_b16 v[46:47], v21 offset:33792
    v_mfma_f32_32x32x16_bf16 v[192:207], v[56:59], v[72:75], v[192:207]
    s_add_u32 m0, s61, 114688
    s_add_u32 s62, s101, 2359296
    s_and_b32 s62, s62, 0x3fffff
    buffer_load_dwordx4 v11, s[24:27], s62 offen lds
    ds_read_b64_tr_b16 v[48:49], v22 offset:32768
    v_mfma_f32_32x32x16_bf16 v[208:223], v[60:63], v[72:75], v[208:223]
    s_add_u32 m0, s61, 122880
    s_add_u32 s62, s101, 2359296
    s_and_b32 s62, s62, 0x3fffff
    buffer_load_dwordx4 v11, s[28:31], s62 offen lds
    ds_read_b64_tr_b16 v[50:51], v22 offset:33792
    v_mfma_f32_32x32x16_bf16 v[224:239], v[56:59], v[76:79], v[224:239]
    s_add_u32 m0, s60, 0
    s_add_u32 s62, s100, 640
    s_and_b32 s62, s62, 1023
    buffer_load_dwordx4 v10, s[20:23], s62 offen lds
    ds_read_b64_tr_b16 v[52:53], v23 offset:32768
    v_mfma_f32_32x32x16_bf16 v[240:255], v[60:63], v[76:79], v[240:255]
    s_add_u32 m0, s60, 1024
    s_add_u32 s62, s100, 640
    s_and_b32 s62, s62, 1023
    buffer_load_dwordx4 v13, s[20:23], s62 offen lds
    ds_read_b64_tr_b16 v[54:55], v23 offset:33792
    s_waitcnt lgkmcnt(7)
    v_mfma_f32_32x32x16_bf16 v[128:143], v[32:35], v[40:43], v[128:143]
    ds_read_b128 v[56:59], v15 offset:32768
    ds_read_b64_tr_b16 v[64:65], v20 offset:36864
    s_waitcnt lgkmcnt(8)
    v_mfma_f32_32x32x16_bf16 v[144:159], v[36:39], v[40:43], v[144:159]
    ds_read_b64_tr_b16 v[66:67], v20 offset:37888
    ds_read_b128 v[60:63], v15 offset:36864
    s_waitcnt lgkmcnt(8)
    v_mfma_f32_32x32x16_bf16 v[160:175], v[32:35], v[44:47], v[160:175]
    ds_read_b64_tr_b16 v[68:69], v21 offset:36864
    ds_read_b64_tr_b16 v[70:71], v21 offset:37888
    v_mfma_f32_32x32x16_bf16 v[176:191], v[36:39], v[44:47], v[176:191]
    ds_read_b64_tr_b16 v[72:73], v22 offset:36864
    ds_read_b64_tr_b16 v[74:75], v22 offset:37888
    s_waitcnt lgkmcnt(10)
    v_mfma_f32_32x32x16_bf16 v[192:207], v[32:35], v[48:51], v[192:207]
    ds_read_b64_tr_b16 v[76:77], v23 offset:36864
    ds_read_b64_tr_b16 v[78:79], v23 offset:37888
    v_mfma_f32_32x32x16_bf16 v[208:223], v[36:39], v[48:51], v[208:223]
    s_waitcnt lgkmcnt(10)
    v_mfma_f32_32x32x16_bf16 v[224:239], v[32:35], v[52:55], v[224:239]
    v_mfma_f32_32x32x16_bf16 v[240:255], v[36:39], v[52:55], v[240:255]
    s_waitcnt lgkmcnt(0)
    v_mfma_f32_32x32x16_bf16 v[128:143], v[56:59], v[64:67], v[128:143]
    v_mfma_f32_32x32x16_bf16 v[144:159], v[60:63], v[64:67], v[144:159]
    s_waitcnt vmcnt(10)
    s_barrier
    ds_read_b128 v[32:35], v16 offset:32768
    ds_read_b64_tr_b16 v[40:41], v20 offset:49152
    v_mfma_f32_32x32x16_bf16 v[160:175], v[56:59], v[68:71], v[160:175]
    ds_read_b64_tr_b16 v[42:43], v20 offset:50176
    ds_read_b128 v[36:39], v16 offset:36864
    v_mfma_f32_32x32x16_bf16 v[176:191], v[60:63], v[68:71], v[176:191]
    ds_read_b64_tr_b16 v[44:45], v21 offset:49152
    ds_read_b64_tr_b16 v[46:47], v21 offset:50176
    v_mfma_f32_32x32x16_bf16 v[192:207], v[56:59], v[72:75], v[192:207]
    s_add_u32 m0, s61, 131072
    s_add_u32 s62, s101, 2621440
    s_and_b32 s62, s62, 0x3fffff
    buffer_load_dwordx4 v11, s[24:27], s62 offen lds
    ds_read_b64_tr_b16 v[48:49], v22 offset:49152
    v_mfma_f32_32x32x16_bf16 v[208:223], v[60:63], v[72:75], v[208:223]
    s_add_u32 m0, s61, 139264
    s_add_u32 s62, s101, 2621440
    s_and_b32 s62, s62, 0x3fffff
    buffer_load_dwordx4 v11, s[28:31], s62 offen lds
    ds_read_b64_tr_b16 v[50:51], v22 offset:50176
    v_mfma_f32_32x32x16_bf16 v[224:239], v[56:59], v[76:79], v[224:239]
    s_add_u32 m0, s60, 2048
    s_add_u32 s62, s100, 640
    s_and_b32 s62, s62, 1023
    s_add_u32 s62, s62, 16384
    buffer_load_dwordx4 v10, s[20:23], s62 offen lds
    ds_read_b64_tr_b16 v[52:53], v23 offset:49152
    v_mfma_f32_32x32x16_bf16 v[240:255], v[60:63], v[76:79], v[240:255]
    s_add_u32 m0, s60, 3072
    s_add_u32 s62, s100, 640
    s_and_b32 s62, s62, 1023
    s_add_u32 s62, s62, 16384
    buffer_load_dwordx4 v13, s[20:23], s62 offen lds
    ds_read_b64_tr_b16 v[54:55], v23 offset:50176
    s_waitcnt lgkmcnt(7)
    v_mfma_f32_32x32x16_bf16 v[128:143], v[32:35], v[40:43], v[128:143]
    ds_read_b128 v[56:59], v17 offset:32768
    ds_read_b64_tr_b16 v[64:65], v20 offset:53248
    s_waitcnt lgkmcnt(8)
    v_mfma_f32_32x32x16_bf16 v[144:159], v[36:39], v[40:43], v[144:159]
    ds_read_b64_tr_b16 v[66:67], v20 offset:54272
    ds_read_b128 v[60:63], v17 offset:36864
    s_waitcnt lgkmcnt(8)
    v_mfma_f32_32x32x16_bf16 v[160:175], v[32:35], v[44:47], v[160:175]
    ds_read_b64_tr_b16 v[68:69], v21 offset:53248
    ds_read_b64_tr_b16 v[70:71], v21 offset:54272
    v_mfma_f32_32x32x16_bf16 v[176:191], v[36:39], v[44:47], v[176:191]
    ds_read_b64_tr_b16 v[72:73], v22 offset:53248
    ds_read_b64_tr_b16 v[74:75], v22 offset:54272
    s_waitcnt lgkmcnt(10)
    v_mfma_f32_32x32x16_bf16 v[192:207], v[32:35], v[48:51], v[192:207]
    ds_read_b64_tr_b16 v[76:77], v23 offset:53248
    ds_read_b64_tr_b16 v[78:79], v23 offset:54272
    v_mfma_f32_32x32x16_bf16 v[208:223], v[36:39], v[48:51], v[208:223]
    s_waitcnt lgkmcnt(10)
    v_mfma_f32_32x32x16_bf16 v[224:239], v[32:35], v[52:55], v[224:239]
    v_mfma_f32_32x32x16_bf16 v[240:255], v[36:39], v[52:55], v[240:255]
    s_waitcnt lgkmcnt(0)
    v_mfma_f32_32x32x16_bf16 v[128:143], v[56:59], v[64:67], v[128:143]
    v_mfma_f32_32x32x16_bf16 v[144:159], v[60:63], v[64:67], v[144:159]
    s_waitcnt vmcnt(10)
    s_waitcnt vmcnt(8)
    s_barrier
    ds_read_b128 v[32:35], v24 offset:0
    ds_read_b64_tr_b16 v[40:41], v20 offset:0
    v_mfma_f32_32x32x16_bf16 v[160:175], v[56:59], v[68:71], v[160:175]
    ds_read_b64_tr_b16 v[42:43], v20 offset:1024
    ds_read_b128 v[36:39], v24 offset:4096
    v_mfma_f32_32x32x16_bf16 v[176:191], v[60:63], v[68:71], v[176:191]
    ds_read_b64_tr_b16 v[44:45], v21 offset:0
    ds_read_b64_tr_b16 v[46:47], v21 offset:1024
    v_mfma_f32_32x32x16_bf16 v[192:207], v[56:59], v[72:75], v[192:207]
    s_add_u32 m0, s61, 147456
    s_add_u32 s62, s101, 2883584
    s_and_b32 s62, s62, 0x3fffff
    buffer_load_dwordx4 v11, s[24:27], s62 offen lds
    ds_read_b64_tr_b16 v[48:49], v22 offset:0
    v_mfma_f32_32x32x16_bf16 v[208:223], v[60:63], v[72:75], v[208:223]
    s_add_u32 m0, s61, 155648
    s_add_u32 s62, s101, 2883584
    s_and_b32 s62, s62, 0x3fffff
    buffer_load_dwordx4 v11, s[28:31], s62 offen lds
    ds_read_b64_tr_b16 v[50:51], v22 offset:1024
    v_mfma_f32_32x32x16_bf16 v[224:239], v[56:59], v[76:79], v[224:239]
    s_add_u32 m0, s60, 32768
    s_add_u32 s62, s100, 768
    s_and_b32 s62, s62, 1023
    buffer_load_dwordx4 v10, s[20:23], s62 offen lds
    ds_read_b64_tr_b16 v[52:53], v23 offset:0
    v_mfma_f32_32x32x16_bf16 v[240:255], v[60:63], v[76:79], v[240:255]
    s_add_u32 m0, s60, 33792
    s_add_u32 s62, s100, 768
    s_and_b32 s62, s62, 1023
    buffer_load_dwordx4 v13, s[20:23], s62 offen lds
    ds_read_b64_tr_b16 v[54:55], v23 offset:1024
    s_waitcnt lgkmcnt(7)
    v_mfma_f32_32x32x16_bf16 v[128:143], v[32:35], v[40:43], v[128:143]
    ds_read_b128 v[56:59], v25 offset:0
    ds_read_b64_tr_b16 v[64:65], v20 offset:4096
    s_waitcnt lgkmcnt(8)
    v_mfma_f32_32x32x16_bf16 v[144:159], v[36:39], v[40:43], v[144:159]
    ds_read_b64_tr_b16 v[66:67], v20 offset:5120
    ds_read_b128 v[60:63], v25 offset:4096
    s_mul_i32 s76, s46, 7
    s_add_u32 s76, s76, s44
    s_lshl_b32 s76, s76, 11
    s_mul_i32 s77, s45, 229376
    s_add_u32 s76, s76, s77
    s_add_u32 s76, s76, 65011712
    s_cmp_eq_u32 s44, 7
    s_cselect_b32 s76, 1073741824, s76
    s_add_u32 s77, s76, 114688
    s_waitcnt lgkmcnt(8)
    v_mfma_f32_32x32x16_bf16 v[160:175], v[32:35], v[44:47], v[160:175]
    ds_read_b64_tr_b16 v[68:69], v21 offset:4096
    ds_read_b64_tr_b16 v[70:71], v21 offset:5120
    v_mov_b32 v108, -1
    v_mov_b32 v109, -1
    v_mov_b32 v110, -1
    v_mov_b32 v111, -1
    v_mfma_f32_32x32x16_bf16 v[176:191], v[36:39], v[44:47], v[176:191]
    ds_read_b64_tr_b16 v[72:73], v22 offset:4096
    ds_read_b64_tr_b16 v[74:75], v22 offset:5120
    buffer_store_dwordx4 v[108:111], v4, s[32:35], s76 offen offset:0 sc1
    s_waitcnt lgkmcnt(10)
    v_mfma_f32_32x32x16_bf16 v[192:207], v[32:35], v[48:51], v[192:207]
    ds_read_b64_tr_b16 v[76:77], v23 offset:4096
    ds_read_b64_tr_b16 v[78:79], v23 offset:5120
    buffer_store_dwordx4 v[108:111], v4, s[32:35], s76 offen offset:1024 sc1
    v_mfma_f32_32x32x16_bf16 v[208:223], v[36:39], v[48:51], v[208:223]
    buffer_store_dwordx4 v[108:111], v4, s[32:35], s77 offen offset:0 sc1
    s_waitcnt lgkmcnt(10)
    v_mfma_f32_32x32x16_bf16 v[224:239], v[32:35], v[52:55], v[224:239]
    buffer_store_dwordx4 v[108:111], v4, s[32:35], s77 offen offset:1024 sc1
    v_mfma_f32_32x32x16_bf16 v[240:255], v[36:39], v[52:55], v[240:255]
    buffer_load_dword v124, v18, s[8:11], 0 offen sc1
    s_waitcnt lgkmcnt(0)
    v_mfma_f32_32x32x16_bf16 v[128:143], v[56:59], v[64:67], v[128:143]
    v_mfma_f32_32x32x16_bf16 v[144:159], v[60:63], v[64:67], v[144:159]
    s_waitcnt vmcnt(15)
    s_barrier
    ds_read_b128 v[32:35], v26 offset:0
    ds_read_b64_tr_b16 v[40:41], v20 offset:16384
    v_mfma_f32_32x32x16_bf16 v[160:175], v[56:59], v[68:71], v[160:175]
    ds_read_b64_tr_b16 v[42:43], v20 offset:17408
    ds_read_b128 v[36:39], v26 offset:4096
    v_mfma_f32_32x32x16_bf16 v[176:191], v[60:63], v[68:71], v[176:191]
    ds_read_b64_tr_b16 v[44:45], v21 offset:16384
    ds_read_b64_tr_b16 v[46:47], v21 offset:17408
    v_mfma_f32_32x32x16_bf16 v[192:207], v[56:59], v[72:75], v[192:207]
    s_add_u32 m0, s61, 98304
    s_add_u32 s62, s101, 3145728
    s_and_b32 s62, s62, 0x3fffff
    buffer_load_dwordx4 v11, s[24:27], s62 offen lds
    ds_read_b64_tr_b16 v[48:49], v22 offset:16384
    v_mfma_f32_32x32x16_bf16 v[208:223], v[60:63], v[72:75], v[208:223]
    s_add_u32 m0, s61, 106496
    s_add_u32 s62, s101, 3145728
    s_and_b32 s62, s62, 0x3fffff
    buffer_load_dwordx4 v11, s[28:31], s62 offen lds
    ds_read_b64_tr_b16 v[50:51], v22 offset:17408
    v_mfma_f32_32x32x16_bf16 v[224:239], v[56:59], v[76:79], v[224:239]
    s_add_u32 m0, s60, 34816
    s_add_u32 s62, s100, 768
    s_and_b32 s62, s62, 1023
    s_add_u32 s62, s62, 16384
    buffer_load_dwordx4 v10, s[20:23], s62 offen lds
    ds_read_b64_tr_b16 v[52:53], v23 offset:16384
    v_mfma_f32_32x32x16_bf16 v[240:255], v[60:63], v[76:79], v[240:255]
    s_add_u32 m0, s60, 35840
    s_add_u32 s62, s100, 768
    s_and_b32 s62, s62, 1023
    s_add_u32 s62, s62, 16384
    buffer_load_dwordx4 v13, s[20:23], s62 offen lds
    ds_read_b64_tr_b16 v[54:55], v23 offset:17408
    s_waitcnt lgkmcnt(7)
    v_mfma_f32_32x32x16_bf16 v[128:143], v[32:35], v[40:43], v[128:143]
    ds_read_b128 v[56:59], v27 offset:0
    ds_read_b64_tr_b16 v[64:65], v20 offset:20480
    s_waitcnt lgkmcnt(8)
    v_mfma_f32_32x32x16_bf16 v[144:159], v[36:39], v[40:43], v[144:159]
    ds_read_b64_tr_b16 v[66:67], v20 offset:21504
    ds_read_b128 v[60:63], v27 offset:4096
    s_waitcnt lgkmcnt(8)
    v_mfma_f32_32x32x16_bf16 v[160:175], v[32:35], v[44:47], v[160:175]
    ds_read_b64_tr_b16 v[68:69], v21 offset:20480
    ds_read_b64_tr_b16 v[70:71], v21 offset:21504
    v_mfma_f32_32x32x16_bf16 v[176:191], v[36:39], v[44:47], v[176:191]
    ds_read_b64_tr_b16 v[72:73], v22 offset:20480
    ds_read_b64_tr_b16 v[74:75], v22 offset:21504
    s_waitcnt lgkmcnt(10)
    v_mfma_f32_32x32x16_bf16 v[192:207], v[32:35], v[48:51], v[192:207]
    ds_read_b64_tr_b16 v[76:77], v23 offset:20480
    ds_read_b64_tr_b16 v[78:79], v23 offset:21504
    v_mfma_f32_32x32x16_bf16 v[208:223], v[36:39], v[48:51], v[208:223]
    s_waitcnt lgkmcnt(10)
    v_mfma_f32_32x32x16_bf16 v[224:239], v[32:35], v[52:55], v[224:239]
    v_mfma_f32_32x32x16_bf16 v[240:255], v[36:39], v[52:55], v[240:255]
    s_waitcnt lgkmcnt(0)
    v_mfma_f32_32x32x16_bf16 v[128:143], v[56:59], v[64:67], v[128:143]
    v_mfma_f32_32x32x16_bf16 v[144:159], v[60:63], v[64:67], v[144:159]
    s_waitcnt vmcnt(15)
    s_waitcnt vmcnt(13)
    s_waitcnt vmcnt(4)
    v_and_b32 v124, v124, v19
    v_cmp_ne_u32 vcc, v124, v19
    s_cbranch_vccnz spin_14
spb_15:
    s_barrier
    ds_read_b128 v[32:35], v14 offset:0
    ds_read_b64_tr_b16 v[40:41], v20 offset:32768
    v_mfma_f32_32x32x16_bf16 v[160:175], v[56:59], v[68:71], v[160:175]
    ds_read_b64_tr_b16 v[42:43], v20 offset:33792
    ds_read_b128 v[36:39], v14 offset:4096
    v_mfma_f32_32x32x16_bf16 v[176:191], v[60:63], v[68:71], v[176:191]
    ds_read_b64_tr_b16 v[44:45], v21 offset:32768
    ds_read_b64_tr_b16 v[46:47], v21 offset:33792
    v_mfma_f32_32x32x16_bf16 v[192:207], v[56:59], v[72:75], v[192:207]
    s_add_u32 m0, s61, 114688
    s_add_u32 s62, s101, 3407872
    s_and_b32 s62, s62, 0x3fffff
    buffer_load_dwordx4 v11, s[24:27], s62 offen lds
    ds_read_b64_tr_b16 v[48:49], v22 offset:32768
    v_mfma_f32_32x32x16_bf16 v[208:223], v[60:63], v[72:75], v[208:223]
    s_add_u32 m0, s61, 122880
    s_add_u32 s62, s101, 3407872
    s_and_b32 s62, s62, 0x3fffff
    buffer_load_dwordx4 v11, s[28:31], s62 offen lds
    ds_read_b64_tr_b16 v[50:51], v22 offset:33792
    v_mfma_f32_32x32x16_bf16 v[224:239], v[56:59], v[76:79], v[224:239]
    s_add_u32 m0, s60, 65536
    s_add_u32 s62, s100, 896
    s_and_b32 s62, s62, 1023
    buffer_load_dwordx4 v10, s[20:23], s62 offen lds
    ds_read_b64_tr_b16 v[52:53], v23 offset:32768
    v_mfma_f32_32x32x16_bf16 v[240:255], v[60:63], v[76:79], v[240:255]
    s_add_u32 m0, s60, 66560
    s_add_u32 s62, s100, 896
    s_and_b32 s62, s62, 1023
    buffer_load_dwordx4 v13, s[20:23], s62 offen lds
    ds_read_b64_tr_b16 v[54:55], v23 offset:33792
    s_waitcnt lgkmcnt(7)
    v_mfma_f32_32x32x16_bf16 v[128:143], v[32:35], v[40:43], v[128:143]
    ds_read_b128 v[56:59], v15 offset:0
    ds_read_b64_tr_b16 v[64:65], v20 offset:36864
    s_waitcnt lgkmcnt(8)
    v_mfma_f32_32x32x16_bf16 v[144:159], v[36:39], v[40:43], v[144:159]
    ds_read_b64_tr_b16 v[66:67], v20 offset:37888
    ds_read_b128 v[60:63], v15 offset:4096
    s_waitcnt lgkmcnt(8)
    v_mfma_f32_32x32x16_bf16 v[160:175], v[32:35], v[44:47], v[160:175]
    ds_read_b64_tr_b16 v[68:69], v21 offset:36864
    ds_read_b64_tr_b16 v[70:71], v21 offset:37888
    v_mfma_f32_32x32x16_bf16 v[176:191], v[36:39], v[44:47], v[176:191]
    ds_read_b64_tr_b16 v[72:73], v22 offset:36864
    ds_read_b64_tr_b16 v[74:75], v22 offset:37888
    s_waitcnt lgkmcnt(10)
    v_mfma_f32_32x32x16_bf16 v[192:207], v[32:35], v[48:51], v[192:207]
    ds_read_b64_tr_b16 v[76:77], v23 offset:36864
    ds_read_b64_tr_b16 v[78:79], v23 offset:37888
    v_mfma_f32_32x32x16_bf16 v[208:223], v[36:39], v[48:51], v[208:223]
    s_waitcnt lgkmcnt(10)
    v_mfma_f32_32x32x16_bf16 v[224:239], v[32:35], v[52:55], v[224:239]
    v_mfma_f32_32x32x16_bf16 v[240:255], v[36:39], v[52:55], v[240:255]
    s_waitcnt lgkmcnt(0)
    v_mfma_f32_32x32x16_bf16 v[128:143], v[56:59], v[64:67], v[128:143]
    v_mfma_f32_32x32x16_bf16 v[144:159], v[60:63], v[64:67], v[144:159]
    s_barrier
    ds_read_b128 v[32:35], v16 offset:0
    ds_read_b64_tr_b16 v[40:41], v20 offset:49152
    v_mfma_f32_32x32x16_bf16 v[160:175], v[56:59], v[68:71], v[160:175]
    ds_read_b64_tr_b16 v[42:43], v20 offset:50176
    ds_read_b128 v[36:39], v16 offset:4096
    v_mfma_f32_32x32x16_bf16 v[176:191], v[60:63], v[68:71], v[176:191]
    ds_read_b64_tr_b16 v[44:45], v21 offset:49152
    ds_read_b64_tr_b16 v[46:47], v21 offset:50176
    v_mfma_f32_32x32x16_bf16 v[192:207], v[56:59], v[72:75], v[192:207]
    s_add_u32 m0, s61, 131072
    s_add_u32 s62, s101, 3670016
    s_and_b32 s62, s62, 0x3fffff
    buffer_load_dwordx4 v11, s[24:27], s62 offen lds
    ds_read_b64_tr_b16 v[48:49], v22 offset:49152
    v_mfma_f32_32x32x16_bf16 v[208:223], v[60:63], v[72:75], v[208:223]
    s_add_u32 m0, s61, 139264
    s_add_u32 s62, s101, 3670016
    s_and_b32 s62, s62, 0x3fffff
    buffer_load_dwordx4 v11, s[28:31], s62 offen lds
    ds_read_b64_tr_b16 v[50:51], v22 offset:50176
    v_mfma_f32_32x32x16_bf16 v[224:239], v[56:59], v[76:79], v[224:239]
    s_add_u32 m0, s60, 67584
    s_add_u32 s62, s100, 896
    s_and_b32 s62, s62, 1023
    s_add_u32 s62, s62, 16384
    buffer_load_dwordx4 v10, s[20:23], s62 offen lds
    ds_read_b64_tr_b16 v[52:53], v23 offset:49152
    v_mfma_f32_32x32x16_bf16 v[240:255], v[60:63], v[76:79], v[240:255]
    s_add_u32 m0, s60, 68608
    s_add_u32 s62, s100, 896
    s_and_b32 s62, s62, 1023
    s_add_u32 s62, s62, 16384
    buffer_load_dwordx4 v13, s[20:23], s62 offen lds
    ds_read_b64_tr_b16 v[54:55], v23 offset:50176
    s_waitcnt lgkmcnt(7)
    v_mfma_f32_32x32x16_bf16 v[128:143], v[32:35], v[40:43], v[128:143]
    ds_read_b128 v[56:59], v17 offset:0
    ds_read_b64_tr_b16 v[64:65], v20 offset:53248
    s_waitcnt lgkmcnt(8)
    v_mfma_f32_32x32x16_bf16 v[144:159], v[36:39], v[40:43], v[144:159]
    ds_read_b64_tr_b16 v[66:67], v20 offset:54272
    ds_read_b128 v[60:63], v17 offset:4096
    s_waitcnt lgkmcnt(8)
    v_mfma_f32_32x32x16_bf16 v[160:175], v[32:35], v[44:47], v[160:175]
    ds_read_b64_tr_b16 v[68:69], v21 offset:53248
    ds_read_b64_tr_b16 v[70:71], v21 offset:54272
    v_mfma_f32_32x32x16_bf16 v[176:191], v[36:39], v[44:47], v[176:191]
    ds_read_b64_tr_b16 v[72:73], v22 offset:53248
    ds_read_b64_tr_b16 v[74:75], v22 offset:54272
    s_waitcnt lgkmcnt(10)
    v_mfma_f32_32x32x16_bf16 v[192:207], v[32:35], v[48:51], v[192:207]
    ds_read_b64_tr_b16 v[76:77], v23 offset:53248
    ds_read_b64_tr_b16 v[78:79], v23 offset:54272
    v_mfma_f32_32x32x16_bf16 v[208:223], v[36:39], v[48:51], v[208:223]
    s_waitcnt lgkmcnt(10)
    v_mfma_f32_32x32x16_bf16 v[224:239], v[32:35], v[52:55], v[224:239]
    v_mfma_f32_32x32x16_bf16 v[240:255], v[36:39], v[52:55], v[240:255]
    s_waitcnt lgkmcnt(0)
    v_mfma_f32_32x32x16_bf16 v[128:143], v[56:59], v[64:67], v[128:143]
    v_mfma_f32_32x32x16_bf16 v[144:159], v[60:63], v[64:67], v[144:159]
    s_waitcnt vmcnt(10)
    s_waitcnt vmcnt(8)
    s_barrier
    ds_read_b128 v[32:35], v14 offset:32768
    ds_read_b64_tr_b16 v[40:41], v20 offset:0
    v_mfma_f32_32x32x16_bf16 v[160:175], v[56:59], v[68:71], v[160:175]
    ds_read_b64_tr_b16 v[42:43], v20 offset:1024
    ds_read_b128 v[36:39], v14 offset:36864
    v_mfma_f32_32x32x16_bf16 v[176:191], v[60:63], v[68:71], v[176:191]
    ds_read_b64_tr_b16 v[44:45], v21 offset:0
    ds_read_b64_tr_b16 v[46:47], v21 offset:1024
    v_mfma_f32_32x32x16_bf16 v[192:207], v[56:59], v[72:75], v[192:207]
    s_add_u32 m0, s61, 147456
    s_add_u32 s62, s101, 3932160
    s_and_b32 s62, s62, 0x3fffff
    buffer_load_dwordx4 v11, s[24:27], s62 offen lds
    ds_read_b64_tr_b16 v[48:49], v22 offset:0
    v_mfma_f32_32x32x16_bf16 v[208:223], v[60:63], v[72:75], v[208:223]
    s_add_u32 m0, s61, 155648
    s_add_u32 s62, s101, 3932160
    s_and_b32 s62, s62, 0x3fffff
    buffer_load_dwordx4 v11, s[28:31], s62 offen lds
    ds_read_b64_tr_b16 v[50:51], v22 offset:1024
    v_mfma_f32_32x32x16_bf16 v[224:239], v[56:59], v[76:79], v[224:239]
    s_add_u32 m0, s61, 0
    s_mov_b32 s62, 0
    buffer_load_dwordx4 v11, s[4:7], s62 offen lds
    ds_read_b64_tr_b16 v[52:53], v23 offset:0
    v_mfma_f32_32x32x16_bf16 v[240:255], v[60:63], v[76:79], v[240:255]
    s_add_u32 m0, s61, 8192
    s_mov_b32 s62, 262144
    buffer_load_dwordx4 v11, s[4:7], s62 offen lds
    ds_read_b64_tr_b16 v[54:55], v23 offset:1024
    s_waitcnt lgkmcnt(7)
    v_mfma_f32_32x32x16_bf16 v[128:143], v[32:35], v[40:43], v[128:143]
    ds_read_b128 v[56:59], v15 offset:32768
    ds_read_b64_tr_b16 v[64:65], v20 offset:4096
    s_waitcnt lgkmcnt(8)
    v_mfma_f32_32x32x16_bf16 v[144:159], v[36:39], v[40:43], v[144:159]
    ds_read_b64_tr_b16 v[66:67], v20 offset:5120
    ds_read_b128 v[60:63], v15 offset:36864
    s_waitcnt lgkmcnt(8)
    v_mfma_f32_32x32x16_bf16 v[160:175], v[32:35], v[44:47], v[160:175]
    ds_read_b64_tr_b16 v[68:69], v21 offset:4096
    ds_read_b64_tr_b16 v[70:71], v21 offset:5120
    v_mfma_f32_32x32x16_bf16 v[176:191], v[36:39], v[44:47], v[176:191]
    ds_read_b64_tr_b16 v[72:73], v22 offset:4096
    ds_read_b64_tr_b16 v[74:75], v22 offset:5120
    buffer_load_dwordx4 v[80:83], v4, s[32:35], s42 offen offset:0 sc1
    s_waitcnt lgkmcnt(10)
    v_mfma_f32_32x32x16_bf16 v[192:207], v[32:35], v[48:51], v[192:207]
    ds_read_b64_tr_b16 v[76:77], v23 offset:4096
    ds_read_b64_tr_b16 v[78:79], v23 offset:5120
    v_mfma_f32_32x32x16_bf16 v[208:223], v[36:39], v[48:51], v[208:223]
    s_waitcnt lgkmcnt(10)
    v_mfma_f32_32x32x16_bf16 v[224:239], v[32:35], v[52:55], v[224:239]
    v_mfma_f32_32x32x16_bf16 v[240:255], v[36:39], v[52:55], v[240:255]
    buffer_load_dwordx4 v[84:87], v4, s[32:35], s42 offen offset:1024 sc1
    s_waitcnt lgkmcnt(0)
    v_mfma_f32_32x32x16_bf16 v[128:143], v[56:59], v[64:67], v[128:143]
    v_mfma_f32_32x32x16_bf16 v[144:159], v[60:63], v[64:67], v[144:159]
    s_waitcnt vmcnt(12)
    s_barrier
    ds_read_b128 v[32:35], v16 offset:32768
    buffer_load_dwordx4 v[88:91], v4, s[32:35], s42 offen offset:2048 sc1
    ds_read_b64_tr_b16 v[40:41], v20 offset:16384
    v_mfma_f32_32x32x16_bf16 v[160:175], v[56:59], v[68:71], v[160:175]
    ds_read_b64_tr_b16 v[42:43], v20 offset:17408
    ds_read_b128 v[36:39], v16 offset:36864
    v_mfma_f32_32x32x16_bf16 v[176:191], v[60:63], v[68:71], v[176:191]
    ds_read_b64_tr_b16 v[44:45], v21 offset:16384
    ds_read_b64_tr_b16 v[46:47], v21 offset:17408
    v_mfma_f32_32x32x16_bf16 v[192:207], v[56:59], v[72:75], v[192:207]
    s_add_u32 m0, s61, 98304
    s_mov_b32 s62, 2097152
    buffer_load_dwordx4 v11, s[4:7], s62 offen lds
    ds_read_b64_tr_b16 v[48:49], v22 offset:16384
    buffer_load_dwordx4 v[92:95], v4, s[32:35], s42 offen offset:3072 sc1
    s_add_u32 s42, s42, 4096
    v_mfma_f32_32x32x16_bf16 v[208:223], v[60:63], v[72:75], v[208:223]
    s_add_u32 m0, s61, 106496
    s_mov_b32 s62, 2359296
    buffer_load_dwordx4 v11, s[4:7], s62 offen lds
    ds_read_b64_tr_b16 v[50:51], v22 offset:17408
    v_mfma_f32_32x32x16_bf16 v[224:239], v[56:59], v[76:79], v[224:239]
    s_add_u32 m0, s61, 16384
    s_mov_b32 s62, 524288
    buffer_load_dwordx4 v11, s[4:7], s62 offen lds
    ds_read_b64_tr_b16 v[52:53], v23 offset:16384
    v_mfma_f32_32x32x16_bf16 v[240:255], v[60:63], v[76:79], v[240:255]
    s_add_u32 m0, s61, 24576
    s_mov_b32 s62, 786432
    buffer_load_dwordx4 v11, s[4:7], s62 offen lds
    ds_read_b64_tr_b16 v[54:55], v23 offset:17408
    s_waitcnt lgkmcnt(7)
    v_mfma_f32_32x32x16_bf16 v[128:143], v[32:35], v[40:43], v[128:143]
    ds_read_b128 v[56:59], v17 offset:32768
    ds_read_b64_tr_b16 v[64:65], v20 offset:20480
    s_waitcnt lgkmcnt(8)
    v_mfma_f32_32x32x16_bf16 v[144:159], v[36:39], v[40:43], v[144:159]
    ds_read_b64_tr_b16 v[66:67], v20 offset:21504
    ds_read_b128 v[60:63], v17 offset:36864
    s_waitcnt lgkmcnt(8)
    v_mfma_f32_32x32x16_bf16 v[160:175], v[32:35], v[44:47], v[160:175]
    ds_read_b64_tr_b16 v[68:69], v21 offset:20480
    ds_read_b64_tr_b16 v[70:71], v21 offset:21504
    v_mfma_f32_32x32x16_bf16 v[176:191], v[36:39], v[44:47], v[176:191]
    ds_read_b64_tr_b16 v[72:73], v22 offset:20480
    ds_read_b64_tr_b16 v[74:75], v22 offset:21504
    buffer_load_dwordx4 v[96:99], v4, s[32:35], s42 offen offset:0 sc1
    s_waitcnt lgkmcnt(10)
    v_mfma_f32_32x32x16_bf16 v[192:207], v[32:35], v[48:51], v[192:207]
    ds_read_b64_tr_b16 v[76:77], v23 offset:20480
    ds_read_b64_tr_b16 v[78:79], v23 offset:21504
    v_mfma_f32_32x32x16_bf16 v[208:223], v[36:39], v[48:51], v[208:223]
    s_waitcnt lgkmcnt(10)
    v_mfma_f32_32x32x16_bf16 v[224:239], v[32:35], v[52:55], v[224:239]
    v_mfma_f32_32x32x16_bf16 v[240:255], v[36:39], v[52:55], v[240:255]
    buffer_load_dwordx4 v[100:103], v4, s[32:35], s42 offen offset:1024 sc1
    s_waitcnt lgkmcnt(0)
    v_mfma_f32_32x32x16_bf16 v[128:143], v[56:59], v[64:67], v[128:143]
    v_mfma_f32_32x32x16_bf16 v[144:159], v[60:63], v[64:67], v[144:159]
    s_waitcnt vmcnt(16)
    s_waitcnt vmcnt(14)
    s_barrier
    ds_read_b128 v[32:35], v24 offset:0
    buffer_load_dwordx4 v[104:107], v4, s[32:35], s42 offen offset:2048 sc1
    ds_read_b64_tr_b16 v[40:41], v20 offset:32768
    v_mfma_f32_32x32x16_bf16 v[160:175], v[56:59], v[68:71], v[160:175]
    ds_read_b64_tr_b16 v[42:43], v20 offset:33792
    ds_read_b128 v[36:39], v24 offset:4096
    v_mfma_f32_32x32x16_bf16 v[176:191], v[60:63], v[68:71], v[176:191]
    ds_read_b64_tr_b16 v[44:45], v21 offset:32768
    ds_read_b64_tr_b16 v[46:47], v21 offset:33792
    v_mfma_f32_32x32x16_bf16 v[192:207], v[56:59], v[72:75], v[192:207]
    s_add_u32 m0, s61, 114688
    s_mov_b32 s62, 2621440
    buffer_load_dwordx4 v11, s[4:7], s62 offen lds
    ds_read_b64_tr_b16 v[48:49], v22 offset:32768
    buffer_load_dwordx4 v[108:111], v4, s[32:35], s42 offen offset:3072 sc1
    s_add_u32 s42, s42, 4096
    v_mfma_f32_32x32x16_bf16 v[208:223], v[60:63], v[72:75], v[208:223]
    s_add_u32 m0, s61, 122880
    s_mov_b32 s62, 2883584
    buffer_load_dwordx4 v11, s[4:7], s62 offen lds
    ds_read_b64_tr_b16 v[50:51], v22 offset:33792
    v_mfma_f32_32x32x16_bf16 v[224:239], v[56:59], v[76:79], v[224:239]
    s_add_u32 m0, s61, 32768
    s_mov_b32 s62, 1048576
    buffer_load_dwordx4 v11, s[4:7], s62 offen lds
    ds_read_b64_tr_b16 v[52:53], v23 offset:32768
    v_mfma_f32_32x32x16_bf16 v[240:255], v[60:63], v[76:79], v[240:255]
    s_add_u32 m0, s61, 40960
    s_mov_b32 s62, 1310720
    buffer_load_dwordx4 v11, s[4:7], s62 offen lds
    ds_read_b64_tr_b16 v[54:55], v23 offset:33792
    s_waitcnt lgkmcnt(7)
    v_mfma_f32_32x32x16_bf16 v[128:143], v[32:35], v[40:43], v[128:143]
    ds_read_b128 v[56:59], v25 offset:0
    ds_read_b64_tr_b16 v[64:65], v20 offset:36864
    s_waitcnt lgkmcnt(8)
    v_mfma_f32_32x32x16_bf16 v[144:159], v[36:39], v[40:43], v[144:159]
    ds_read_b64_tr_b16 v[66:67], v20 offset:37888
    ds_read_b128 v[60:63], v25 offset:4096
    s_waitcnt lgkmcnt(8)
    v_mfma_f32_32x32x16_bf16 v[160:175], v[32:35], v[44:47], v[160:175]
    ds_read_b64_tr_b16 v[68:69], v21 offset:36864
    ds_read_b64_tr_b16 v[70:71], v21 offset:37888
    v_mfma_f32_32x32x16_bf16 v[176:191], v[36:39], v[44:47], v[176:191]
    ds_read_b64_tr_b16 v[72:73], v22 offset:36864
    ds_read_b64_tr_b16 v[74:75], v22 offset:37888
    buffer_load_dwordx4 v[112:115], v4, s[32:35], s42 offen offset:0 sc1
    s_waitcnt lgkmcnt(10)
    v_mfma_f32_32x32x16_bf16 v[192:207], v[32:35], v[48:51], v[192:207]
    ds_read_b64_tr_b16 v[76:77], v23 offset:36864
    ds_read_b64_tr_b16 v[78:79], v23 offset:37888
    v_mfma_f32_32x32x16_bf16 v[208:223], v[36:39], v[48:51], v[208:223]
    s_waitcnt lgkmcnt(10)
    v_mfma_f32_32x32x16_bf16 v[224:239], v[32:35], v[52:55], v[224:239]
    v_mfma_f32_32x32x16_bf16 v[240:255], v[36:39], v[52:55], v[240:255]
    buffer_load_dwordx4 v[116:119], v4, s[32:35], s42 offen offset:1024 sc1
    s_waitcnt lgkmcnt(0)
    v_mfma_f32_32x32x16_bf16 v[128:143], v[56:59], v[64:67], v[128:143]
    v_mfma_f32_32x32x16_bf16 v[144:159], v[60:63], v[64:67], v[144:159]
    s_waitcnt vmcnt(20)
    s_barrier
    ds_read_b128 v[32:35], v26 offset:0
    buffer_load_dwordx4 v[120:123], v4, s[32:35], s42 offen offset:2048 sc1
    ds_read_b64_tr_b16 v[40:41], v20 offset:49152
    v_mfma_f32_32x32x16_bf16 v[160:175], v[56:59], v[68:71], v[160:175]
    ds_read_b64_tr_b16 v[42:43], v20 offset:50176
    ds_read_b128 v[36:39], v26 offset:4096
    v_mfma_f32_32x32x16_bf16 v[176:191], v[60:63], v[68:71], v[176:191]
    ds_read_b64_tr_b16 v[44:45], v21 offset:49152
    ds_read_b64_tr_b16 v[46:47], v21 offset:50176
    v_mfma_f32_32x32x16_bf16 v[192:207], v[56:59], v[72:75], v[192:207]
    s_add_u32 m0, s61, 131072
    s_mov_b32 s62, 3145728
    buffer_load_dwordx4 v11, s[4:7], s62 offen lds
    ds_read_b64_tr_b16 v[48:49], v22 offset:49152
    buffer_load_dwordx4 v[124:127], v4, s[32:35], s42 offen offset:3072 sc1
    s_add_u32 s42, s42, 4096
    v_mfma_f32_32x32x16_bf16 v[208:223], v[60:63], v[72:75], v[208:223]
    s_add_u32 m0, s61, 139264
    s_mov_b32 s62, 3407872
    buffer_load_dwordx4 v11, s[4:7], s62 offen lds
    ds_read_b64_tr_b16 v[50:51], v22 offset:50176
    v_mfma_f32_32x32x16_bf16 v[224:239], v[56:59], v[76:79], v[224:239]
    s_add_u32 m0, s61, 49152
    s_mov_b32 s62, 1572864
    buffer_load_dwordx4 v11, s[4:7], s62 offen lds
    ds_read_b64_tr_b16 v[52:53], v23 offset:49152
    v_mfma_f32_32x32x16_bf16 v[240:255], v[60:63], v[76:79], v[240:255]
    s_add_u32 m0, s61, 57344
    s_mov_b32 s62, 1835008
    buffer_load_dwordx4 v11, s[4:7], s62 offen lds
    ds_read_b64_tr_b16 v[54:55], v23 offset:50176
    s_waitcnt lgkmcnt(7)
    v_mfma_f32_32x32x16_bf16 v[128:143], v[32:35], v[40:43], v[128:143]
    ds_read_b128 v[56:59], v27 offset:0
    ds_read_b64_tr_b16 v[64:65], v20 offset:53248
    s_waitcnt lgkmcnt(8)
    v_mfma_f32_32x32x16_bf16 v[144:159], v[36:39], v[40:43], v[144:159]
    ds_read_b64_tr_b16 v[66:67], v20 offset:54272
    ds_read_b128 v[60:63], v27 offset:4096
    s_waitcnt lgkmcnt(8)
    v_mfma_f32_32x32x16_bf16 v[160:175], v[32:35], v[44:47], v[160:175]
    ds_read_b64_tr_b16 v[68:69], v21 offset:53248
    ds_read_b64_tr_b16 v[70:71], v21 offset:54272
    v_mfma_f32_32x32x16_bf16 v[176:191], v[36:39], v[44:47], v[176:191]
    ds_read_b64_tr_b16 v[72:73], v22 offset:53248
    ds_read_b64_tr_b16 v[74:75], v22 offset:54272
    s_waitcnt lgkmcnt(10)
    v_mfma_f32_32x32x16_bf16 v[192:207], v[32:35], v[48:51], v[192:207]
    ds_read_b64_tr_b16 v[76:77], v23 offset:53248
    ds_read_b64_tr_b16 v[78:79], v23 offset:54272
    v_mfma_f32_32x32x16_bf16 v[208:223], v[36:39], v[48:51], v[208:223]
    s_waitcnt lgkmcnt(10)
    v_mfma_f32_32x32x16_bf16 v[224:239], v[32:35], v[52:55], v[224:239]
    v_mfma_f32_32x32x16_bf16 v[240:255], v[36:39], v[52:55], v[240:255]
    s_waitcnt lgkmcnt(0)
    v_mfma_f32_32x32x16_bf16 v[128:143], v[56:59], v[64:67], v[128:143]
    v_mfma_f32_32x32x16_bf16 v[144:159], v[60:63], v[64:67], v[144:159]
    s_waitcnt vmcnt(16)
    s_barrier
    v_subrev_u32 v20, s67, v20
    v_subrev_u32 v21, s67, v21
    v_subrev_u32 v22, s67, v22
    v_subrev_u32 v23, s67, v23
    v_add_u32 v24, 4294868992, v20
    v_add_u32 v25, 4294868992, v21
    v_add_u32 v26, 4294868992, v22
    v_add_u32 v27, 4294868992, v23
    ds_read_b64_tr_b16 v[32:33], v24 offset:0
    v_mfma_f32_32x32x16_bf16 v[160:175], v[56:59], v[68:71], v[160:175]
    ds_read_b64_tr_b16 v[34:35], v24 offset:1024
    ds_read_b64_tr_b16 v[36:37], v25 offset:0
    v_mfma_f32_32x32x16_bf16 v[176:191], v[60:63], v[68:71], v[176:191]
    ds_read_b64_tr_b16 v[38:39], v25 offset:1024
    ds_read_b64_tr_b16 v[40:41], v26 offset:0
    v_mfma_f32_32x32x16_bf16 v[192:207], v[56:59], v[72:75], v[192:207]
    s_add_u32 m0, s61, 147456
    s_mov_b32 s62, 3670016
    buffer_load_dwordx4 v11, s[4:7], s62 offen lds
    v_mfma_f32_32x32x16_bf16 v[208:223], v[60:63], v[72:75], v[208:223]
    ds_read_b64_tr_b16 v[42:43], v26 offset:1024
    ds_read_b64_tr_b16 v[44:45], v27 offset:0
    v_mfma_f32_32x32x16_bf16 v[224:239], v[56:59], v[76:79], v[224:239]
    s_add_u32 m0, s61, 155648
    s_mov_b32 s62, 3932160
    buffer_load_dwordx4 v11, s[4:7], s62 offen lds
    ds_read_b64_tr_b16 v[46:47], v27 offset:1024
    v_mfma_f32_32x32x16_bf16 v[240:255], v[60:63], v[76:79], v[240:255]
    s_lshl_b32 s48, s45, 6
    s_lshl_b32 s49, s46, 3
    s_add_u32 s48, s48, s49
    s_lshl_b32 s49, s41, 1
    s_add_u32 s48, s48, s49
    s_lshl_b32 s48, s48, 13
    s_add_u32 s17, s48, 16777216
    s_add_u32 s18, s17, 4096
    s_mov_b32 s19, 1024
    s_load_dwordx2 s[20:21], s[0:1], 0
    s_load_dwordx2 s[24:25], s[0:1], 72
    s_load_dwordx2 s[28:29], s[0:1], 40
    v_cvt_pk_bf16_f32 v128, v128, v129
    v_cvt_pk_bf16_f32 v129, v130, v131
    v_cvt_pk_bf16_f32 v130, v132, v133
    v_cvt_pk_bf16_f32 v131, v134, v135
    v_cvt_pk_bf16_f32 v132, v136, v137
    v_cvt_pk_bf16_f32 v133, v138, v139
    v_cvt_pk_bf16_f32 v134, v140, v141
    v_cvt_pk_bf16_f32 v135, v142, v143
    v_cvt_pk_bf16_f32 v136, v144, v145
    v_cvt_pk_bf16_f32 v137, v146, v147
    v_cvt_pk_bf16_f32 v138, v148, v149
    v_cvt_pk_bf16_f32 v139, v150, v151
    v_cvt_pk_bf16_f32 v140, v152, v153
    v_cvt_pk_bf16_f32 v141, v154, v155
    v_cvt_pk_bf16_f32 v142, v156, v157
    v_cvt_pk_bf16_f32 v143, v158, v159
    v_cvt_pk_bf16_f32 v160, v160, v161
    v_cvt_pk_bf16_f32 v161, v162, v163
    v_cvt_pk_bf16_f32 v162, v164, v165
    v_cvt_pk_bf16_f32 v163, v166, v167
    v_cvt_pk_bf16_f32 v164, v168, v169
    v_cvt_pk_bf16_f32 v165, v170, v171
    v_cvt_pk_bf16_f32 v166, v172, v173
    v_cvt_pk_bf16_f32 v167, v174, v175
    v_cvt_pk_bf16_f32 v168, v176, v177
    v_cvt_pk_bf16_f32 v169, v178, v179
    v_cvt_pk_bf16_f32 v170, v180, v181
    v_cvt_pk_bf16_f32 v171, v182, v183
    v_cvt_pk_bf16_f32 v172, v184, v185
    v_cvt_pk_bf16_f32 v173, v186, v187
    v_cvt_pk_bf16_f32 v174, v188, v189
    v_cvt_pk_bf16_f32 v175, v190, v191
    buffer_load_dwordx4 v[64:67], v4, s[32:35], s42 offen offset:0 sc1
    buffer_load_dwordx4 v[68:71], v4, s[32:35], s42 offen offset:1024 sc1
    buffer_load_dwordx4 v[72:75], v4, s[32:35], s42 offen offset:2048 sc1
    buffer_load_dwordx4 v[76:79], v4, s[32:35], s42 offen offset:3072 sc1
    s_add_u32 s42, s42, 4096
    v_cvt_pk_bf16_f32 v192, v192, v193
    v_cvt_pk_bf16_f32 v193, v194, v195
    v_cvt_pk_bf16_f32 v194, v196, v197
    v_cvt_pk_bf16_f32 v195, v198, v199
    v_cvt_pk_bf16_f32 v196, v200, v201
    v_cvt_pk_bf16_f32 v197, v202, v203
    v_cvt_pk_bf16_f32 v198, v204, v205
    v_cvt_pk_bf16_f32 v199, v206, v207
    v_cvt_pk_bf16_f32 v200, v208, v209
    v_cvt_pk_bf16_f32 v201, v210, v211
    v_cvt_pk_bf16_f32 v202, v212, v213
    v_cvt_pk_bf16_f32 v203, v214, v215
    v_cvt_pk_bf16_f32 v204, v216, v217
    v_cvt_pk_bf16_f32 v205, v218, v219
    v_cvt_pk_bf16_f32 v206, v220, v221
    v_cvt_pk_bf16_f32 v207, v222, v223
    v_cvt_pk_bf16_f32 v224, v224, v225
    v_cvt_pk_bf16_f32 v225, v226, v227
    v_cvt_pk_bf16_f32 v226, v228, v229
    v_cvt_pk_bf16_f32 v227, v230, v231
    v_cvt_pk_bf16_f32 v228, v232, v233
    v_cvt_pk_bf16_f32 v229, v234, v235
    v_cvt_pk_bf16_f32 v230, v236, v237
    v_cvt_pk_bf16_f32 v231, v238, v239
    v_cvt_pk_bf16_f32 v232, v240, v241
    v_cvt_pk_bf16_f32 v233, v242, v243
    v_cvt_pk_bf16_f32 v234, v244, v245
    v_cvt_pk_bf16_f32 v235, v246, v247
    v_cvt_pk_bf16_f32 v236, v248, v249
    v_cvt_pk_bf16_f32 v237, v250, v251
    v_cvt_pk_bf16_f32 v238, v252, v253
    v_cvt_pk_bf16_f32 v239, v254, v255
    s_waitcnt lgkmcnt(0)
    v_mfma_f32_32x32x16_bf16 v[144:159], v[32:35], v[80:83], 0
    ds_read_b64_tr_b16 v[48:49], v24 offset:4096
    ds_read_b64_tr_b16 v[50:51], v24 offset:5120
    v_mfma_f32_32x32x16_bf16 v[176:191], v[36:39], v[80:83], 0
    ds_read_b64_tr_b16 v[52:53], v25 offset:4096
    ds_read_b64_tr_b16 v[54:55], v25 offset:5120
    v_mfma_f32_32x32x16_bf16 v[208:223], v[40:43], v[80:83], 0
    ds_read_b64_tr_b16 v[56:57], v26 offset:4096
    ds_read_b64_tr_b16 v[58:59], v26 offset:5120
    v_mfma_f32_32x32x16_bf16 v[240:255], v[44:47], v[80:83], 0
    ds_read_b64_tr_b16 v[60:61], v27 offset:4096
    ds_read_b64_tr_b16 v[62:63], v27 offset:5120
    s_waitcnt lgkmcnt(6)
    v_mfma_f32_32x32x16_bf16 v[144:159], v[48:51], v[84:87], v[144:159]
    ds_read_b64_tr_b16 v[32:33], v24 offset:8192
    ds_read_b64_tr_b16 v[34:35], v24 offset:9216
    buffer_load_dwordx4 v[80:83], v4, s[32:35], s42 offen offset:0 sc1
    s_waitcnt lgkmcnt(6)
    v_mfma_f32_32x32x16_bf16 v[176:191], v[52:55], v[84:87], v[176:191]
    ds_read_b64_tr_b16 v[36:37], v25 offset:8192
    ds_read_b64_tr_b16 v[38:39], v25 offset:9216
    s_waitcnt lgkmcnt(6)
    v_mfma_f32_32x32x16_bf16 v[208:223], v[56:59], v[84:87], v[208:223]
    ds_read_b64_tr_b16 v[40:41], v26 offset:8192
    ds_read_b64_tr_b16 v[42:43], v26 offset:9216
    s_mov_b32 s22, 0x200000
    s_mov_b32 s26, 0x200000
    s_mov_b32 s30, 0x400000
    s_waitcnt lgkmcnt(6)
    v_mfma_f32_32x32x16_bf16 v[240:255], v[60:63], v[84:87], v[240:255]
    ds_read_b64_tr_b16 v[44:45], v27 offset:8192
    ds_read_b64_tr_b16 v[46:47], v27 offset:9216
    s_waitcnt lgkmcnt(6)
    v_mfma_f32_32x32x16_bf16 v[144:159], v[32:35], v[88:91], v[144:159]
    ds_read_b64_tr_b16 v[48:49], v24 offset:12288
    ds_read_b64_tr_b16 v[50:51], v24 offset:13312
    buffer_load_dwordx4 v[84:87], v4, s[32:35], s42 offen offset:1024 sc1
    s_waitcnt lgkmcnt(6)
    v_mfma_f32_32x32x16_bf16 v[176:191], v[36:39], v[88:91], v[176:191]
    ds_read_b64_tr_b16 v[52:53], v25 offset:12288
    ds_read_b64_tr_b16 v[54:55], v25 offset:13312
    s_waitcnt lgkmcnt(6)
    v_mfma_f32_32x32x16_bf16 v[208:223], v[40:43], v[88:91], v[208:223]
    ds_read_b64_tr_b16 v[56:57], v26 offset:12288
    ds_read_b64_tr_b16 v[58:59], v26 offset:13312
    s_waitcnt lgkmcnt(6)
    v_mfma_f32_32x32x16_bf16 v[240:255], v[44:47], v[88:91], v[240:255]
    ds_read_b64_tr_b16 v[60:61], v27 offset:12288
    ds_read_b64_tr_b16 v[62:63], v27 offset:13312
    s_waitcnt lgkmcnt(6)
    v_mfma_f32_32x32x16_bf16 v[144:159], v[48:51], v[92:95], v[144:159]
    ds_read_b64_tr_b16 v[32:33], v24 offset:16384
    ds_read_b64_tr_b16 v[34:35], v24 offset:17408
    buffer_load_dwordx4 v[88:91], v4, s[32:35], s42 offen offset:2048 sc1
    s_waitcnt lgkmcnt(6)
    v_mfma_f32_32x32x16_bf16 v[176:191], v[52:55], v[92:95], v[176:191]
    ds_read_b64_tr_b16 v[36:37], v25 offset:16384
    ds_read_b64_tr_b16 v[38:39], v25 offset:17408
    s_waitcnt lgkmcnt(6)
    v_mfma_f32_32x32x16_bf16 v[208:223], v[56:59], v[92:95], v[208:223]
    ds_read_b64_tr_b16 v[40:41], v26 offset:16384
    ds_read_b64_tr_b16 v[42:43], v26 offset:17408
    s_waitcnt lgkmcnt(6)
    v_mfma_f32_32x32x16_bf16 v[240:255], v[60:63], v[92:95], v[240:255]
    ds_read_b64_tr_b16 v[44:45], v27 offset:16384
    ds_read_b64_tr_b16 v[46:47], v27 offset:17408
    s_waitcnt vmcnt(24) lgkmcnt(6)
    v_mfma_f32_32x32x16_bf16 v[144:159], v[32:35], v[96:99], v[144:159]
    ds_read_b64_tr_b16 v[48:49], v24 offset:20480
    ds_read_b64_tr_b16 v[50:51], v24 offset:21504
    buffer_load_dwordx4 v[92:95], v4, s[32:35], s42 offen offset:3072 sc1
    s_add_u32 s42, s42, 4096
    s_waitcnt lgkmcnt(6)
    v_mfma_f32_32x32x16_bf16 v[176:191], v[36:39], v[96:99], v[176:191]
    ds_read_b64_tr_b16 v[52:53], v25 offset:20480
    ds_read_b64_tr_b16 v[54:55], v25 offset:21504
    s_waitcnt lgkmcnt(6)
    v_mfma_f32_32x32x16_bf16 v[208:223], v[40:43], v[96:99], v[208:223]
    ds_read_b64_tr_b16 v[56:57], v26 offset:20480
    ds_read_b64_tr_b16 v[58:59], v26 offset:21504
    s_waitcnt lgkmcnt(6)
    v_mfma_f32_32x32x16_bf16 v[240:255], v[44:47], v[96:99], v[240:255]
    ds_read_b64_tr_b16 v[60:61], v27 offset:20480
    ds_read_b64_tr_b16 v[62:63], v27 offset:21504
    s_waitcnt vmcnt(24) lgkmcnt(6)
    v_mfma_f32_32x32x16_bf16 v[144:159], v[48:51], v[100:103], v[144:159]
    ds_read_b64_tr_b16 v[32:33], v24 offset:24576
    ds_read_b64_tr_b16 v[34:35], v24 offset:25600
    buffer_load_dwordx4 v[96:99], v4, s[32:35], s42 offen offset:0 sc1
    s_waitcnt lgkmcnt(6)
    v_mfma_f32_32x32x16_bf16 v[176:191], v[52:55], v[100:103], v[176:191]
    ds_read_b64_tr_b16 v[36:37], v25 offset:24576
    ds_read_b64_tr_b16 v[38:39], v25 offset:25600
    s_waitcnt lgkmcnt(6)
    v_mfma_f32_32x32x16_bf16 v[208:223], v[56:59], v[100:103], v[208:223]
    ds_read_b64_tr_b16 v[40:41], v26 offset:24576
    ds_read_b64_tr_b16 v[42:43], v26 offset:25600
    s_waitcnt lgkmcnt(6)
    v_mfma_f32_32x32x16_bf16 v[240:255], v[60:63], v[100:103], v[240:255]
    ds_read_b64_tr_b16 v[44:45], v27 offset:24576
    ds_read_b64_tr_b16 v[46:47], v27 offset:25600
    s_waitcnt vmcnt(24) lgkmcnt(6)
    v_mfma_f32_32x32x16_bf16 v[144:159], v[32:35], v[104:107], v[144:159]
    ds_read_b64_tr_b16 v[48:49], v24 offset:28672
    ds_read_b64_tr_b16 v[50:51], v24 offset:29696
    buffer_load_dwordx4 v[100:103], v4, s[32:35], s42 offen offset:1024 sc1
    s_waitcnt lgkmcnt(6)
    v_mfma_f32_32x32x16_bf16 v[176:191], v[36:39], v[104:107], v[176:191]
    ds_read_b64_tr_b16 v[52:53], v25 offset:28672
    ds_read_b64_tr_b16 v[54:55], v25 offset:29696
    s_waitcnt lgkmcnt(6)
    v_mfma_f32_32x32x16_bf16 v[208:223], v[40:43], v[104:107], v[208:223]
    ds_read_b64_tr_b16 v[56:57], v26 offset:28672
    ds_read_b64_tr_b16 v[58:59], v26 offset:29696
    s_waitcnt lgkmcnt(6)
    v_mfma_f32_32x32x16_bf16 v[240:255], v[44:47], v[104:107], v[240:255]
    ds_read_b64_tr_b16 v[60:61], v27 offset:28672
    ds_read_b64_tr_b16 v[62:63], v27 offset:29696
    s_waitcnt lgkmcnt(0)
    s_waitcnt vmcnt(23)
    v_mfma_f32_32x32x16_bf16 v[144:159], v[48:51], v[108:111], v[144:159]
    s_waitcnt vmcnt(12)
    s_barrier
    ds_read_b64_tr_b16 v[32:33], v24 offset:32768
    ds_read_b64_tr_b16 v[34:35], v24 offset:33792
    buffer_load_dwordx4 v[104:107], v4, s[32:35], s42 offen offset:2048 sc1
    v_mfma_f32_32x32x16_bf16 v[176:191], v[52:55], v[108:111], v[176:191]
    ds_read_b64_tr_b16 v[36:37], v25 offset:32768
    ds_read_b64_tr_b16 v[38:39], v25 offset:33792
    v_mfma_f32_32x32x16_bf16 v[208:223], v[56:59], v[108:111], v[208:223]
    ds_read_b64_tr_b16 v[40:41], v26 offset:32768
    ds_read_b64_tr_b16 v[42:43], v26 offset:33792
    v_mfma_f32_32x32x16_bf16 v[240:255], v[60:63], v[108:111], v[240:255]
    ds_read_b64_tr_b16 v[44:45], v27 offset:32768
    ds_read_b64_tr_b16 v[46:47], v27 offset:33792
    s_waitcnt lgkmcnt(6)
    v_mfma_f32_32x32x16_bf16 v[144:159], v[32:35], v[112:115], v[144:159]
    ds_read_b64_tr_b16 v[48:49], v24 offset:36864
    ds_read_b64_tr_b16 v[50:51], v24 offset:37888
    buffer_load_dwordx4 v[108:111], v4, s[32:35], s42 offen offset:3072 sc1
    s_add_u32 s42, s42, 4096
    s_waitcnt lgkmcnt(6)
    v_mfma_f32_32x32x16_bf16 v[176:191], v[36:39], v[112:115], v[176:191]
    ds_read_b64_tr_b16 v[52:53], v25 offset:36864
    ds_read_b64_tr_b16 v[54:55], v25 offset:37888
    s_waitcnt lgkmcnt(6)
    v_mfma_f32_32x32x16_bf16 v[208:223], v[40:43], v[112:115], v[208:223]
    ds_read_b64_tr_b16 v[56:57], v26 offset:36864
    ds_read_b64_tr_b16 v[58:59], v26 offset:37888
    s_waitcnt lgkmcnt(6)
    v_mfma_f32_32x32x16_bf16 v[240:255], v[44:47], v[112:115], v[240:255]
    ds_read_b64_tr_b16 v[60:61], v27 offset:36864
    ds_read_b64_tr_b16 v[62:63], v27 offset:37888
    s_waitcnt lgkmcnt(6)
    v_mfma_f32_32x32x16_bf16 v[144:159], v[48:51], v[116:119], v[144:159]
    ds_read_b64_tr_b16 v[32:33], v24 offset:40960
    ds_read_b64_tr_b16 v[34:35], v24 offset:41984
    buffer_load_dwordx4 v[112:115], v4, s[32:35], s42 offen offset:0 sc1
    s_lshl_b32 s60, s44, 11
    s_mov_b32 s50, 0
    s_lshl_b32 s51, s46, 1
    s_waitcnt lgkmcnt(6)
    v_mfma_f32_32x32x16_bf16 v[176:191], v[52:55], v[116:119], v[176:191]
    ds_read_b64_tr_b16 v[36:37], v25 offset:40960
    ds_read_b64_tr_b16 v[38:39], v25 offset:41984
    s_add_u32 s51, s51, 2
    s_lshl_b32 s52, s47, 1
    s_add_u32 s52, s52, 2
    s_waitcnt lgkmcnt(6)
    v_mfma_f32_32x32x16_bf16 v[208:223], v[56:59], v[116:119], v[208:223]
    ds_read_b64_tr_b16 v[40:41], v26 offset:40960
    ds_read_b64_tr_b16 v[42:43], v26 offset:41984
    s_add_u32 s53, s60, 32768
    s_lshl_b32 s54, s45, 19
    s_add_u32 s55, s54, 16777216
    s_add_u32 s59, s60, 98304
    s_mov_b32 s57, s58
    s_mov_b32 s73, s58
    s_waitcnt lgkmcnt(6)
    v_mfma_f32_32x32x16_bf16 v[240:255], v[60:63], v[116:119], v[240:255]
    ds_read_b64_tr_b16 v[44:45], v27 offset:40960
    ds_read_b64_tr_b16 v[46:47], v27 offset:41984
    s_mov_b32 s75, -1
    s_waitcnt lgkmcnt(6)
    v_mfma_f32_32x32x16_bf16 v[144:159], v[32:35], v[120:123], v[144:159]
    ds_read_b64_tr_b16 v[48:49], v24 offset:45056
    ds_read_b64_tr_b16 v[50:51], v24 offset:46080
    buffer_load_dwordx4 v[116:119], v4, s[32:35], s42 offen offset:1024 sc1
    s_waitcnt lgkmcnt(6)
    v_mfma_f32_32x32x16_bf16 v[176:191], v[36:39], v[120:123], v[176:191]
    ds_read_b64_tr_b16 v[52:53], v25 offset:45056
    ds_read_b64_tr_b16 v[54:55], v25 offset:46080
    s_waitcnt lgkmcnt(6)
    v_mfma_f32_32x32x16_bf16 v[208:223], v[40:43], v[120:123], v[208:223]
    ds_read_b64_tr_b16 v[56:57], v26 offset:45056
    ds_read_b64_tr_b16 v[58:59], v26 offset:46080
    s_waitcnt lgkmcnt(6)
    v_mfma_f32_32x32x16_bf16 v[240:255], v[44:47], v[120:123], v[240:255]
    ds_read_b64_tr_b16 v[60:61], v27 offset:45056
    ds_read_b64_tr_b16 v[62:63], v27 offset:46080
    s_waitcnt lgkmcnt(6)
    v_mfma_f32_32x32x16_bf16 v[144:159], v[48:51], v[124:127], v[144:159]
    ds_read_b64_tr_b16 v[32:33], v24 offset:49152
    ds_read_b64_tr_b16 v[34:35], v24 offset:50176
    buffer_load_dwordx4 v[120:123], v4, s[32:35], s42 offen offset:2048 sc1
    s_waitcnt lgkmcnt(6)
    v_mfma_f32_32x32x16_bf16 v[176:191], v[52:55], v[124:127], v[176:191]
    ds_read_b64_tr_b16 v[36:37], v25 offset:49152
    ds_read_b64_tr_b16 v[38:39], v25 offset:50176
    s_waitcnt lgkmcnt(6)
    v_mfma_f32_32x32x16_bf16 v[208:223], v[56:59], v[124:127], v[208:223]
    ds_read_b64_tr_b16 v[40:41], v26 offset:49152
    ds_read_b64_tr_b16 v[42:43], v26 offset:50176
    s_waitcnt lgkmcnt(6)
    v_mfma_f32_32x32x16_bf16 v[240:255], v[60:63], v[124:127], v[240:255]
    ds_read_b64_tr_b16 v[44:45], v27 offset:49152
    ds_read_b64_tr_b16 v[46:47], v27 offset:50176
    s_waitcnt vmcnt(14) lgkmcnt(6)
    v_mfma_f32_32x32x16_bf16 v[144:159], v[32:35], v[64:67], v[144:159]
    ds_read_b64_tr_b16 v[48:49], v24 offset:53248
    ds_read_b64_tr_b16 v[50:51], v24 offset:54272
    buffer_load_dwordx4 v[124:127], v4, s[32:35], s42 offen offset:3072 sc1
    s_add_u32 s42, s42, 4096
    s_waitcnt lgkmcnt(6)
    v_mfma_f32_32x32x16_bf16 v[176:191], v[36:39], v[64:67], v[176:191]
    ds_read_b64_tr_b16 v[52:53], v25 offset:53248
    ds_read_b64_tr_b16 v[54:55], v25 offset:54272
    s_waitcnt lgkmcnt(6)
    v_mfma_f32_32x32x16_bf16 v[208:223], v[40:43], v[64:67], v[208:223]
    ds_read_b64_tr_b16 v[56:57], v26 offset:53248
    ds_read_b64_tr_b16 v[58:59], v26 offset:54272
    s_waitcnt lgkmcnt(6)
    v_mfma_f32_32x32x16_bf16 v[240:255], v[44:47], v[64:67], v[240:255]
    ds_read_b64_tr_b16 v[60:61], v27 offset:53248
    ds_read_b64_tr_b16 v[62:63], v27 offset:54272
    s_waitcnt vmcnt(14) lgkmcnt(6)
    v_mfma_f32_32x32x16_bf16 v[144:159], v[48:51], v[68:71], v[144:159]
    ds_read_b64_tr_b16 v[32:33], v24 offset:57344
    ds_read_b64_tr_b16 v[34:35], v24 offset:58368
    buffer_store_dwordx4 v[128:131], v4, s[32:35], s17 offen sc1
    s_waitcnt lgkmcnt(6)
    v_mfma_f32_32x32x16_bf16 v[176:191], v[52:55], v[68:71], v[176:191]
    ds_read_b64_tr_b16 v[36:37], v25 offset:57344
    ds_read_b64_tr_b16 v[38:39], v25 offset:58368
    s_waitcnt lgkmcnt(6)
    v_mfma_f32_32x32x16_bf16 v[208:223], v[56:59], v[68:71], v[208:223]
    ds_read_b64_tr_b16 v[40:41], v26 offset:57344
    ds_read_b64_tr_b16 v[42:43], v26 offset:58368
    buffer_load_dwordx4 v[64:67], v4, s[32:35], s42 offen offset:0 sc1
    s_waitcnt lgkmcnt(6)
    v_mfma_f32_32x32x16_bf16 v[240:255], v[60:63], v[68:71], v[240:255]
    ds_read_b64_tr_b16 v[44:45], v27 offset:57344
    ds_read_b64_tr_b16 v[46:47], v27 offset:58368
    s_waitcnt vmcnt(15) lgkmcnt(6)
    v_mfma_f32_32x32x16_bf16 v[144:159], v[32:35], v[72:75], v[144:159]
    ds_read_b64_tr_b16 v[48:49], v24 offset:61440
    ds_read_b64_tr_b16 v[50:51], v24 offset:62464
    buffer_store_dwordx4 v[132:135], v4, s[32:35], s18 offen sc1
    s_waitcnt lgkmcnt(6)
    v_mfma_f32_32x32x16_bf16 v[176:191], v[36:39], v[72:75], v[176:191]
    ds_read_b64_tr_b16 v[52:53], v25 offset:61440
    ds_read_b64_tr_b16 v[54:55], v25 offset:62464
    s_waitcnt lgkmcnt(6)
    v_mfma_f32_32x32x16_bf16 v[208:223], v[40:43], v[72:75], v[208:223]
    ds_read_b64_tr_b16 v[56:57], v26 offset:61440
    ds_read_b64_tr_b16 v[58:59], v26 offset:62464
    buffer_load_dwordx4 v[68:71], v4, s[32:35], s42 offen offset:1024 sc1
    s_waitcnt lgkmcnt(6)
    v_mfma_f32_32x32x16_bf16 v[240:255], v[44:47], v[72:75], v[240:255]
    ds_read_b64_tr_b16 v[60:61], v27 offset:61440
    ds_read_b64_tr_b16 v[62:63], v27 offset:62464
    s_waitcnt lgkmcnt(0)
    s_waitcnt vmcnt(16)
    v_mfma_f32_32x32x16_bf16 v[144:159], v[48:51], v[76:79], v[144:159]
    s_barrier
    ds_read_b64_tr_b16 v[32:33], v20 offset:0
    ds_read_b64_tr_b16 v[34:35], v20 offset:1024
    buffer_store_dwordx4 v[136:139], v9, s[32:35], s17 offen sc1
    v_mfma_f32_32x32x16_bf16 v[176:191], v[52:55], v[76:79], v[176:191]
    ds_read_b64_tr_b16 v[36:37], v21 offset:0
    ds_read_b64_tr_b16 v[38:39], v21 offset:1024
    v_mfma_f32_32x32x16_bf16 v[208:223], v[56:59], v[76:79], v[208:223]
    ds_read_b64_tr_b16 v[40:41], v22 offset:0
    ds_read_b64_tr_b16 v[42:43], v22 offset:1024
    buffer_load_dwordx4 v[72:75], v4, s[32:35], s42 offen offset:2048 sc1
    v_mfma_f32_32x32x16_bf16 v[240:255], v[60:63], v[76:79], v[240:255]
    ds_read_b64_tr_b16 v[44:45], v23 offset:0
    ds_read_b64_tr_b16 v[46:47], v23 offset:1024
    s_waitcnt vmcnt(17) lgkmcnt(6)
    v_mfma_f32_32x32x16_bf16 v[144:159], v[32:35], v[80:83], v[144:159]
    ds_read_b64_tr_b16 v[48:49], v20 offset:4096
    ds_read_b64_tr_b16 v[50:51], v20 offset:5120
    buffer_store_dwordx4 v[140:143], v9, s[32:35], s18 offen sc1
    s_add_u32 s17, s17, s19
    s_add_u32 s18, s18, s19
    s_waitcnt lgkmcnt(6)
    v_mfma_f32_32x32x16_bf16 v[176:191], v[36:39], v[80:83], v[176:191]
    ds_read_b64_tr_b16 v[52:53], v21 offset:4096
    ds_read_b64_tr_b16 v[54:55], v21 offset:5120
    buffer_load_dwordx4 v[76:79], v4, s[32:35], s42 offen offset:3072 sc1
    s_add_u32 s42, s42, 4096
    s_waitcnt lgkmcnt(6)
    v_mfma_f32_32x32x16_bf16 v[208:223], v[40:43], v[80:83], v[208:223]
    ds_read_b64_tr_b16 v[56:57], v22 offset:4096
    ds_read_b64_tr_b16 v[58:59], v22 offset:5120
    v_lshrrev_b32 v29, 5, v1
    v_lshlrev_b32 v29, 10, v29
    s_waitcnt lgkmcnt(6)
    v_mfma_f32_32x32x16_bf16 v[240:255], v[44:47], v[80:83], v[240:255]
    ds_read_b64_tr_b16 v[60:61], v23 offset:4096
    ds_read_b64_tr_b16 v[62:63], v23 offset:5120
    v_sub_u32 v24, v24, v29
    v_sub_u32 v25, v25, v29
    v_sub_u32 v26, v26, v29
    v_sub_u32 v27, v27, v29
    s_waitcnt vmcnt(18) lgkmcnt(6)
    v_mfma_f32_32x32x16_bf16 v[144:159], v[48:51], v[84:87], v[144:159]
    ds_read_b64_tr_b16 v[32:33], v20 offset:8192
    ds_read_b64_tr_b16 v[34:35], v20 offset:9216
    buffer_store_dwordx4 v[160:163], v4, s[32:35], s17 offen sc1
    s_waitcnt lgkmcnt(6)
    v_mfma_f32_32x32x16_bf16 v[176:191], v[52:55], v[84:87], v[176:191]
    ds_read_b64_tr_b16 v[36:37], v21 offset:8192
    ds_read_b64_tr_b16 v[38:39], v21 offset:9216
    s_waitcnt lgkmcnt(6)
    v_mfma_f32_32x32x16_bf16 v[208:223], v[56:59], v[84:87], v[208:223]
    ds_read_b64_tr_b16 v[40:41], v22 offset:8192
    ds_read_b64_tr_b16 v[42:43], v22 offset:9216
    s_waitcnt lgkmcnt(6)
    v_mfma_f32_32x32x16_bf16 v[240:255], v[60:63], v[84:87], v[240:255]
    ds_read_b64_tr_b16 v[44:45], v23 offset:8192
    ds_read_b64_tr_b16 v[46:47], v23 offset:9216
    s_waitcnt vmcnt(18) lgkmcnt(6)
    v_mfma_f32_32x32x16_bf16 v[144:159], v[32:35], v[88:91], v[144:159]
    ds_read_b64_tr_b16 v[48:49], v20 offset:12288
    ds_read_b64_tr_b16 v[50:51], v20 offset:13312
    buffer_store_dwordx4 v[164:167], v4, s[32:35], s18 offen sc1
    s_waitcnt lgkmcnt(6)
    v_mfma_f32_32x32x16_bf16 v[176:191], v[36:39], v[88:91], v[176:191]
    ds_read_b64_tr_b16 v[52:53], v21 offset:12288
    ds_read_b64_tr_b16 v[54:55], v21 offset:13312
    s_waitcnt lgkmcnt(6)
    v_mfma_f32_32x32x16_bf16 v[208:223], v[40:43], v[88:91], v[208:223]
    ds_read_b64_tr_b16 v[56:57], v22 offset:12288
    ds_read_b64_tr_b16 v[58:59], v22 offset:13312
    s_waitcnt lgkmcnt(6)
    v_mfma_f32_32x32x16_bf16 v[240:255], v[44:47], v[88:91], v[240:255]
    ds_read_b64_tr_b16 v[60:61], v23 offset:12288
    ds_read_b64_tr_b16 v[62:63], v23 offset:13312
    s_waitcnt vmcnt(18) lgkmcnt(6)
    v_mfma_f32_32x32x16_bf16 v[144:159], v[48:51], v[92:95], v[144:159]
    ds_read_b64_tr_b16 v[32:33], v20 offset:16384
    ds_read_b64_tr_b16 v[34:35], v20 offset:17408
    buffer_store_dwordx4 v[168:171], v9, s[32:35], s17 offen sc1
    s_waitcnt lgkmcnt(6)
    v_mfma_f32_32x32x16_bf16 v[176:191], v[52:55], v[92:95], v[176:191]
    ds_read_b64_tr_b16 v[36:37], v21 offset:16384
    ds_read_b64_tr_b16 v[38:39], v21 offset:17408
    s_waitcnt lgkmcnt(6)
    v_mfma_f32_32x32x16_bf16 v[208:223], v[56:59], v[92:95], v[208:223]
    ds_read_b64_tr_b16 v[40:41], v22 offset:16384
    ds_read_b64_tr_b16 v[42:43], v22 offset:17408
    s_waitcnt lgkmcnt(6)
    v_mfma_f32_32x32x16_bf16 v[240:255], v[60:63], v[92:95], v[240:255]
    ds_read_b64_tr_b16 v[44:45], v23 offset:16384
    ds_read_b64_tr_b16 v[46:47], v23 offset:17408
    s_waitcnt vmcnt(18) lgkmcnt(6)
    v_mfma_f32_32x32x16_bf16 v[144:159], v[32:35], v[96:99], v[144:159]
    ds_read_b64_tr_b16 v[48:49], v20 offset:20480
    ds_read_b64_tr_b16 v[50:51], v20 offset:21504
    buffer_store_dwordx4 v[172:175], v9, s[32:35], s18 offen sc1
    s_add_u32 s17, s17, s19
    s_add_u32 s18, s18, s19
    s_waitcnt lgkmcnt(6)
    v_mfma_f32_32x32x16_bf16 v[176:191], v[36:39], v[96:99], v[176:191]
    ds_read_b64_tr_b16 v[52:53], v21 offset:20480
    ds_read_b64_tr_b16 v[54:55], v21 offset:21504
    s_waitcnt lgkmcnt(6)
    v_mfma_f32_32x32x16_bf16 v[208:223], v[40:43], v[96:99], v[208:223]
    ds_read_b64_tr_b16 v[56:57], v22 offset:20480
    ds_read_b64_tr_b16 v[58:59], v22 offset:21504
    s_waitcnt lgkmcnt(6)
    v_mfma_f32_32x32x16_bf16 v[240:255], v[44:47], v[96:99], v[240:255]
    ds_read_b64_tr_b16 v[60:61], v23 offset:20480
    ds_read_b64_tr_b16 v[62:63], v23 offset:21504
    s_waitcnt vmcnt(18) lgkmcnt(6)
    v_mfma_f32_32x32x16_bf16 v[144:159], v[48:51], v[100:103], v[144:159]
    ds_read_b64_tr_b16 v[32:33], v20 offset:24576
    ds_read_b64_tr_b16 v[34:35], v20 offset:25600
    buffer_store_dwordx4 v[192:195], v4, s[32:35], s17 offen sc1
    s_waitcnt lgkmcnt(6)
    v_mfma_f32_32x32x16_bf16 v[176:191], v[52:55], v[100:103], v[176:191]
    ds_read_b64_tr_b16 v[36:37], v21 offset:24576
    ds_read_b64_tr_b16 v[38:39], v21 offset:25600
    s_waitcnt lgkmcnt(6)
    v_mfma_f32_32x32x16_bf16 v[208:223], v[56:59], v[100:103], v[208:223]
    ds_read_b64_tr_b16 v[40:41], v22 offset:24576
    ds_read_b64_tr_b16 v[42:43], v22 offset:25600
    s_waitcnt lgkmcnt(6)
    v_mfma_f32_32x32x16_bf16 v[240:255], v[60:63], v[100:103], v[240:255]
    ds_read_b64_tr_b16 v[44:45], v23 offset:24576
    ds_read_b64_tr_b16 v[46:47], v23 offset:25600
    s_waitcnt vmcnt(18) lgkmcnt(6)
    v_mfma_f32_32x32x16_bf16 v[144:159], v[32:35], v[104:107], v[144:159]
    ds_read_b64_tr_b16 v[48:49], v20 offset:28672
    ds_read_b64_tr_b16 v[50:51], v20 offset:29696
    buffer_store_dwordx4 v[196:199], v4, s[32:35], s18 offen sc1
    s_waitcnt lgkmcnt(6)
    v_mfma_f32_32x32x16_bf16 v[176:191], v[36:39], v[104:107], v[176:191]
    ds_read_b64_tr_b16 v[52:53], v21 offset:28672
    ds_read_b64_tr_b16 v[54:55], v21 offset:29696
    s_waitcnt lgkmcnt(6)
    v_mfma_f32_32x32x16_bf16 v[208:223], v[40:43], v[104:107], v[208:223]
    ds_read_b64_tr_b16 v[56:57], v22 offset:28672
    ds_read_b64_tr_b16 v[58:59], v22 offset:29696
    s_waitcnt lgkmcnt(6)
    v_mfma_f32_32x32x16_bf16 v[240:255], v[44:47], v[104:107], v[240:255]
    ds_read_b64_tr_b16 v[60:61], v23 offset:28672
    ds_read_b64_tr_b16 v[62:63], v23 offset:29696
    s_waitcnt lgkmcnt(0)
    s_waitcnt vmcnt(18)
    v_mfma_f32_32x32x16_bf16 v[144:159], v[48:51], v[108:111], v[144:159]
    s_barrier
    ds_read_b64_tr_b16 v[32:33], v20 offset:32768
    ds_read_b64_tr_b16 v[34:35], v20 offset:33792
    v_mov_b32 v19, 1
    buffer_store_dword v19, v28, s[32:35], s16 offen sc1
    v_mfma_f32_32x32x16_bf16 v[176:191], v[52:55], v[108:111], v[176:191]
    ds_read_b64_tr_b16 v[36:37], v21 offset:32768
    ds_read_b64_tr_b16 v[38:39], v21 offset:33792
    v_mfma_f32_32x32x16_bf16 v[208:223], v[56:59], v[108:111], v[208:223]
    ds_read_b64_tr_b16 v[40:41], v22 offset:32768
    ds_read_b64_tr_b16 v[42:43], v22 offset:33792
    buffer_store_dwordx4 v[200:203], v9, s[32:35], s17 offen sc1
    v_mfma_f32_32x32x16_bf16 v[240:255], v[60:63], v[108:111], v[240:255]
    ds_read_b64_tr_b16 v[44:45], v23 offset:32768
    ds_read_b64_tr_b16 v[46:47], v23 offset:33792
    s_waitcnt vmcnt(19) lgkmcnt(6)
    v_mfma_f32_32x32x16_bf16 v[144:159], v[32:35], v[112:115], v[144:159]
    ds_read_b64_tr_b16 v[48:49], v20 offset:36864
    ds_read_b64_tr_b16 v[50:51], v20 offset:37888
    buffer_store_dwordx4 v[204:207], v9, s[32:35], s18 offen sc1
    s_add_u32 s17, s17, s19
    s_add_u32 s18, s18, s19
    s_waitcnt lgkmcnt(6)
    v_mfma_f32_32x32x16_bf16 v[176:191], v[36:39], v[112:115], v[176:191]
    ds_read_b64_tr_b16 v[52:53], v21 offset:36864
    ds_read_b64_tr_b16 v[54:55], v21 offset:37888
    s_waitcnt lgkmcnt(6)
    v_mfma_f32_32x32x16_bf16 v[208:223], v[40:43], v[112:115], v[208:223]
    ds_read_b64_tr_b16 v[56:57], v22 offset:36864
    ds_read_b64_tr_b16 v[58:59], v22 offset:37888
    s_waitcnt lgkmcnt(6)
    v_mfma_f32_32x32x16_bf16 v[240:255], v[44:47], v[112:115], v[240:255]
    ds_read_b64_tr_b16 v[60:61], v23 offset:36864
    ds_read_b64_tr_b16 v[62:63], v23 offset:37888
    s_waitcnt vmcnt(19) lgkmcnt(6)
    v_mfma_f32_32x32x16_bf16 v[144:159], v[48:51], v[116:119], v[144:159]
    ds_read_b64_tr_b16 v[32:33], v20 offset:40960
    ds_read_b64_tr_b16 v[34:35], v20 offset:41984
    buffer_store_dwordx4 v[224:227], v4, s[32:35], s17 offen sc1
    s_waitcnt lgkmcnt(6)
    v_mfma_f32_32x32x16_bf16 v[176:191], v[52:55], v[116:119], v[176:191]
    ds_read_b64_tr_b16 v[36:37], v21 offset:40960
    ds_read_b64_tr_b16 v[38:39], v21 offset:41984
    s_waitcnt lgkmcnt(6)
    v_mfma_f32_32x32x16_bf16 v[208:223], v[56:59], v[116:119], v[208:223]
    ds_read_b64_tr_b16 v[40:41], v22 offset:40960
    ds_read_b64_tr_b16 v[42:43], v22 offset:41984
    s_waitcnt lgkmcnt(6)
    v_mfma_f32_32x32x16_bf16 v[240:255], v[60:63], v[116:119], v[240:255]
    ds_read_b64_tr_b16 v[44:45], v23 offset:40960
    ds_read_b64_tr_b16 v[46:47], v23 offset:41984
    s_waitcnt vmcnt(19) lgkmcnt(6)
    v_mfma_f32_32x32x16_bf16 v[144:159], v[32:35], v[120:123], v[144:159]
    ds_read_b64_tr_b16 v[48:49], v20 offset:45056
    ds_read_b64_tr_b16 v[50:51], v20 offset:46080
    buffer_store_dwordx4 v[228:231], v4, s[32:35], s18 offen sc1
    s_waitcnt lgkmcnt(6)
    v_mfma_f32_32x32x16_bf16 v[176:191], v[36:39], v[120:123], v[176:191]
    ds_read_b64_tr_b16 v[52:53], v21 offset:45056
    ds_read_b64_tr_b16 v[54:55], v21 offset:46080
    s_waitcnt lgkmcnt(6)
    v_mfma_f32_32x32x16_bf16 v[208:223], v[40:43], v[120:123], v[208:223]
    ds_read_b64_tr_b16 v[56:57], v22 offset:45056
    ds_read_b64_tr_b16 v[58:59], v22 offset:46080
    s_waitcnt lgkmcnt(6)
    v_mfma_f32_32x32x16_bf16 v[240:255], v[44:47], v[120:123], v[240:255]
    ds_read_b64_tr_b16 v[60:61], v23 offset:45056
    ds_read_b64_tr_b16 v[62:63], v23 offset:46080
    s_waitcnt vmcnt(19) lgkmcnt(6)
    v_mfma_f32_32x32x16_bf16 v[144:159], v[48:51], v[124:127], v[144:159]
    ds_read_b64_tr_b16 v[32:33], v20 offset:49152
    ds_read_b64_tr_b16 v[34:35], v20 offset:50176
    buffer_store_dwordx4 v[232:235], v9, s[32:35], s17 offen sc1
    s_waitcnt lgkmcnt(6)
    v_mfma_f32_32x32x16_bf16 v[176:191], v[52:55], v[124:127], v[176:191]
    ds_read_b64_tr_b16 v[36:37], v21 offset:49152
    ds_read_b64_tr_b16 v[38:39], v21 offset:50176
    s_waitcnt lgkmcnt(6)
    v_mfma_f32_32x32x16_bf16 v[208:223], v[56:59], v[124:127], v[208:223]
    ds_read_b64_tr_b16 v[40:41], v22 offset:49152
    ds_read_b64_tr_b16 v[42:43], v22 offset:50176
    s_waitcnt lgkmcnt(6)
    v_mfma_f32_32x32x16_bf16 v[240:255], v[60:63], v[124:127], v[240:255]
    ds_read_b64_tr_b16 v[44:45], v23 offset:49152
    ds_read_b64_tr_b16 v[46:47], v23 offset:50176
    s_waitcnt vmcnt(18) lgkmcnt(6)
    v_mfma_f32_32x32x16_bf16 v[144:159], v[32:35], v[64:67], v[144:159]
    ds_read_b64_tr_b16 v[48:49], v20 offset:53248
    ds_read_b64_tr_b16 v[50:51], v20 offset:54272
    buffer_store_dwordx4 v[236:239], v9, s[32:35], s18 offen sc1
    s_add_u32 s17, s17, s19
    s_add_u32 s18, s18, s19
    s_waitcnt lgkmcnt(6)
    v_mfma_f32_32x32x16_bf16 v[176:191], v[36:39], v[64:67], v[176:191]
    ds_read_b64_tr_b16 v[52:53], v21 offset:53248
    ds_read_b64_tr_b16 v[54:55], v21 offset:54272
    s_waitcnt lgkmcnt(6)
    v_mfma_f32_32x32x16_bf16 v[208:223], v[40:43], v[64:67], v[208:223]
    ds_read_b64_tr_b16 v[56:57], v22 offset:53248
    ds_read_b64_tr_b16 v[58:59], v22 offset:54272
    buffer_load_dword v13, v18, s[32:35], s16 offen sc1
    s_waitcnt lgkmcnt(6)
    v_mfma_f32_32x32x16_bf16 v[240:255], v[44:47], v[64:67], v[240:255]
    ds_read_b64_tr_b16 v[60:61], v23 offset:53248
    ds_read_b64_tr_b16 v[62:63], v23 offset:54272
    s_waitcnt vmcnt(18) lgkmcnt(6)
    v_mfma_f32_32x32x16_bf16 v[144:159], v[48:51], v[68:71], v[144:159]
    ds_read_b64_tr_b16 v[32:33], v20 offset:57344
    ds_read_b64_tr_b16 v[34:35], v20 offset:58368
    s_waitcnt lgkmcnt(6)
    v_mfma_f32_32x32x16_bf16 v[176:191], v[52:55], v[68:71], v[176:191]
    ds_read_b64_tr_b16 v[36:37], v21 offset:57344
    ds_read_b64_tr_b16 v[38:39], v21 offset:58368
    s_waitcnt lgkmcnt(6)
    v_mfma_f32_32x32x16_bf16 v[208:223], v[56:59], v[68:71], v[208:223]
    ds_read_b64_tr_b16 v[40:41], v22 offset:57344
    ds_read_b64_tr_b16 v[42:43], v22 offset:58368
    s_waitcnt lgkmcnt(6)
    v_mfma_f32_32x32x16_bf16 v[240:255], v[60:63], v[68:71], v[240:255]
    ds_read_b64_tr_b16 v[44:45], v23 offset:57344
    ds_read_b64_tr_b16 v[46:47], v23 offset:58368
    s_waitcnt vmcnt(16) lgkmcnt(6)
    v_mfma_f32_32x32x16_bf16 v[144:159], v[32:35], v[72:75], v[144:159]
    ds_read_b64_tr_b16 v[48:49], v20 offset:61440
    ds_read_b64_tr_b16 v[50:51], v20 offset:62464
    s_waitcnt lgkmcnt(6)
    v_mfma_f32_32x32x16_bf16 v[176:191], v[36:39], v[72:75], v[176:191]
    ds_read_b64_tr_b16 v[52:53], v21 offset:61440
    ds_read_b64_tr_b16 v[54:55], v21 offset:62464
    s_waitcnt lgkmcnt(6)
    v_mfma_f32_32x32x16_bf16 v[208:223], v[40:43], v[72:75], v[208:223]
    ds_read_b64_tr_b16 v[56:57], v22 offset:61440
    ds_read_b64_tr_b16 v[58:59], v22 offset:62464
    s_waitcnt lgkmcnt(6)
    v_mfma_f32_32x32x16_bf16 v[240:255], v[44:47], v[72:75], v[240:255]
    ds_read_b64_tr_b16 v[60:61], v23 offset:61440
    ds_read_b64_tr_b16 v[62:63], v23 offset:62464
    s_waitcnt vmcnt(14) lgkmcnt(6)
    v_mfma_f32_32x32x16_bf16 v[144:159], v[48:51], v[76:79], v[144:159]
    s_waitcnt lgkmcnt(4)
    v_mfma_f32_32x32x16_bf16 v[176:191], v[52:55], v[76:79], v[176:191]
    s_waitcnt lgkmcnt(2)
    v_mfma_f32_32x32x16_bf16 v[208:223], v[56:59], v[76:79], v[208:223]
    s_waitcnt lgkmcnt(0)
    v_mfma_f32_32x32x16_bf16 v[240:255], v[60:63], v[76:79], v[240:255]
    s_waitcnt vmcnt(0)
    v_and_b32 v13, v13, v12
    v_cmp_ne_u32 vcc, v13, v12
    s_cbranch_vccnz spin_16
spb_17:
    s_mov_b32 s48, 1040356334
    s_nop 0
    v_mul_f32 v144, s48, v144
    v_mul_f32 v145, s48, v145
    v_mul_f32 v146, s48, v146
    v_mul_f32 v147, s48, v147
    v_mul_f32 v148, s48, v148
    v_mul_f32 v149, s48, v149
    v_mul_f32 v150, s48, v150
    v_mul_f32 v151, s48, v151
    v_mul_f32 v152, s48, v152
    v_mul_f32 v153, s48, v153
    v_mul_f32 v154, s48, v154
    v_mul_f32 v155, s48, v155
    v_mul_f32 v156, s48, v156
    v_mul_f32 v157, s48, v157
    v_mul_f32 v158, s48, v158
    v_mul_f32 v159, s48, v159
    v_cvt_pk_bf16_f32 v80, v144, v145
    v_cvt_pk_bf16_f32 v81, v146, v147
    v_cvt_pk_bf16_f32 v82, v148, v149
    v_cvt_pk_bf16_f32 v83, v150, v151
    v_cvt_pk_bf16_f32 v84, v152, v153
    v_cvt_pk_bf16_f32 v85, v154, v155
    v_cvt_pk_bf16_f32 v86, v156, v157
    v_cvt_pk_bf16_f32 v87, v158, v159
    v_mul_f32 v176, s48, v176
    v_mul_f32 v177, s48, v177
    v_mul_f32 v178, s48, v178
    v_mul_f32 v179, s48, v179
    v_mul_f32 v180, s48, v180
    v_mul_f32 v181, s48, v181
    v_mul_f32 v182, s48, v182
    v_mul_f32 v183, s48, v183
    v_mul_f32 v184, s48, v184
    v_mul_f32 v185, s48, v185
    v_mul_f32 v186, s48, v186
    v_mul_f32 v187, s48, v187
    v_mul_f32 v188, s48, v188
    v_mul_f32 v189, s48, v189
    v_mul_f32 v190, s48, v190
    v_mul_f32 v191, s48, v191
    v_cvt_pk_bf16_f32 v88, v176, v177
    v_cvt_pk_bf16_f32 v89, v178, v179
    v_cvt_pk_bf16_f32 v90, v180, v181
    v_cvt_pk_bf16_f32 v91, v182, v183
    v_cvt_pk_bf16_f32 v92, v184, v185
    v_cvt_pk_bf16_f32 v93, v186, v187
    v_cvt_pk_bf16_f32 v94, v188, v189
    v_cvt_pk_bf16_f32 v95, v190, v191
    v_mul_f32 v208, s48, v208
    v_mul_f32 v209, s48, v209
    v_mul_f32 v210, s48, v210
    v_mul_f32 v211, s48, v211
    v_mul_f32 v212, s48, v212
    v_mul_f32 v213, s48, v213
    v_mul_f32 v214, s48, v214
    v_mul_f32 v215, s48, v215
    v_mul_f32 v216, s48, v216
    v_mul_f32 v217, s48, v217
    v_mul_f32 v218, s48, v218
    v_mul_f32 v219, s48, v219
    v_mul_f32 v220, s48, v220
    v_mul_f32 v221, s48, v221
    v_mul_f32 v222, s48, v222
    v_mul_f32 v223, s48, v223
    v_cvt_pk_bf16_f32 v96, v208, v209
    v_cvt_pk_bf16_f32 v97, v210, v211
    v_cvt_pk_bf16_f32 v98, v212, v213
    v_cvt_pk_bf16_f32 v99, v214, v215
    v_cvt_pk_bf16_f32 v100, v216, v217
    v_cvt_pk_bf16_f32 v101, v218, v219
    v_cvt_pk_bf16_f32 v102, v220, v221
    v_cvt_pk_bf16_f32 v103, v222, v223
    v_mul_f32 v240, s48, v240
    v_mul_f32 v241, s48, v241
    v_mul_f32 v242, s48, v242
    v_mul_f32 v243, s48, v243
    v_mul_f32 v244, s48, v244
    v_mul_f32 v245, s48, v245
    v_mul_f32 v246, s48, v246
    v_mul_f32 v247, s48, v247
    v_mul_f32 v248, s48, v248
    v_mul_f32 v249, s48, v249
    v_mul_f32 v250, s48, v250
    v_mul_f32 v251, s48, v251
    v_mul_f32 v252, s48, v252
    v_mul_f32 v253, s48, v253
    v_mul_f32 v254, s48, v254
    v_mul_f32 v255, s48, v255
    v_cvt_pk_bf16_f32 v104, v240, v241
    v_cvt_pk_bf16_f32 v105, v242, v243
    v_cvt_pk_bf16_f32 v106, v244, v245
    v_cvt_pk_bf16_f32 v107, v246, v247
    v_cvt_pk_bf16_f32 v108, v248, v249
    v_cvt_pk_bf16_f32 v109, v250, v251
    v_cvt_pk_bf16_f32 v110, v252, v253
    v_cvt_pk_bf16_f32 v111, v254, v255
kq_9:
    s_barrier
    v_mov_b32 v19, 3
    buffer_store_dword v19, v28, s[32:35], s16 offen sc1
    s_lshl_b32 s56, s50, 14
    s_add_u32 s74, s56, s55
    s_add_u32 s56, s56, s54
    s_cmp_lt_u32 s50, s51
    s_cselect_b32 s56, s56, s58
    s_mov_b32 m0, s53
    s_cselect_b32 s74, s74, s58
    buffer_load_dwordx4 v5, s[32:35], s56 offen sc1 lds
    buffer_load_dwordx4 v5, s[32:35], s56 offen offset:1024 sc1 lds
    s_add_u32 m0, s53, 16384
    s_add_u32 s50, s50, 1
    s_cmp_eq_u32 s50, s51
    s_cselect_b32 s50, 0, s50
    s_cselect_b32 s51, s52, s51
    s_cselect_b32 s52, 0, s52
    s_mov_b32 s57, s73
    s_mov_b32 s73, s74
    s_add_u32 s53, s53, 32768
    s_cmp_eq_u32 s53, s59
    s_cselect_b32 s53, s60, s53
    s_lshl_b32 s56, s50, 14
    s_add_u32 s74, s56, s55
    s_add_u32 s56, s56, s54
    s_cmp_lt_u32 s50, s51
    s_cselect_b32 s56, s56, s58
    s_mov_b32 m0, s53
    s_cselect_b32 s74, s74, s58
    buffer_load_dwordx4 v5, s[32:35], s56 offen sc1 lds
    buffer_load_dwordx4 v5, s[32:35], s56 offen offset:1024 sc1 lds
    s_add_u32 m0, s53, 16384
    s_add_u32 s50, s50, 1
    s_cmp_eq_u32 s50, s51
    s_cselect_b32 s50, 0, s50
    s_cselect_b32 s51, s52, s51
    s_cselect_b32 s52, 0, s52
    s_mov_b32 s57, s73
    s_mov_b32 s73, s74
    s_add_u32 s53, s53, 32768
    s_cmp_eq_u32 s53, s59
    s_cselect_b32 s53, s60, s53
    s_lshl_b32 s56, s50, 14
    s_add_u32 s74, s56, s55
    s_add_u32 s56, s56, s54
    s_cmp_lt_u32 s50, s51
    s_cselect_b32 s56, s56, s58
    s_mov_b32 m0, s53
    s_cselect_b32 s74, s74, s58
    buffer_load_dwordx4 v5, s[32:35], s56 offen sc1 lds
    buffer_load_dwordx4 v5, s[32:35], s56 offen offset:1024 sc1 lds
    s_add_u32 m0, s53, 16384
    s_add_u32 s50, s50, 1
    s_cmp_eq_u32 s50, s51
    s_cselect_b32 s50, 0, s50
    s_cselect_b32 s51, s52, s51
    s_cselect_b32 s52, 0, s52
    s_mov_b32 s57, s73
    s_mov_b32 s73, s74
    s_add_u32 s53, s53, 32768
    s_cmp_eq_u32 s53, s59
    s_cselect_b32 s53, s60, s53
    s_lshl_b32 s49, s44, 13
    s_add_u32 s49, s49, 98304
    v_add_u32 v9, s49, v4
    ds_write_b128 v9, v[80:83] offset:0
    ds_write_b128 v9, v[84:87] offset:1024
    ds_write_b128 v9, v[88:91] offset:2048
    ds_write_b128 v9, v[92:95] offset:3072
    ds_write_b128 v9, v[96:99] offset:4096
    ds_write_b128 v9, v[100:103] offset:5120
    ds_write_b128 v9, v[104:107] offset:6144
    ds_write_b128 v9, v[108:111] offset:7168
    s_xor_b32 s49, s44, 4
    s_lshl_b32 s49, s49, 13
    s_add_u32 s49, s49, 98304
    v_add_u32 v15, s49, v4
    s_lshl_b32 s49, s41, 13
    s_add_u32 s49, s49, 98304
    v_add_u32 v14, s49, v4
    s_mov_b32 s62, 32768
    v_add_u32 v2, s62, v3
    s_mov_b32 s63, s46
    s_mov_b32 s43, 0
    s_mov_b32 s64, 1568669696
    s_mov_b32 s65, 0xff800000
    v_lshlrev_b32 v12, 1, v12
    s_cmp_ge_u32 s44, 4
    s_cbranch_scc1 r_18
    v_lshrrev_b32 v10, 4, v1
    v_mul_lo_u32 v10, v10, s15
    v_and_b32 v29, 0xff, v11
    v_add_u32 v245, v10, v29
    s_lshl_b32 s61, s15, 2
    s_mov_b32 s72, s12
    s_branch r_19
r_18:
    s_lshl_b32 s48, s45, 3
    s_add_u32 s48, s48, s46
    s_lshl_b32 s48, s48, 14
    s_cmp_eq_u32 s44, 5
    s_cselect_b32 s72, s48, s58
    v_lshlrev_b32 v245, 6, v1
    s_mov_b32 s61, 4096
    s_mov_b32 s36, s28
    s_mov_b32 s37, s29
    s_mov_b32 s38, s30
    s_mov_b32 s39, s31
r_19:
    s_mov_b32 s100, s13
    s_mov_b32 s101, s14
    v_mov_b32 v246, v8
    v_lshlrev_b32 v244, 2, v1
    s_cmp_eq_u32 s44, 6
    s_cselect_b32 s48, 0, s58
    v_add_u32 v244, s48, v244
    v_mov_b32 v10, v18
    v_cmp_eq_u32 vcc, 0, v1
    s_lshl_b32 s48, s46, 2
    v_mov_b32 v240, s48
    v_mov_b32 v241, s58
    v_cndmask_b32 v240, v241, v240, vcc
    s_lshr_b32 s49, s45, 2
    s_lshl_b32 s7, s49, 10
    s_add_u32 s48, s48, s7
    v_and_b32 v241, 3, v1
    v_lshlrev_b32 v241, 8, v241
    v_add_u32 v241, s48, v241
    v_lshrrev_b32 v242, 4, v1
    v_lshlrev_b32 v242, 10, v242
    v_and_b32 v243, 0xff, v11
    s_lshl_b32 s48, s44, 14
    s_lshl_b32 s7, s3, 8
    s_add_u32 s48, s48, s7
    v_add3_u32 v242, v242, v243, s48
    v_mov_b32 v243, v24
    s_mov_b32 s4, 75497472
    s_cmp_eq_u32 s44, 0
    s_cselect_b32 s5, s16, s58
    s_cmp_eq_u32 s44, 4
    s_cselect_b32 s6, s16, s58
    s_lshl_b32 s7, s49, 19
    s_cmp_eq_u32 s40, 1
    s_cselect_b32 s48, s47, s46
    s_lshl_b32 s48, s48, 2
    s_add_u32 s48, s48, s41
    s_lshl_b32 s13, s48, 18
    s_lshl_b32 s12, s49, 15
    s_add_u32 s13, s13, s12
    s_add_u32 s13, s13, 37748736
    s_lshl_b32 s12, s3, 13
    s_add_u32 s13, s13, s12
    s_lshl_b32 s12, s3, 17
    s_add_u32 s7, s7, s12
    s_cmp_eq_u32 s40, 0
    s_cselect_b32 s12, s13, s58
    s_lshl_b32 s14, s48, 15
    s_lshl_b32 s48, s49, 21
    s_add_u32 s14, s14, s48
    s_lshl_b32 s48, s3, 13
    s_add_u32 s14, s14, s48
    s_add_u32 s14, s14, 83886080
    s_lshl_b32 s17, s44, 12
    s_lshl_b32 s15, s47, 2
    s_add_u32 s15, s15, s41
    s_lshl_b32 s15, s15, 18
    s_lshl_b32 s48, s45, 13
    s_add_u32 s15, s15, s48
    s_lshl_b32 s48, s40, 12
    s_add_u32 s15, s15, s48
    s_add_u32 s15, s15, 37748736
    s_lshl_b32 s18, s45, 3
    s_add_u32 s18, s18, s46
    s_and_b32 s19, s18, 31
    s_lshl_b32 s18, s18, 3
    s_add_u32 s18, s18, s44
    s_lshl_b32 s18, s18, 11
    s_lshl_b32 s19, s19, 2
    s_add_u32 s19, s19, s41
    s_mul_i32 s19, s19, 14336
    s_add_u32 s19, s19, 58720256
    s_waitcnt vmcnt(4) lgkmcnt(0)
    s_barrier
    ds_read_b128 v[16:19], v14 offset:0
    ds_read_b128 v[20:23], v14 offset:1024
    ds_read_b128 v[24:27], v14 offset:2048
    ds_read_b128 v[28:31], v14 offset:3072
    ds_read_b128 v[32:35], v14 offset:4096
    ds_read_b128 v[36:39], v14 offset:5120
    ds_read_b128 v[40:43], v14 offset:6144
    ds_read_b128 v[44:47], v14 offset:7168
    ds_read_b128 v[176:179], v2 offset:0
    ds_read_b128 v[184:187], v2 offset:1024
    ds_read_b128 v[188:191], v2 offset:2048
    ds_read_b128 v[196:199], v2 offset:3072
    ds_read_b128 v[200:203], v2 offset:4096
    ds_read_b128 v[208:211], v2 offset:5120
    ds_read_b128 v[212:215], v2 offset:6144
    ds_read_b128 v[220:223], v2 offset:7168
    buffer_load_dword v13, v10, s[32:35], s16 offen sc1
    v_mov_b32 v248, s65
    v_mov_b32 v250, s64
    s_lshl_b32 s48, s63, 7
    v_add_u32 v251, s48, v6
    s_waitcnt lgkmcnt(7)
    v_mfma_f32_32x32x16_bf16 v[112:127], v[176:179], v[16:19], 0
    v_mov_b32 v48, 0
    v_mov_b32 v49, 0
    v_mov_b32 v50, 0
    v_mov_b32 v51, 0
    v_mov_b32 v52, 0
    v_mov_b32 v53, 0
    v_mov_b32 v54, 0
    v_mov_b32 v55, 0
    v_mov_b32 v56, 0
    v_mov_b32 v57, 0
    v_mov_b32 v58, 0
    v_mov_b32 v59, 0
    v_mov_b32 v60, 0
    v_mov_b32 v61, 0
    v_mov_b32 v62, 0
    v_mov_b32 v63, 0
    s_waitcnt lgkmcnt(6)
    v_mfma_f32_32x32x16_bf16 v[112:127], v[184:187], v[20:23], v[112:127]
    v_mov_b32 v64, 0
    v_mov_b32 v65, 0
    v_mov_b32 v66, 0
    v_mov_b32 v67, 0
    v_mov_b32 v68, 0
    v_mov_b32 v69, 0
    v_mov_b32 v70, 0
    v_mov_b32 v71, 0
    s_waitcnt lgkmcnt(5)
    v_mfma_f32_32x32x16_bf16 v[112:127], v[188:191], v[24:27], v[112:127]
    v_mov_b32 v72, 0
    v_mov_b32 v73, 0
    v_mov_b32 v74, 0
    v_mov_b32 v75, 0
    v_mov_b32 v76, 0
    v_mov_b32 v77, 0
    v_mov_b32 v78, 0
    v_mov_b32 v79, 0
    s_waitcnt lgkmcnt(4)
    v_mfma_f32_32x32x16_bf16 v[112:127], v[196:199], v[28:31], v[112:127]
    v_mov_b32 v80, 0
    v_mov_b32 v81, 0
    v_mov_b32 v82, 0
    v_mov_b32 v83, 0
    v_mov_b32 v84, 0
    v_mov_b32 v85, 0
    v_mov_b32 v86, 0
    v_mov_b32 v87, 0
    v_mov_b32 v88, 0
    v_mov_b32 v89, 0
    v_mov_b32 v90, 0
    v_mov_b32 v91, 0
    v_mov_b32 v92, 0
    v_mov_b32 v93, 0
    v_mov_b32 v94, 0
    v_mov_b32 v95, 0
    s_waitcnt lgkmcnt(3)
    v_mfma_f32_32x32x16_bf16 v[112:127], v[200:203], v[32:35], v[112:127]
    v_mov_b32 v96, 0
    v_mov_b32 v97, 0
    v_mov_b32 v98, 0
    v_mov_b32 v99, 0
    v_mov_b32 v100, 0
    v_mov_b32 v101, 0
    v_mov_b32 v102, 0
    v_mov_b32 v103, 0
    s_waitcnt lgkmcnt(2)
    v_mfma_f32_32x32x16_bf16 v[112:127], v[208:211], v[36:39], v[112:127]
    v_mov_b32 v104, 0
    v_mov_b32 v105, 0
    v_mov_b32 v106, 0
    v_mov_b32 v107, 0
    v_mov_b32 v108, 0
    v_mov_b32 v109, 0
    v_mov_b32 v110, 0
    v_mov_b32 v111, 0
    s_waitcnt lgkmcnt(1)
    v_mfma_f32_32x32x16_bf16 v[112:127], v[212:215], v[40:43], v[112:127]
    s_waitcnt vmcnt(0)
    v_and_b32 v13, v13, v12
    v_cmp_ne_u32 vcc, v13, v12
    s_cbranch_vccnz spin_20
spb_21:
    s_waitcnt vmcnt(0) lgkmcnt(0)
    s_barrier
    s_add_u32 s62, s62, 32768
    s_cmp_eq_u32 s62, 98304
    s_cselect_b32 s62, 0, s62
    v_add_u32 v2, s62, v3
    s_add_u32 m0, s60, 16384
    s_nop 0
    buffer_load_dwordx4 v5, s[32:35], s55 offen sc1 lds
    buffer_load_dwordx4 v5, s[32:35], s55 offen offset:1024 sc1 lds
    ds_read_b128 v[176:179], v2 offset:0
    ds_read_b128 v[184:187], v2 offset:1024
    v_mov_b32 v8, 0
    v_mfma_f32_32x32x16_bf16 v[112:127], v[220:223], v[44:47], v[112:127]
    ds_read_b128 v[188:191], v2 offset:2048
    ds_read_b128 v[196:199], v2 offset:3072
    s_lshl_b32 s56, s50, 14
    s_add_u32 s74, s56, s55
    s_add_u32 s56, s56, s54
    s_cmp_lt_u32 s50, s51
    s_cselect_b32 s56, s56, s58
    s_mov_b32 m0, s53
    s_cselect_b32 s74, s74, s58
    buffer_load_dwordx4 v5, s[32:35], s56 offen sc1 lds
    ds_read_b128 v[200:203], v2 offset:4096
    ds_read_b128 v[208:211], v2 offset:5120
    ds_read_b128 v[212:215], v2 offset:6144
    ds_read_b128 v[220:223], v2 offset:7168
    buffer_load_dwordx4 v5, s[32:35], s56 offen offset:1024 sc1 lds
    s_add_u32 m0, s53, 16384
    s_add_u32 s50, s50, 1
    s_cmp_eq_u32 s50, s51
    buffer_load_dwordx4 v5, s[32:35], s57 offen sc1 lds
    s_cselect_b32 s50, 0, s50
    s_cselect_b32 s51, s52, s51
    s_cselect_b32 s52, 0, s52
    buffer_load_dwordx4 v5, s[32:35], s57 offen offset:1024 sc1 lds
    s_mov_b32 s57, s73
    s_mov_b32 s73, s74
    s_add_u32 s53, s53, 32768
    s_cmp_eq_u32 s53, s59
    s_cselect_b32 s53, s60, s53
    v_cmp_le_i32 s[66:67], 0, v251
    v_cmp_le_i32 s[68:69], 1, v251
    v_cmp_le_i32 s[70:71], 2, v251
    v_cndmask_b32 v112, v248, v112, s[66:67]
    v_cmp_le_i32 s[66:67], 3, v251
    v_cndmask_b32 v113, v248, v113, s[68:69]
    v_cmp_le_i32 s[68:69], 8, v251
    v_cndmask_b32 v114, v248, v114, s[70:71]
    v_cmp_le_i32 s[70:71], 9, v251
    v_cndmask_b32 v115, v248, v115, s[66:67]
    v_cmp_le_i32 s[66:67], 10, v251
    v_cndmask_b32 v116, v248, v116, s[68:69]
    v_cmp_le_i32 s[68:69], 11, v251
    v_cndmask_b32 v117, v248, v117, s[70:71]
    v_cmp_le_i32 s[70:71], 16, v251
    v_cndmask_b32 v118, v248, v118, s[66:67]
    v_cmp_le_i32 s[66:67], 17, v251
    v_cndmask_b32 v119, v248, v119, s[68:69]
    v_cmp_le_i32 s[68:69], 18, v251
    v_cndmask_b32 v120, v248, v120, s[70:71]
    v_cmp_le_i32 s[70:71], 19, v251
    v_cndmask_b32 v121, v248, v121, s[66:67]
    v_cmp_le_i32 s[66:67], 24, v251
    v_cndmask_b32 v122, v248, v122, s[68:69]
    v_cmp_le_i32 s[68:69], 25, v251
    v_cndmask_b32 v123, v248, v123, s[70:71]
    v_cmp_le_i32 s[70:71], 26, v251
    v_cndmask_b32 v124, v248, v124, s[66:67]
    v_cmp_le_i32 s[66:67], 27, v251
    v_cndmask_b32 v125, v248, v125, s[68:69]
    v_cndmask_b32 v126, v248, v126, s[70:71]
    v_cndmask_b32 v127, v248, v127, s[66:67]
    v_max3_f32 v0, v112, v113, v114
    v_max3_f32 v0, v0, v115, v116
    v_max3_f32 v0, v0, v117, v118
    v_max3_f32 v0, v0, v119, v120
    v_max3_f32 v0, v0, v121, v122
    v_max3_f32 v0, v0, v123, v124
    v_max3_f32 v0, v0, v125, v126
    v_max_f32 v0, v0, v127
    v_mov_b32 v249, v0
    s_nop 1
    v_permlane32_swap_b32 v0, v249
    v_max_f32 v0, v0, v249
    v_max_f32 v0, 0xc9800000, v0
    v_sub_f32 v160, 0, v0
    v_sub_f32 v161, 0, v0
    v_sub_f32 v162, 0, v0
    v_sub_f32 v163, 0, v0
    v_sub_f32 v164, 0, v0
    v_sub_f32 v165, 0, v0
    v_sub_f32 v166, 0, v0
    v_sub_f32 v167, 0, v0
    v_sub_f32 v168, 0, v0
    v_sub_f32 v169, 0, v0
    v_sub_f32 v170, 0, v0
    v_sub_f32 v171, 0, v0
    v_sub_f32 v172, 0, v0
    v_sub_f32 v173, 0, v0
    v_sub_f32 v174, 0, v0
    v_sub_f32 v175, 0, v0
    v_sub_f32 v112, v112, v0
    v_sub_f32 v113, v113, v0
    v_sub_f32 v114, v114, v0
    v_sub_f32 v115, v115, v0
    v_sub_f32 v116, v116, v0
    v_sub_f32 v117, v117, v0
    v_sub_f32 v118, v118, v0
    v_sub_f32 v119, v119, v0
    v_sub_f32 v120, v120, v0
    v_sub_f32 v121, v121, v0
    v_sub_f32 v122, v122, v0
    v_sub_f32 v123, v123, v0
    v_sub_f32 v124, v124, v0
    v_sub_f32 v125, v125, v0
    v_sub_f32 v126, v126, v0
    v_sub_f32 v127, v127, v0
    s_waitcnt lgkmcnt(7)
    v_mfma_f32_32x32x16_bf16 v[128:143], v[176:179], v[16:19], v[160:175]
    v_exp_f32 v10, v112
    v_exp_f32 v11, v113
    v_add_f32 v7, v8, v10
    v_exp_f32 v12, v114
    v_add_f32 v7, v7, v11
    v_cvt_pk_bf16_f32 v144, v10, v11
    s_waitcnt lgkmcnt(6)
    v_mfma_f32_32x32x16_bf16 v[128:143], v[184:187], v[20:23], v[128:143]
    v_exp_f32 v13, v115
    v_add_f32 v7, v7, v12
    v_exp_f32 v10, v116
    v_add_f32 v7, v7, v13
    v_cvt_pk_bf16_f32 v145, v12, v13
    s_waitcnt lgkmcnt(5)
    v_mfma_f32_32x32x16_bf16 v[128:143], v[188:191], v[24:27], v[128:143]
    v_exp_f32 v11, v117
    v_add_f32 v7, v7, v10
    v_exp_f32 v12, v118
    v_add_f32 v7, v7, v11
    v_cvt_pk_bf16_f32 v146, v10, v11
    v_exp_f32 v13, v119
    v_add_f32 v7, v7, v12
    s_waitcnt lgkmcnt(4)
    v_mfma_f32_32x32x16_bf16 v[128:143], v[196:199], v[28:31], v[128:143]
    s_waitcnt vmcnt(4) lgkmcnt(0)
    s_barrier
    s_add_u32 s62, s62, 32768
    s_cmp_eq_u32 s62, 98304
    s_cselect_b32 s62, 0, s62
    v_add_u32 v2, s62, v3
    ds_read_b128 v[176:179], v2 offset:0
    ds_read_b128 v[180:183], v2 offset:16384
    v_exp_f32 v10, v120
    v_add_f32 v7, v7, v13
    v_cvt_pk_bf16_f32 v147, v12, v13
    v_exp_f32 v11, v121
    v_add_f32 v7, v7, v10
    v_mfma_f32_32x32x16_bf16 v[128:143], v[200:203], v[32:35], v[128:143]
    ds_read_b128 v[184:187], v2 offset:1024
    ds_read_b128 v[188:191], v2 offset:2048
    s_lshl_b32 s56, s50, 14
    s_add_u32 s74, s56, s55
    s_add_u32 s56, s56, s54
    s_cmp_lt_u32 s50, s51
    s_cselect_b32 s56, s56, s58
    s_mov_b32 m0, s53
    s_cselect_b32 s74, s74, s58
    buffer_load_dwordx4 v5, s[32:35], s56 offen sc1 lds
    v_exp_f32 v12, v122
    v_add_f32 v7, v7, v11
    v_cvt_pk_bf16_f32 v148, v10, v11
    v_exp_f32 v13, v123
    v_add_f32 v7, v7, v12
    v_exp_f32 v10, v124
    v_add_f32 v7, v7, v13
    v_cvt_pk_bf16_f32 v149, v12, v13
    v_mfma_f32_32x32x16_bf16 v[128:143], v[208:211], v[36:39], v[128:143]
    ds_read_b128 v[192:195], v2 offset:17408
    ds_read_b128 v[196:199], v2 offset:3072
    buffer_load_dwordx4 v5, s[32:35], s56 offen offset:1024 sc1 lds
    s_add_u32 m0, s53, 16384
    s_add_u32 s50, s50, 1
    s_cmp_eq_u32 s50, s51
    v_exp_f32 v11, v125
    v_add_f32 v7, v7, v10
    v_exp_f32 v12, v126
    v_add_f32 v7, v7, v11
    v_cvt_pk_bf16_f32 v150, v10, v11
    v_mfma_f32_32x32x16_bf16 v[128:143], v[212:215], v[40:43], v[128:143]
    ds_read_b128 v[200:203], v2 offset:4096
    ds_read_b128 v[204:207], v2 offset:18432
    buffer_load_dwordx4 v5, s[32:35], s57 offen sc1 lds
    s_cselect_b32 s50, 0, s50
    s_cselect_b32 s51, s52, s51
    s_cselect_b32 s52, 0, s52
    v_exp_f32 v13, v127
    v_add_f32 v7, v7, v12
    v_add_f32 v7, v7, v13
    v_cvt_pk_bf16_f32 v151, v12, v13
    v_mfma_f32_32x32x16_bf16 v[128:143], v[220:223], v[44:47], v[128:143]
    ds_read_b128 v[208:211], v2 offset:5120
    ds_read_b128 v[212:215], v2 offset:6144
    buffer_load_dwordx4 v5, s[32:35], s57 offen offset:1024 sc1 lds
    s_mov_b32 s57, s73
    s_mov_b32 s73, s74
    s_add_u32 s53, s53, 32768
    s_cmp_eq_u32 s53, s59
    s_cselect_b32 s53, s60, s53
    s_cmp_eq_u32 s63, 0
    s_cbranch_scc1 last_22
    s_mov_b32 s42, s63
.p2align 6
odd_23:
    s_cmp_eq_u32 s42, s75
    s_cbranch_scc1 vis_25
vbk_26:
    s_waitcnt lgkmcnt(9)
    v_mfma_f32_32x32x16_bf16 v[112:127], v[176:179], v[16:19], v[160:175]
    ds_read_b128 v[216:219], v2 offset:19456
    v_exp_f32 v10, v128
    v_exp_f32 v11, v129
    v_add_f32 v8, v7, v10
    s_waitcnt lgkmcnt(9)
    v_mfma_f32_32x32x16_bf16 v[48:63], v[180:183], v[144:147], v[48:63]
    ds_read_b128 v[220:223], v2 offset:7168
    v_exp_f32 v12, v130
    v_add_f32 v8, v8, v11
    v_cvt_pk_bf16_f32 v152, v10, v11
    s_waitcnt lgkmcnt(9)
    v_mfma_f32_32x32x16_bf16 v[112:127], v[184:187], v[20:23], v[112:127]
    ds_read_b128 v[224:227], v2 offset:20480
    v_exp_f32 v13, v131
    v_add_f32 v8, v8, v12
    s_waitcnt lgkmcnt(9)
    v_mfma_f32_32x32x16_bf16 v[112:127], v[188:191], v[24:27], v[112:127]
    ds_read_b128 v[228:231], v2 offset:21504
    v_exp_f32 v10, v132
    v_add_f32 v8, v8, v13
    v_cvt_pk_bf16_f32 v153, v12, v13
    s_waitcnt lgkmcnt(9)
    v_mfma_f32_32x32x16_bf16 v[64:79], v[192:195], v[144:147], v[64:79]
    ds_read_b128 v[232:235], v2 offset:22528
    v_exp_f32 v11, v133
    v_add_f32 v8, v8, v10
    v_exp_f32 v12, v134
    v_add_f32 v8, v8, v11
    v_cvt_pk_bf16_f32 v154, v10, v11
    s_waitcnt lgkmcnt(9)
    v_mfma_f32_32x32x16_bf16 v[112:127], v[196:199], v[28:31], v[112:127]
    ds_read_b128 v[236:239], v2 offset:23552
    v_exp_f32 v13, v135
    v_add_f32 v8, v8, v12
    s_waitcnt lgkmcnt(9)
    v_mfma_f32_32x32x16_bf16 v[112:127], v[200:203], v[32:35], v[112:127]
    v_exp_f32 v10, v136
    v_add_f32 v8, v8, v13
    v_cvt_pk_bf16_f32 v155, v12, v13
    s_waitcnt lgkmcnt(8)
    v_mfma_f32_32x32x16_bf16 v[80:95], v[204:207], v[144:147], v[80:95]
    v_exp_f32 v11, v137
    v_add_f32 v8, v8, v10
    s_waitcnt lgkmcnt(7)
    v_mfma_f32_32x32x16_bf16 v[112:127], v[208:211], v[36:39], v[112:127]
    v_exp_f32 v12, v138
    v_add_f32 v8, v8, v11
    v_cvt_pk_bf16_f32 v156, v10, v11
    s_waitcnt lgkmcnt(6)
    v_mfma_f32_32x32x16_bf16 v[112:127], v[212:215], v[40:43], v[112:127]
    s_waitcnt vmcnt(4) lgkmcnt(0)
    s_barrier
    s_add_u32 s62, s62, 32768
    s_cmp_eq_u32 s62, 98304
    s_cselect_b32 s62, 0, s62
    v_add_u32 v2, s62, v3
    ds_read_b128 v[176:179], v2 offset:0
    ds_read_b128 v[180:183], v2 offset:16384
    v_exp_f32 v13, v139
    v_add_f32 v8, v8, v12
    v_exp_f32 v10, v140
    v_add_f32 v8, v8, v13
    v_cvt_pk_bf16_f32 v157, v12, v13
    v_mfma_f32_32x32x16_bf16 v[96:111], v[216:219], v[144:147], v[96:111]
    ds_read_b128 v[184:187], v2 offset:1024
    ds_read_b128 v[188:191], v2 offset:2048
    s_lshl_b32 s56, s50, 14
    s_add_u32 s74, s56, s55
    s_add_u32 s56, s56, s54
    s_cmp_lt_u32 s50, s51
    s_cselect_b32 s56, s56, s58
    s_mov_b32 m0, s53
    s_cselect_b32 s74, s74, s58
    buffer_load_dwordx4 v5, s[32:35], s56 offen sc1 lds
    v_exp_f32 v11, v141
    v_add_f32 v8, v8, v10
    v_mfma_f32_32x32x16_bf16 v[112:127], v[220:223], v[44:47], v[112:127]
    ds_read_b128 v[192:195], v2 offset:17408
    ds_read_b128 v[196:199], v2 offset:3072
    buffer_load_dwordx4 v5, s[32:35], s56 offen offset:1024 sc1 lds
    s_add_u32 m0, s53, 16384
    s_add_u32 s50, s50, 1
    s_cmp_eq_u32 s50, s51
    v_exp_f32 v12, v142
    v_add_f32 v8, v8, v11
    v_cvt_pk_bf16_f32 v158, v10, v11
    v_mfma_f32_32x32x16_bf16 v[48:63], v[224:227], v[148:151], v[48:63]
    ds_read_b128 v[200:203], v2 offset:4096
    ds_read_b128 v[204:207], v2 offset:18432
    buffer_load_dwordx4 v5, s[32:35], s57 offen sc1 lds
    s_cselect_b32 s50, 0, s50
    s_cselect_b32 s51, s52, s51
    s_cselect_b32 s52, 0, s52
    v_exp_f32 v13, v143
    v_add_f32 v8, v8, v12
    v_mfma_f32_32x32x16_bf16 v[64:79], v[228:231], v[148:151], v[64:79]
    ds_read_b128 v[208:211], v2 offset:5120
    ds_read_b128 v[212:215], v2 offset:6144
    buffer_load_dwordx4 v5, s[32:35], s57 offen offset:1024 sc1 lds
    s_mov_b32 s57, s73
    s_mov_b32 s73, s74
    s_add_u32 s53, s53, 32768
    s_cmp_eq_u32 s53, s59
    s_cselect_b32 s53, s60, s53
    v_add_f32 v8, v8, v13
    v_cvt_pk_bf16_f32 v159, v12, v13
    v_mfma_f32_32x32x16_bf16 v[80:95], v[232:235], v[148:151], v[80:95]
    v_mfma_f32_32x32x16_bf16 v[96:111], v[236:239], v[148:151], v[96:111]
    v_cmp_nle_f32 vcc, v8, v250
    s_cbranch_vccnz fb_27
fbr_28:
    s_sub_u32 s42, s42, 1
    s_cmp_eq_u32 s42, 0
    s_cbranch_scc1 msk_24
    s_waitcnt lgkmcnt(9)
    v_mfma_f32_32x32x16_bf16 v[128:143], v[176:179], v[16:19], v[160:175]
    ds_read_b128 v[216:219], v2 offset:19456
    v_exp_f32 v10, v112
    v_exp_f32 v11, v113
    v_add_f32 v7, v8, v10
    s_waitcnt lgkmcnt(9)
    v_mfma_f32_32x32x16_bf16 v[48:63], v[180:183], v[152:155], v[48:63]
    ds_read_b128 v[220:223], v2 offset:7168
    v_exp_f32 v12, v114
    v_add_f32 v7, v7, v11
    v_cvt_pk_bf16_f32 v144, v10, v11
    s_waitcnt lgkmcnt(9)
    v_mfma_f32_32x32x16_bf16 v[128:143], v[184:187], v[20:23], v[128:143]
    ds_read_b128 v[224:227], v2 offset:20480
    v_exp_f32 v13, v115
    v_add_f32 v7, v7, v12
    s_waitcnt lgkmcnt(9)
    v_mfma_f32_32x32x16_bf16 v[128:143], v[188:191], v[24:27], v[128:143]
    ds_read_b128 v[228:231], v2 offset:21504
    v_exp_f32 v10, v116
    v_add_f32 v7, v7, v13
    v_cvt_pk_bf16_f32 v145, v12, v13
    s_waitcnt lgkmcnt(9)
    v_mfma_f32_32x32x16_bf16 v[64:79], v[192:195], v[152:155], v[64:79]
    ds_read_b128 v[232:235], v2 offset:22528
    v_exp_f32 v11, v117
    v_add_f32 v7, v7, v10
    v_exp_f32 v12, v118
    v_add_f32 v7, v7, v11
    v_cvt_pk_bf16_f32 v146, v10, v11
    s_waitcnt lgkmcnt(9)
    v_mfma_f32_32x32x16_bf16 v[128:143], v[196:199], v[28:31], v[128:143]
    ds_read_b128 v[236:239], v2 offset:23552
    v_exp_f32 v13, v119
    v_add_f32 v7, v7, v12
    s_waitcnt lgkmcnt(9)
    v_mfma_f32_32x32x16_bf16 v[128:143], v[200:203], v[32:35], v[128:143]
    v_exp_f32 v10, v120
    v_add_f32 v7, v7, v13
    v_cvt_pk_bf16_f32 v147, v12, v13
    s_waitcnt lgkmcnt(8)
    v_mfma_f32_32x32x16_bf16 v[80:95], v[204:207], v[152:155], v[80:95]
    v_exp_f32 v11, v121
    v_add_f32 v7, v7, v10
    s_waitcnt lgkmcnt(7)
    v_mfma_f32_32x32x16_bf16 v[128:143], v[208:211], v[36:39], v[128:143]
    v_exp_f32 v12, v122
    v_add_f32 v7, v7, v11
    v_cvt_pk_bf16_f32 v148, v10, v11
    s_waitcnt lgkmcnt(6)
    v_mfma_f32_32x32x16_bf16 v[128:143], v[212:215], v[40:43], v[128:143]
    s_waitcnt vmcnt(4) lgkmcnt(0)
    s_barrier
    s_add_u32 s62, s62, 32768
    s_cmp_eq_u32 s62, 98304
    s_cselect_b32 s62, 0, s62
    v_add_u32 v2, s62, v3
    ds_read_b128 v[176:179], v2 offset:0
    ds_read_b128 v[180:183], v2 offset:16384
    v_exp_f32 v13, v123
    v_add_f32 v7, v7, v12
    v_exp_f32 v10, v124
    v_add_f32 v7, v7, v13
    v_cvt_pk_bf16_f32 v149, v12, v13
    v_mfma_f32_32x32x16_bf16 v[96:111], v[216:219], v[152:155], v[96:111]
    ds_read_b128 v[184:187], v2 offset:1024
    ds_read_b128 v[188:191], v2 offset:2048
    s_lshl_b32 s56, s50, 14
    s_add_u32 s74, s56, s55
    s_add_u32 s56, s56, s54
    s_cmp_lt_u32 s50, s51
    s_cselect_b32 s56, s56, s58
    s_mov_b32 m0, s53
    s_cselect_b32 s74, s74, s58
    buffer_load_dwordx4 v5, s[32:35], s56 offen sc1 lds
    v_exp_f32 v11, v125
    v_add_f32 v7, v7, v10
    v_mfma_f32_32x32x16_bf16 v[128:143], v[220:223], v[44:47], v[128:143]
    ds_read_b128 v[192:195], v2 offset:17408
    ds_read_b128 v[196:199], v2 offset:3072
    buffer_load_dwordx4 v5, s[32:35], s56 offen offset:1024 sc1 lds
    s_add_u32 m0, s53, 16384
    s_add_u32 s50, s50, 1
    s_cmp_eq_u32 s50, s51
    v_exp_f32 v12, v126
    v_add_f32 v7, v7, v11
    v_cvt_pk_bf16_f32 v150, v10, v11
    v_mfma_f32_32x32x16_bf16 v[48:63], v[224:227], v[156:159], v[48:63]
    ds_read_b128 v[200:203], v2 offset:4096
    ds_read_b128 v[204:207], v2 offset:18432
    buffer_load_dwordx4 v5, s[32:35], s57 offen sc1 lds
    s_cselect_b32 s50, 0, s50
    s_cselect_b32 s51, s52, s51
    s_cselect_b32 s52, 0, s52
    v_exp_f32 v13, v127
    v_add_f32 v7, v7, v12
    v_mfma_f32_32x32x16_bf16 v[64:79], v[228:231], v[156:159], v[64:79]
    ds_read_b128 v[208:211], v2 offset:5120
    ds_read_b128 v[212:215], v2 offset:6144
    buffer_load_dwordx4 v5, s[32:35], s57 offen offset:1024 sc1 lds
    s_mov_b32 s57, s73
    s_mov_b32 s73, s74
    s_add_u32 s53, s53, 32768
    s_cmp_eq_u32 s53, s59
    s_cselect_b32 s53, s60, s53
    v_add_f32 v7, v7, v13
    v_cvt_pk_bf16_f32 v151, v12, v13
    v_mfma_f32_32x32x16_bf16 v[80:95], v[232:235], v[156:159], v[80:95]
    v_mfma_f32_32x32x16_bf16 v[96:111], v[236:239], v[156:159], v[96:111]
    v_cmp_nle_f32 vcc, v7, v250
    s_cbranch_vccnz fb_29
fbr_30:
    s_branch odd_23
msk_24:
    s_add_u32 s48, s40, 2
    s_cmp_gt_u32 s48, s41
    s_cselect_b64 vcc, -1, 0
    s_waitcnt lgkmcnt(9)
    s_cbranch_vccnz sk_31
    v_mfma_f32_32x32x16_bf16 v[128:143], v[176:179], v[16:19], v[160:175]
sk_31:
    ds_read_b128 v[216:219], v2 offset:19456
    v_cmp_le_i32 s[66:67], 0, v6
    v_cmp_le_i32 s[68:69], 1, v6
    v_cmp_le_i32 s[70:71], 2, v6
    v_cndmask_b32 v112, v248, v112, s[66:67]
    s_waitcnt lgkmcnt(9)
    v_mfma_f32_32x32x16_bf16 v[48:63], v[180:183], v[152:155], v[48:63]
    ds_read_b128 v[220:223], v2 offset:7168
    v_cmp_le_i32 s[66:67], 3, v6
    v_cndmask_b32 v113, v248, v113, s[68:69]
    v_cmp_le_i32 s[68:69], 8, v6
    v_cndmask_b32 v114, v248, v114, s[70:71]
    s_waitcnt lgkmcnt(9)
    s_cbranch_vccnz sk_32
    v_mfma_f32_32x32x16_bf16 v[128:143], v[184:187], v[20:23], v[128:143]
sk_32:
    ds_read_b128 v[224:227], v2 offset:20480
    v_cmp_le_i32 s[70:71], 9, v6
    v_cndmask_b32 v115, v248, v115, s[66:67]
    v_cmp_le_i32 s[66:67], 10, v6
    v_cndmask_b32 v116, v248, v116, s[68:69]
    v_cmp_le_i32 s[68:69], 11, v6
    v_cndmask_b32 v117, v248, v117, s[70:71]
    s_waitcnt lgkmcnt(9)
    s_cbranch_vccnz sk_33
    v_mfma_f32_32x32x16_bf16 v[128:143], v[188:191], v[24:27], v[128:143]
sk_33:
    ds_read_b128 v[228:231], v2 offset:21504
    v_cmp_le_i32 s[70:71], 16, v6
    v_cndmask_b32 v118, v248, v118, s[66:67]
    v_cmp_le_i32 s[66:67], 17, v6
    v_cndmask_b32 v119, v248, v119, s[68:69]
    s_waitcnt lgkmcnt(9)
    v_mfma_f32_32x32x16_bf16 v[64:79], v[192:195], v[152:155], v[64:79]
    ds_read_b128 v[232:235], v2 offset:22528
    v_cmp_le_i32 s[68:69], 18, v6
    v_cndmask_b32 v120, v248, v120, s[70:71]
    v_cmp_le_i32 s[70:71], 19, v6
    v_cndmask_b32 v121, v248, v121, s[66:67]
    v_cmp_le_i32 s[66:67], 24, v6
    v_cndmask_b32 v122, v248, v122, s[68:69]
    s_waitcnt lgkmcnt(9)
    s_cbranch_vccnz sk_34
    v_mfma_f32_32x32x16_bf16 v[128:143], v[196:199], v[28:31], v[128:143]
sk_34:
    ds_read_b128 v[236:239], v2 offset:23552
    v_cmp_le_i32 s[68:69], 25, v6
    v_cndmask_b32 v123, v248, v123, s[70:71]
    v_cmp_le_i32 s[70:71], 26, v6
    v_cndmask_b32 v124, v248, v124, s[66:67]
    s_waitcnt lgkmcnt(9)
    s_cbranch_vccnz sk_35
    v_mfma_f32_32x32x16_bf16 v[128:143], v[200:203], v[32:35], v[128:143]
sk_35:
    v_cmp_le_i32 s[66:67], 27, v6
    v_cndmask_b32 v125, v248, v125, s[68:69]
    v_cndmask_b32 v126, v248, v126, s[70:71]
    v_cndmask_b32 v127, v248, v127, s[66:67]
    s_waitcnt lgkmcnt(8)
    v_mfma_f32_32x32x16_bf16 v[80:95], v[204:207], v[152:155], v[80:95]
    v_exp_f32 v10, v112
    v_exp_f32 v11, v113
    v_add_f32 v7, v8, v10
    s_waitcnt lgkmcnt(7)
    s_cbranch_vccnz sk_36
    v_mfma_f32_32x32x16_bf16 v[128:143], v[208:211], v[36:39], v[128:143]
sk_36:
    v_exp_f32 v12, v114
    v_add_f32 v7, v7, v11
    v_cvt_pk_bf16_f32 v144, v10, v11
    v_exp_f32 v13, v115
    v_add_f32 v7, v7, v12
    v_exp_f32 v10, v116
    v_add_f32 v7, v7, v13
    v_cvt_pk_bf16_f32 v145, v12, v13
    s_waitcnt lgkmcnt(6)
    s_cbranch_vccnz sk_37
    v_mfma_f32_32x32x16_bf16 v[128:143], v[212:215], v[40:43], v[128:143]
sk_37:
    s_waitcnt vmcnt(4) lgkmcnt(0)
    s_barrier
    s_add_u32 s62, s62, 32768
    s_cmp_eq_u32 s62, 98304
    s_cselect_b32 s62, 0, s62
    v_add_u32 v2, s62, v3
    ds_read_b128 v[176:179], v2 offset:0
    ds_read_b128 v[180:183], v2 offset:16384
    v_exp_f32 v11, v117
    v_add_f32 v7, v7, v10
    v_exp_f32 v12, v118
    v_add_f32 v7, v7, v11
    v_cvt_pk_bf16_f32 v146, v10, v11
    v_mfma_f32_32x32x16_bf16 v[96:111], v[216:219], v[152:155], v[96:111]
    ds_read_b128 v[184:187], v2 offset:1024
    ds_read_b128 v[188:191], v2 offset:2048
    s_lshl_b32 s56, s50, 14
    s_add_u32 s74, s56, s55
    s_add_u32 s56, s56, s54
    s_cmp_lt_u32 s50, s51
    s_cselect_b32 s56, s56, s58
    s_mov_b32 m0, s53
    s_cselect_b32 s74, s74, s58
    buffer_load_dwordx4 v5, s[32:35], s56 offen sc1 lds
    v_exp_f32 v13, v119
    v_add_f32 v7, v7, v12
    v_exp_f32 v10, v120
    v_add_f32 v7, v7, v13
    v_cvt_pk_bf16_f32 v147, v12, v13
    v_exp_f32 v11, v121
    v_add_f32 v7, v7, v10
    s_cbranch_vccnz sk_38
    v_mfma_f32_32x32x16_bf16 v[128:143], v[220:223], v[44:47], v[128:143]
sk_38:
    ds_read_b128 v[192:195], v2 offset:17408
    ds_read_b128 v[196:199], v2 offset:3072
    buffer_load_dwordx4 v5, s[32:35], s56 offen offset:1024 sc1 lds
    s_add_u32 m0, s53, 16384
    s_add_u32 s50, s50, 1
    s_cmp_eq_u32 s50, s51
    v_exp_f32 v12, v122
    v_add_f32 v7, v7, v11
    v_cvt_pk_bf16_f32 v148, v10, v11
    v_exp_f32 v13, v123
    v_add_f32 v7, v7, v12
    v_mfma_f32_32x32x16_bf16 v[48:63], v[224:227], v[156:159], v[48:63]
    ds_read_b128 v[200:203], v2 offset:4096
    ds_read_b128 v[204:207], v2 offset:18432
    buffer_load_dwordx4 v5, s[32:35], s57 offen sc1 lds
    s_cselect_b32 s50, 0, s50
    s_cselect_b32 s51, s52, s51
    s_cselect_b32 s52, 0, s52
    v_exp_f32 v10, v124
    v_add_f32 v7, v7, v13
    v_cvt_pk_bf16_f32 v149, v12, v13
    v_exp_f32 v11, v125
    v_add_f32 v7, v7, v10
    v_exp_f32 v12, v126
    v_add_f32 v7, v7, v11
    v_cvt_pk_bf16_f32 v150, v10, v11
    v_mfma_f32_32x32x16_bf16 v[64:79], v[228:231], v[156:159], v[64:79]
    ds_read_b128 v[208:211], v2 offset:5120
    ds_read_b128 v[212:215], v2 offset:6144
    buffer_load_dwordx4 v5, s[32:35], s57 offen offset:1024 sc1 lds
    s_mov_b32 s57, s73
    s_mov_b32 s73, s74
    s_add_u32 s53, s53, 32768
    s_cmp_eq_u32 s53, s59
    s_cselect_b32 s53, s60, s53
    v_exp_f32 v13, v127
    v_add_f32 v7, v7, v12
    v_add_f32 v7, v7, v13
    v_cvt_pk_bf16_f32 v151, v12, v13
    v_mfma_f32_32x32x16_bf16 v[80:95], v[232:235], v[156:159], v[80:95]
    v_mfma_f32_32x32x16_bf16 v[96:111], v[236:239], v[156:159], v[96:111]
    v_cmp_nle_f32 vcc, v7, v250
    s_cbranch_vccnz fb_39
fbr_40:
last_22:
    s_cmp_lg_u32 s43, 0
    s_cbranch_scc1 lastb_41
    ds_read_b128 v[16:19], v14 offset:32768
    ds_read_b128 v[20:23], v14 offset:33792
    ds_read_b128 v[24:27], v14 offset:34816
    ds_read_b128 v[28:31], v14 offset:35840
    ds_read_b128 v[32:35], v14 offset:36864
    ds_read_b128 v[36:39], v14 offset:37888
    ds_read_b128 v[40:43], v14 offset:38912
    ds_read_b128 v[44:47], v14 offset:39936
    v_add_u32 v251, -64, v6
    s_waitcnt lgkmcnt(15)
    v_mfma_f32_32x32x16_bf16 v[48:63], v[180:183], v[144:147], v[48:63]
    ds_read_b128 v[216:219], v2 offset:19456
    v_cmp_le_i32 s[66:67], 0, v251
    v_cmp_le_i32 s[68:69], 1, v251
    v_cmp_le_i32 s[70:71], 2, v251
    v_cndmask_b32 v128, v248, v128, s[66:67]
    s_waitcnt lgkmcnt(14)
    v_mfma_f32_32x32x16_bf16 v[64:79], v[192:195], v[144:147], v[64:79]
    ds_read_b128 v[224:227], v2 offset:20480
    v_cmp_le_i32 s[66:67], 3, v251
    v_cndmask_b32 v129, v248, v129, s[68:69]
    v_cmp_le_i32 s[68:69], 8, v251
    v_cndmask_b32 v130, v248, v130, s[70:71]
    s_waitcnt lgkmcnt(12)
    v_mfma_f32_32x32x16_bf16 v[80:95], v[204:207], v[144:147], v[80:95]
    ds_read_b128 v[220:223], v2 offset:7168
    v_cmp_le_i32 s[70:71], 9, v251
    v_cndmask_b32 v131, v248, v131, s[66:67]
    v_cmp_le_i32 s[66:67], 10, v251
    v_cndmask_b32 v132, v248, v132, s[68:69]
    v_cmp_le_i32 s[68:69], 11, v251
    v_cndmask_b32 v133, v248, v133, s[70:71]
    s_waitcnt lgkmcnt(10)
    v_mfma_f32_32x32x16_bf16 v[112:127], v[176:179], v[16:19], 0
    ds_read_b128 v[228:231], v2 offset:21504
    v_cmp_le_i32 s[70:71], 16, v251
    v_cndmask_b32 v134, v248, v134, s[66:67]
    v_cmp_le_i32 s[66:67], 17, v251
    v_cndmask_b32 v135, v248, v135, s[68:69]
    s_waitcnt lgkmcnt(10)
    v_mfma_f32_32x32x16_bf16 v[112:127], v[184:187], v[20:23], v[112:127]
    ds_read_b128 v[232:235], v2 offset:22528
    v_cmp_le_i32 s[68:69], 18, v251
    v_cndmask_b32 v136, v248, v136, s[70:71]
    v_cmp_le_i32 s[70:71], 19, v251
    v_cndmask_b32 v137, v248, v137, s[66:67]
    v_cmp_le_i32 s[66:67], 24, v251
    v_cndmask_b32 v138, v248, v138, s[68:69]
    s_waitcnt lgkmcnt(10)
    v_mfma_f32_32x32x16_bf16 v[112:127], v[188:191], v[24:27], v[112:127]
    ds_read_b128 v[236:239], v2 offset:23552
    v_cmp_le_i32 s[68:69], 25, v251
    v_cndmask_b32 v139, v248, v139, s[70:71]
    v_cmp_le_i32 s[70:71], 26, v251
    v_cndmask_b32 v140, v248, v140, s[66:67]
    s_waitcnt lgkmcnt(5)
    v_mfma_f32_32x32x16_bf16 v[96:111], v[216:219], v[144:147], v[96:111]
    v_cmp_le_i32 s[66:67], 27, v251
    v_cndmask_b32 v141, v248, v141, s[68:69]
    v_cndmask_b32 v142, v248, v142, s[70:71]
    v_cndmask_b32 v143, v248, v143, s[66:67]
    v_mfma_f32_32x32x16_bf16 v[112:127], v[196:199], v[28:31], v[112:127]
    v_exp_f32 v10, v128
    v_exp_f32 v11, v129
    v_add_f32 v8, v7, v10
    v_mfma_f32_32x32x16_bf16 v[112:127], v[200:203], v[32:35], v[112:127]
    v_exp_f32 v12, v130
    v_add_f32 v8, v8, v11
    v_cvt_pk_bf16_f32 v152, v10, v11
    v_exp_f32 v13, v131
    v_add_f32 v8, v8, v12
    v_exp_f32 v10, v132
    v_add_f32 v8, v8, v13
    v_cvt_pk_bf16_f32 v153, v12, v13
    v_mfma_f32_32x32x16_bf16 v[112:127], v[208:211], v[36:39], v[112:127]
    s_waitcnt vmcnt(4) lgkmcnt(0)
    s_barrier
    s_add_u32 s62, s62, 32768
    s_cmp_eq_u32 s62, 98304
    s_cselect_b32 s62, 0, s62
    v_add_u32 v2, s62, v3
    ds_read_b128 v[180:183], v2 offset:16384
    ds_read_b128 v[192:195], v2 offset:17408
    v_exp_f32 v11, v133
    v_add_f32 v8, v8, v10
    v_exp_f32 v12, v134
    v_add_f32 v8, v8, v11
    v_cvt_pk_bf16_f32 v154, v10, v11
    v_mfma_f32_32x32x16_bf16 v[48:63], v[224:227], v[148:151], v[48:63]
    ds_read_b128 v[204:207], v2 offset:18432
    ds_read_b128 v[216:219], v2 offset:19456
    s_lshl_b32 s56, s50, 14
    s_add_u32 s74, s56, s55
    s_add_u32 s56, s56, s54
    s_cmp_lt_u32 s50, s51
    s_cselect_b32 s56, s56, s58
    s_mov_b32 m0, s53
    s_cselect_b32 s74, s74, s58
    buffer_load_dwordx4 v5, s[32:35], s56 offen sc1 lds
    v_exp_f32 v13, v135
    v_add_f32 v8, v8, v12
    v_exp_f32 v10, v136
    v_add_f32 v8, v8, v13
    v_cvt_pk_bf16_f32 v155, v12, v13
    v_exp_f32 v11, v137
    v_add_f32 v8, v8, v10
    v_mfma_f32_32x32x16_bf16 v[112:127], v[212:215], v[40:43], v[112:127]
    ds_read_b128 v[224:227], v2 offset:20480
    ds_read_b128 v[176:179], v2 offset:0
    buffer_load_dwordx4 v5, s[32:35], s56 offen offset:1024 sc1 lds
    s_add_u32 m0, s53, 16384
    s_add_u32 s50, s50, 1
    s_cmp_eq_u32 s50, s51
    v_exp_f32 v12, v138
    v_add_f32 v8, v8, v11
    v_cvt_pk_bf16_f32 v156, v10, v11
    v_exp_f32 v13, v139
    v_add_f32 v8, v8, v12
    v_mfma_f32_32x32x16_bf16 v[112:127], v[220:223], v[44:47], v[112:127]
    ds_read_b128 v[184:187], v2 offset:1024
    ds_read_b128 v[188:191], v2 offset:2048
    buffer_load_dwordx4 v5, s[32:35], s57 offen sc1 lds
    s_cselect_b32 s50, 0, s50
    s_cselect_b32 s51, s52, s51
    s_cselect_b32 s52, 0, s52
    v_exp_f32 v10, v140
    v_add_f32 v8, v8, v13
    v_cvt_pk_bf16_f32 v157, v12, v13
    v_exp_f32 v11, v141
    v_add_f32 v8, v8, v10
    v_exp_f32 v12, v142
    v_add_f32 v8, v8, v11
    v_cvt_pk_bf16_f32 v158, v10, v11
    v_mfma_f32_32x32x16_bf16 v[64:79], v[228:231], v[148:151], v[64:79]
    ds_read_b128 v[196:199], v2 offset:3072
    ds_read_b128 v[200:203], v2 offset:4096
    buffer_load_dwordx4 v5, s[32:35], s57 offen offset:1024 sc1 lds
    s_mov_b32 s57, s73
    s_mov_b32 s73, s74
    s_add_u32 s53, s53, 32768
    s_cmp_eq_u32 s53, s59
    s_cselect_b32 s53, s60, s53
    v_exp_f32 v13, v143
    v_add_f32 v8, v8, v12
    v_add_f32 v8, v8, v13
    v_cvt_pk_bf16_f32 v159, v12, v13
    v_mfma_f32_32x32x16_bf16 v[80:95], v[232:235], v[148:151], v[80:95]
    v_mfma_f32_32x32x16_bf16 v[96:111], v[236:239], v[148:151], v[96:111]
    v_cmp_nle_f32 vcc, v8, v250
    s_cbranch_vccnz fb_42
fbr_43:
    s_add_u32 s48, s40, 2
    s_cmp_gt_u32 s48, s41
    s_cselect_b64 vcc, -1, 0
    s_waitcnt lgkmcnt(9)
    s_cbranch_vccnz sk_44
    v_mfma_f32_32x32x16_bf16 v[48:63], v[180:183], v[152:155], v[48:63]
sk_44:
    ds_read_b128 v[228:231], v2 offset:21504
    v_mov_b32 v249, v8
    v_max3_f32 v0, v112, v113, v114
    v_max3_f32 v0, v0, v115, v116
    v_permlane32_swap_b32 v8, v249
    v_max3_f32 v0, v0, v117, v118
    v_max3_f32 v0, v0, v119, v120
    v_add_f32 v253, v8, v249
    v_mov_b32 v252, v160
    s_waitcnt lgkmcnt(9)
    s_cbranch_vccnz sk_45
    v_mfma_f32_32x32x16_bf16 v[64:79], v[192:195], v[152:155], v[64:79]
sk_45:
    ds_read_b128 v[232:235], v2 offset:22528
    v_max3_f32 v0, v0, v121, v122
    v_max3_f32 v0, v0, v123, v124
    ds_write_b64 v9, v[252:253]
    v_max3_f32 v0, v0, v125, v126
    v_max_f32 v0, v0, v127
    v_mov_b32 v8, 0
    v_mov_b32 v249, v0
    s_nop 1
    v_permlane32_swap_b32 v0, v249
    s_waitcnt lgkmcnt(10)
    s_cbranch_vccnz sk_46
    v_mfma_f32_32x32x16_bf16 v[80:95], v[204:207], v[152:155], v[80:95]
sk_46:
    ds_read_b128 v[236:239], v2 offset:23552
    v_max_f32 v0, v0, v249
    v_sub_f32 v160, 0, v0
    v_sub_f32 v161, 0, v0
    v_sub_f32 v162, 0, v0
    v_sub_f32 v163, 0, v0
    v_sub_f32 v164, 0, v0
    s_waitcnt lgkmcnt(10)
    s_cbranch_vccnz sk_47
    v_mfma_f32_32x32x16_bf16 v[96:111], v[216:219], v[152:155], v[96:111]
sk_47:
    ds_read_b128 v[208:211], v2 offset:5120
    v_sub_f32 v165, 0, v0
    v_sub_f32 v166, 0, v0
    v_sub_f32 v167, 0, v0
    v_sub_f32 v168, 0, v0
    v_sub_f32 v169, 0, v0
    v_sub_f32 v170, 0, v0
    v_sub_f32 v171, 0, v0
    s_waitcnt lgkmcnt(10)
    s_cbranch_vccnz sk_48
    v_mfma_f32_32x32x16_bf16 v[48:63], v[224:227], v[156:159], v[48:63]
sk_48:
    ds_read_b128 v[212:215], v2 offset:6144
    v_sub_f32 v172, 0, v0
    v_sub_f32 v173, 0, v0
    v_sub_f32 v174, 0, v0
    v_sub_f32 v175, 0, v0
    v_sub_f32 v112, v112, v0
    v_sub_f32 v113, v113, v0
    v_sub_f32 v114, v114, v0
    v_sub_f32 v115, v115, v0
    v_sub_f32 v116, v116, v0
    v_sub_f32 v117, v117, v0
    v_sub_f32 v118, v118, v0
    v_sub_f32 v119, v119, v0
    v_sub_f32 v120, v120, v0
    v_sub_f32 v121, v121, v0
    v_sub_f32 v122, v122, v0
    v_sub_f32 v123, v123, v0
    v_sub_f32 v124, v124, v0
    v_sub_f32 v125, v125, v0
    v_sub_f32 v126, v126, v0
    v_sub_f32 v127, v127, v0
    s_waitcnt lgkmcnt(10)
    v_mfma_f32_32x32x16_bf16 v[128:143], v[176:179], v[16:19], v[160:175]
    ds_read_b128 v[220:223], v2 offset:7168
    v_exp_f32 v10, v112
    v_exp_f32 v11, v113
    v_add_f32 v7, v8, v10
    s_waitcnt lgkmcnt(6)
    s_cbranch_vccnz sk_49
    v_mfma_f32_32x32x16_bf16 v[64:79], v[228:231], v[156:159], v[64:79]
sk_49:
    v_exp_f32 v12, v114
    v_add_f32 v7, v7, v11
    v_cvt_pk_bf16_f32 v144, v10, v11
    v_exp_f32 v13, v115
    v_add_f32 v7, v7, v12
    v_mfma_f32_32x32x16_bf16 v[128:143], v[184:187], v[20:23], v[128:143]
    v_exp_f32 v10, v116
    v_add_f32 v7, v7, v13
    v_cvt_pk_bf16_f32 v145, v12, v13
    v_exp_f32 v11, v117
    v_add_f32 v7, v7, v10
    s_waitcnt lgkmcnt(5)
    s_cbranch_vccnz sk_50
    v_mfma_f32_32x32x16_bf16 v[80:95], v[232:235], v[156:159], v[80:95]
sk_50:
    v_exp_f32 v12, v118
    v_add_f32 v7, v7, v11
    v_cvt_pk_bf16_f32 v146, v10, v11
    v_exp_f32 v13, v119
    v_add_f32 v7, v7, v12
    v_mfma_f32_32x32x16_bf16 v[128:143], v[188:191], v[24:27], v[128:143]
    s_waitcnt vmcnt(4) lgkmcnt(0)
    s_barrier
    s_add_u32 s62, s62, 32768
    s_cmp_eq_u32 s62, 98304
    s_cselect_b32 s62, 0, s62
    v_add_u32 v2, s62, v3
    ds_read_b64 v[254:255], v15
    ds_read_b128 v[176:179], v2 offset:0
    ds_read_b128 v[180:183], v2 offset:16384
    v_exp_f32 v10, v120
    v_add_f32 v7, v7, v13
    v_cvt_pk_bf16_f32 v147, v12, v13
    v_exp_f32 v11, v121
    v_add_f32 v7, v7, v10
    s_cbranch_vccnz sk_51
    v_mfma_f32_32x32x16_bf16 v[96:111], v[236:239], v[156:159], v[96:111]
sk_51:
    ds_read_b128 v[184:187], v2 offset:1024
    ds_read_b128 v[188:191], v2 offset:2048
    s_lshl_b32 s56, s50, 14
    s_add_u32 s74, s56, s55
    s_add_u32 s56, s56, s54
    s_cmp_lt_u32 s50, s51
    s_cselect_b32 s56, s56, s58
    s_mov_b32 m0, s53
    s_cselect_b32 s74, s74, s58
    buffer_load_dwordx4 v5, s[32:35], s56 offen sc1 lds
    v_exp_f32 v12, v122
    v_add_f32 v7, v7, v11
    v_cvt_pk_bf16_f32 v148, v10, v11
    v_exp_f32 v13, v123
    v_add_f32 v7, v7, v12
    v_mfma_f32_32x32x16_bf16 v[128:143], v[196:199], v[28:31], v[128:143]
    ds_read_b128 v[192:195], v2 offset:17408
    ds_read_b128 v[196:199], v2 offset:3072
    buffer_load_dwordx4 v5, s[32:35], s56 offen offset:1024 sc1 lds
    s_add_u32 m0, s53, 16384
    s_add_u32 s50, s50, 1
    s_cmp_eq_u32 s50, s51
    v_exp_f32 v10, v124
    v_add_f32 v7, v7, v13
    v_cvt_pk_bf16_f32 v149, v12, v13
    v_exp_f32 v11, v125
    v_add_f32 v7, v7, v10
    v_mfma_f32_32x32x16_bf16 v[128:143], v[200:203], v[32:35], v[128:143]
    ds_read_b128 v[200:203], v2 offset:4096
    ds_read_b128 v[204:207], v2 offset:18432
    buffer_load_dwordx4 v5, s[32:35], s57 offen sc1 lds
    s_cselect_b32 s50, 0, s50
    s_cselect_b32 s51, s52, s51
    s_cselect_b32 s52, 0, s52
    v_exp_f32 v12, v126
    v_add_f32 v7, v7, v11
    v_cvt_pk_bf16_f32 v150, v10, v11
    v_exp_f32 v13, v127
    v_add_f32 v7, v7, v12
    v_mfma_f32_32x32x16_bf16 v[128:143], v[208:211], v[36:39], v[128:143]
    ds_read_b128 v[208:211], v2 offset:5120
    buffer_load_dwordx4 v5, s[32:35], s57 offen offset:1024 sc1 lds
    s_mov_b32 s57, s73
    s_mov_b32 s73, s74
    s_add_u32 s53, s53, 32768
    s_cmp_eq_u32 s53, s59
    s_cselect_b32 s53, s60, s53
    v_add_f32 v7, v7, v13
    v_cvt_pk_bf16_f32 v151, v12, v13
    v_mfma_f32_32x32x16_bf16 v[128:143], v[212:215], v[40:43], v[128:143]
    ds_read_b128 v[212:215], v2 offset:6144
    v_mfma_f32_32x32x16_bf16 v[128:143], v[220:223], v[44:47], v[128:143]
    s_waitcnt lgkmcnt(10)
    v_min_f32 v0, v252, v254
    v_sub_f32 v252, v0, v252
    v_sub_f32 v254, v0, v254
    v_exp_f32 v252, v252
    v_exp_f32 v254, v254
    v_mul_f32 v253, v253, v252
    v_fmac_f32 v253, v255, v254
    v_rcp_f32 v253, v253
    s_nop 0
    v_mul_f32 v252, v252, v253
    s_lshl_b32 s48, s63, 2
    s_add_u32 s48, s48, s41
    s_lshl_b32 s48, s48, 18
    s_lshl_b32 s49, s45, 13
    s_add_u32 s48, s48, s49
    s_lshl_b32 s49, s40, 12
    s_add_u32 s48, s48, s49
    s_add_u32 s48, s48, 37748736
    s_cmp_eq_u32 s40, 0
    s_cbranch_scc0 mg_53
    v_mul_f32 v80, v80, v252
    v_mul_f32 v81, v81, v252
    v_mul_f32 v82, v82, v252
    v_mul_f32 v83, v83, v252
    ds_write_b128 v15, v[80:83] offset:0
    v_mul_f32 v84, v84, v252
    v_mul_f32 v85, v85, v252
    v_mul_f32 v86, v86, v252
    v_mul_f32 v87, v87, v252
    ds_write_b128 v15, v[84:87] offset:1024
    v_mul_f32 v88, v88, v252
    v_mul_f32 v89, v89, v252
    v_mul_f32 v90, v90, v252
    v_mul_f32 v91, v91, v252
    ds_write_b128 v15, v[88:91] offset:2048
    v_mul_f32 v92, v92, v252
    v_mul_f32 v93, v93, v252
    v_mul_f32 v94, v94, v252
    v_mul_f32 v95, v95, v252
    ds_write_b128 v15, v[92:95] offset:3072
    v_mul_f32 v96, v96, v252
    v_mul_f32 v97, v97, v252
    v_mul_f32 v98, v98, v252
    v_mul_f32 v99, v99, v252
    ds_write_b128 v15, v[96:99] offset:4096
    v_mul_f32 v100, v100, v252
    v_mul_f32 v101, v101, v252
    v_mul_f32 v102, v102, v252
    v_mul_f32 v103, v103, v252
    ds_write_b128 v15, v[100:103] offset:5120
    v_mul_f32 v104, v104, v252
    v_mul_f32 v105, v105, v252
    v_mul_f32 v106, v106, v252
    v_mul_f32 v107, v107, v252
    ds_write_b128 v15, v[104:107] offset:6144
    v_mul_f32 v108, v108, v252
    v_mul_f32 v109, v109, v252
    v_mul_f32 v110, v110, v252
    v_mul_f32 v111, v111, v252
    ds_write_b128 v15, v[108:111] offset:7168
    s_waitcnt lgkmcnt(0)
    s_barrier
    ds_read_b128 v[80:83], v9 offset:0
    ds_read_b128 v[84:87], v9 offset:1024
    ds_read_b128 v[88:91], v9 offset:2048
    ds_read_b128 v[92:95], v9 offset:3072
    ds_read_b128 v[96:99], v9 offset:4096
    ds_read_b128 v[100:103], v9 offset:5120
    ds_read_b128 v[104:107], v9 offset:6144
    ds_read_b128 v[108:111], v9 offset:7168
    s_waitcnt lgkmcnt(7)
    v_fmac_f32 v80, v48, v252
    v_fmac_f32 v81, v49, v252
    v_fmac_f32 v82, v50, v252
    v_fmac_f32 v83, v51, v252
    s_waitcnt lgkmcnt(6)
    v_fmac_f32 v84, v52, v252
    v_fmac_f32 v85, v53, v252
    v_fmac_f32 v86, v54, v252
    v_fmac_f32 v87, v55, v252
    v_cvt_pk_bf16_f32 v48, v80, v81
    v_cvt_pk_bf16_f32 v49, v82, v83
    v_cvt_pk_bf16_f32 v50, v84, v85
    v_cvt_pk_bf16_f32 v51, v86, v87
    buffer_store_dwordx4 v[48:51], v4, s[32:35], s48 offen offset:0 sc1
    v_mov_b32 v80, 0
    v_mov_b32 v81, 0
    v_mov_b32 v82, 0
    v_mov_b32 v83, 0
    v_mov_b32 v84, 0
    v_mov_b32 v85, 0
    v_mov_b32 v86, 0
    v_mov_b32 v87, 0
    v_mov_b32 v52, 0
    v_mov_b32 v53, 0
    v_mov_b32 v54, 0
    v_mov_b32 v55, 0
    s_waitcnt lgkmcnt(5)
    v_fmac_f32 v88, v56, v252
    v_fmac_f32 v89, v57, v252
    v_fmac_f32 v90, v58, v252
    v_fmac_f32 v91, v59, v252
    s_waitcnt lgkmcnt(4)
    v_fmac_f32 v92, v60, v252
    v_fmac_f32 v93, v61, v252
    v_fmac_f32 v94, v62, v252
    v_fmac_f32 v95, v63, v252
    v_cvt_pk_bf16_f32 v56, v88, v89
    v_cvt_pk_bf16_f32 v57, v90, v91
    v_cvt_pk_bf16_f32 v58, v92, v93
    v_cvt_pk_bf16_f32 v59, v94, v95
    buffer_store_dwordx4 v[56:59], v4, s[32:35], s48 offen offset:1024 sc1
    v_mov_b32 v88, 0
    v_mov_b32 v89, 0
    v_mov_b32 v90, 0
    v_mov_b32 v91, 0
    v_mov_b32 v92, 0
    v_mov_b32 v93, 0
    v_mov_b32 v94, 0
    v_mov_b32 v95, 0
    v_mov_b32 v60, 0
    v_mov_b32 v61, 0
    v_mov_b32 v62, 0
    v_mov_b32 v63, 0
    v_mov_b32 v48, 0
    v_mov_b32 v49, 0
    v_mov_b32 v50, 0
    v_mov_b32 v51, 0
    s_waitcnt lgkmcnt(3)
    v_fmac_f32 v96, v64, v252
    v_fmac_f32 v97, v65, v252
    v_fmac_f32 v98, v66, v252
    v_fmac_f32 v99, v67, v252
    s_waitcnt lgkmcnt(2)
    v_fmac_f32 v100, v68, v252
    v_fmac_f32 v101, v69, v252
    v_fmac_f32 v102, v70, v252
    v_fmac_f32 v103, v71, v252
    v_cvt_pk_bf16_f32 v64, v96, v97
    v_cvt_pk_bf16_f32 v65, v98, v99
    v_cvt_pk_bf16_f32 v66, v100, v101
    v_cvt_pk_bf16_f32 v67, v102, v103
    buffer_store_dwordx4 v[64:67], v4, s[32:35], s48 offen offset:2048 sc1
    v_mov_b32 v96, 0
    v_mov_b32 v97, 0
    v_mov_b32 v98, 0
    v_mov_b32 v99, 0
    v_mov_b32 v100, 0
    v_mov_b32 v101, 0
    v_mov_b32 v102, 0
    v_mov_b32 v103, 0
    v_mov_b32 v68, 0
    v_mov_b32 v69, 0
    v_mov_b32 v70, 0
    v_mov_b32 v71, 0
    v_mov_b32 v56, 0
    v_mov_b32 v57, 0
    v_mov_b32 v58, 0
    v_mov_b32 v59, 0
    s_waitcnt lgkmcnt(1)
    v_fmac_f32 v104, v72, v252
    v_fmac_f32 v105, v73, v252
    v_fmac_f32 v106, v74, v252
    v_fmac_f32 v107, v75, v252
    s_waitcnt lgkmcnt(0)
    v_fmac_f32 v108, v76, v252
    v_fmac_f32 v109, v77, v252
    v_fmac_f32 v110, v78, v252
    v_fmac_f32 v111, v79, v252
    v_cvt_pk_bf16_f32 v72, v104, v105
    v_cvt_pk_bf16_f32 v73, v106, v107
    v_cvt_pk_bf16_f32 v74, v108, v109
    v_cvt_pk_bf16_f32 v75, v110, v111
    buffer_store_dwordx4 v[72:75], v4, s[32:35], s48 offen offset:3072 sc1
    v_mov_b32 v104, 0
    v_mov_b32 v105, 0
    v_mov_b32 v106, 0
    v_mov_b32 v107, 0
    v_mov_b32 v108, 0
    v_mov_b32 v109, 0
    v_mov_b32 v110, 0
    v_mov_b32 v111, 0
    v_mov_b32 v76, 0
    v_mov_b32 v77, 0
    v_mov_b32 v78, 0
    v_mov_b32 v79, 0
    v_mov_b32 v64, 0
    v_mov_b32 v65, 0
    v_mov_b32 v66, 0
    v_mov_b32 v67, 0
    v_mov_b32 v72, 0
    v_mov_b32 v73, 0
    v_mov_b32 v74, 0
    v_mov_b32 v75, 0
    s_branch mg_54
mg_53:
    v_mul_f32 v48, v48, v252
    v_mul_f32 v49, v49, v252
    v_mul_f32 v50, v50, v252
    v_mul_f32 v51, v51, v252
    ds_write_b128 v15, v[48:51] offset:0
    v_mul_f32 v52, v52, v252
    v_mul_f32 v53, v53, v252
    v_mul_f32 v54, v54, v252
    v_mul_f32 v55, v55, v252
    ds_write_b128 v15, v[52:55] offset:1024
    v_mul_f32 v56, v56, v252
    v_mul_f32 v57, v57, v252
    v_mul_f32 v58, v58, v252
    v_mul_f32 v59, v59, v252
    ds_write_b128 v15, v[56:59] offset:2048
    v_mul_f32 v60, v60, v252
    v_mul_f32 v61, v61, v252
    v_mul_f32 v62, v62, v252
    v_mul_f32 v63, v63, v252
    ds_write_b128 v15, v[60:63] offset:3072
    v_mul_f32 v64, v64, v252
    v_mul_f32 v65, v65, v252
    v_mul_f32 v66, v66, v252
    v_mul_f32 v67, v67, v252
    ds_write_b128 v15, v[64:67] offset:4096
    v_mul_f32 v68, v68, v252
    v_mul_f32 v69, v69, v252
    v_mul_f32 v70, v70, v252
    v_mul_f32 v71, v71, v252
    ds_write_b128 v15, v[68:71] offset:5120
    v_mul_f32 v72, v72, v252
    v_mul_f32 v73, v73, v252
    v_mul_f32 v74, v74, v252
    v_mul_f32 v75, v75, v252
    ds_write_b128 v15, v[72:75] offset:6144
    v_mul_f32 v76, v76, v252
    v_mul_f32 v77, v77, v252
    v_mul_f32 v78, v78, v252
    v_mul_f32 v79, v79, v252
    ds_write_b128 v15, v[76:79] offset:7168
    s_waitcnt lgkmcnt(0)
    s_barrier
    ds_read_b128 v[48:51], v9 offset:0
    ds_read_b128 v[52:55], v9 offset:1024
    ds_read_b128 v[56:59], v9 offset:2048
    ds_read_b128 v[60:63], v9 offset:3072
    ds_read_b128 v[64:67], v9 offset:4096
    ds_read_b128 v[68:71], v9 offset:5120
    ds_read_b128 v[72:75], v9 offset:6144
    ds_read_b128 v[76:79], v9 offset:7168
    s_waitcnt lgkmcnt(7)
    v_fmac_f32 v48, v80, v252
    v_fmac_f32 v49, v81, v252
    v_fmac_f32 v50, v82, v252
    v_fmac_f32 v51, v83, v252
    s_waitcnt lgkmcnt(6)
    v_fmac_f32 v52, v84, v252
    v_fmac_f32 v53, v85, v252
    v_fmac_f32 v54, v86, v252
    v_fmac_f32 v55, v87, v252
    v_cvt_pk_bf16_f32 v80, v48, v49
    v_cvt_pk_bf16_f32 v81, v50, v51
    v_cvt_pk_bf16_f32 v82, v52, v53
    v_cvt_pk_bf16_f32 v83, v54, v55
    buffer_store_dwordx4 v[80:83], v4, s[32:35], s48 offen offset:0 sc1
    v_mov_b32 v48, 0
    v_mov_b32 v49, 0
    v_mov_b32 v50, 0
    v_mov_b32 v51, 0
    v_mov_b32 v52, 0
    v_mov_b32 v53, 0
    v_mov_b32 v54, 0
    v_mov_b32 v55, 0
    v_mov_b32 v84, 0
    v_mov_b32 v85, 0
    v_mov_b32 v86, 0
    v_mov_b32 v87, 0
    s_waitcnt lgkmcnt(5)
    v_fmac_f32 v56, v88, v252
    v_fmac_f32 v57, v89, v252
    v_fmac_f32 v58, v90, v252
    v_fmac_f32 v59, v91, v252
    s_waitcnt lgkmcnt(4)
    v_fmac_f32 v60, v92, v252
    v_fmac_f32 v61, v93, v252
    v_fmac_f32 v62, v94, v252
    v_fmac_f32 v63, v95, v252
    v_cvt_pk_bf16_f32 v88, v56, v57
    v_cvt_pk_bf16_f32 v89, v58, v59
    v_cvt_pk_bf16_f32 v90, v60, v61
    v_cvt_pk_bf16_f32 v91, v62, v63
    buffer_store_dwordx4 v[88:91], v4, s[32:35], s48 offen offset:1024 sc1
    v_mov_b32 v56, 0
    v_mov_b32 v57, 0
    v_mov_b32 v58, 0
    v_mov_b32 v59, 0
    v_mov_b32 v60, 0
    v_mov_b32 v61, 0
    v_mov_b32 v62, 0
    v_mov_b32 v63, 0
    v_mov_b32 v92, 0
    v_mov_b32 v93, 0
    v_mov_b32 v94, 0
    v_mov_b32 v95, 0
    v_mov_b32 v80, 0
    v_mov_b32 v81, 0
    v_mov_b32 v82, 0
    v_mov_b32 v83, 0
    s_waitcnt lgkmcnt(3)
    v_fmac_f32 v64, v96, v252
    v_fmac_f32 v65, v97, v252
    v_fmac_f32 v66, v98, v252
    v_fmac_f32 v67, v99, v252
    s_waitcnt lgkmcnt(2)
    v_fmac_f32 v68, v100, v252
    v_fmac_f32 v69, v101, v252
    v_fmac_f32 v70, v102, v252
    v_fmac_f32 v71, v103, v252
    v_cvt_pk_bf16_f32 v96, v64, v65
    v_cvt_pk_bf16_f32 v97, v66, v67
    v_cvt_pk_bf16_f32 v98, v68, v69
    v_cvt_pk_bf16_f32 v99, v70, v71
    buffer_store_dwordx4 v[96:99], v4, s[32:35], s48 offen offset:2048 sc1
    v_mov_b32 v64, 0
    v_mov_b32 v65, 0
    v_mov_b32 v66, 0
    v_mov_b32 v67, 0
    v_mov_b32 v68, 0
    v_mov_b32 v69, 0
    v_mov_b32 v70, 0
    v_mov_b32 v71, 0
    v_mov_b32 v100, 0
    v_mov_b32 v101, 0
    v_mov_b32 v102, 0
    v_mov_b32 v103, 0
    v_mov_b32 v88, 0
    v_mov_b32 v89, 0
    v_mov_b32 v90, 0
    v_mov_b32 v91, 0
    s_waitcnt lgkmcnt(1)
    v_fmac_f32 v72, v104, v252
    v_fmac_f32 v73, v105, v252
    v_fmac_f32 v74, v106, v252
    v_fmac_f32 v75, v107, v252
    s_waitcnt lgkmcnt(0)
    v_fmac_f32 v76, v108, v252
    v_fmac_f32 v77, v109, v252
    v_fmac_f32 v78, v110, v252
    v_fmac_f32 v79, v111, v252
    v_cvt_pk_bf16_f32 v104, v72, v73
    v_cvt_pk_bf16_f32 v105, v74, v75
    v_cvt_pk_bf16_f32 v106, v76, v77
    v_cvt_pk_bf16_f32 v107, v78, v79
    buffer_store_dwordx4 v[104:107], v4, s[32:35], s48 offen offset:3072 sc1
    v_mov_b32 v72, 0
    v_mov_b32 v73, 0
    v_mov_b32 v74, 0
    v_mov_b32 v75, 0
    v_mov_b32 v76, 0
    v_mov_b32 v77, 0
    v_mov_b32 v78, 0
    v_mov_b32 v79, 0
    v_mov_b32 v108, 0
    v_mov_b32 v109, 0
    v_mov_b32 v110, 0
    v_mov_b32 v111, 0
    v_mov_b32 v96, 0
    v_mov_b32 v97, 0
    v_mov_b32 v98, 0
    v_mov_b32 v99, 0
    v_mov_b32 v104, 0
    v_mov_b32 v105, 0
    v_mov_b32 v106, 0
    v_mov_b32 v107, 0
mg_54:
    s_mov_b32 s63, s47
    s_mov_b32 s43, 1
    s_mov_b32 s42, s47
    s_sub_u32 s75, s47, 1
    s_branch odd_23
.p2align 6
lastb_41:
    s_waitcnt lgkmcnt(8)
    v_mfma_f32_32x32x16_bf16 v[48:63], v[180:183], v[144:147], v[48:63]
    ds_read_b128 v[216:219], v2 offset:19456
    ds_read_b128 v[224:227], v2 offset:20480
    ds_read_b128 v[228:231], v2 offset:21504
    ds_read_b128 v[232:235], v2 offset:22528
    ds_read_b128 v[236:239], v2 offset:23552
    v_add_u32 v251, -64, v6
    v_cmp_le_i32 s[66:67], 0, v251
    v_cmp_le_i32 s[68:69], 1, v251
    v_cmp_le_i32 s[70:71], 2, v251
    v_cndmask_b32 v128, v248, v128, s[66:67]
    v_cmp_le_i32 s[66:67], 3, v251
    v_cndmask_b32 v129, v248, v129, s[68:69]
    s_waitcnt lgkmcnt(10)
    v_mfma_f32_32x32x16_bf16 v[64:79], v[192:195], v[144:147], v[64:79]
    v_cmp_le_i32 s[68:69], 8, v251
    v_cndmask_b32 v130, v248, v130, s[70:71]
    v_cmp_le_i32 s[70:71], 9, v251
    v_cndmask_b32 v131, v248, v131, s[66:67]
    v_cmp_le_i32 s[66:67], 10, v251
    v_cndmask_b32 v132, v248, v132, s[68:69]
    v_cmp_le_i32 s[68:69], 11, v251
    v_cndmask_b32 v133, v248, v133, s[70:71]
    v_cmp_le_i32 s[70:71], 16, v251
    v_cndmask_b32 v134, v248, v134, s[66:67]
    s_waitcnt lgkmcnt(7)
    v_mfma_f32_32x32x16_bf16 v[80:95], v[204:207], v[144:147], v[80:95]
    v_cmp_le_i32 s[66:67], 17, v251
    v_cndmask_b32 v135, v248, v135, s[68:69]
    v_cmp_le_i32 s[68:69], 18, v251
    v_cndmask_b32 v136, v248, v136, s[70:71]
    v_cmp_le_i32 s[70:71], 19, v251
    v_cndmask_b32 v137, v248, v137, s[66:67]
    v_cmp_le_i32 s[66:67], 24, v251
    v_cndmask_b32 v138, v248, v138, s[68:69]
    v_cmp_le_i32 s[68:69], 25, v251
    v_cndmask_b32 v139, v248, v139, s[70:71]
    s_waitcnt lgkmcnt(4)
    v_mfma_f32_32x32x16_bf16 v[96:111], v[216:219], v[144:147], v[96:111]
    s_waitcnt vmcnt(0) lgkmcnt(0)
    s_barrier
    s_add_u32 s62, s62, 32768
    s_cmp_eq_u32 s62, 98304
    s_cselect_b32 s62, 0, s62
    v_add_u32 v2, s62, v3
    ds_read_b128 v[180:183], v2 offset:16384
    ds_read_b128 v[192:195], v2 offset:17408
    v_cmp_le_i32 s[70:71], 26, v251
    v_cndmask_b32 v140, v248, v140, s[66:67]
    v_cmp_le_i32 s[66:67], 27, v251
    v_cndmask_b32 v141, v248, v141, s[68:69]
    v_cndmask_b32 v142, v248, v142, s[70:71]
    v_cndmask_b32 v143, v248, v143, s[66:67]
    v_exp_f32 v10, v128
    v_exp_f32 v11, v129
    v_add_f32 v8, v7, v10
    v_mfma_f32_32x32x16_bf16 v[48:63], v[224:227], v[148:151], v[48:63]
    ds_read_b128 v[204:207], v2 offset:18432
    ds_read_b128 v[216:219], v2 offset:19456
    buffer_load_dword v247, v241, s[32:35], s4 offen sc1
    buffer_load_dword v245, v244, s[8:11], 0 offen sc1
    s_bfe_u32 s51, s44, 0x10001
    s_lshr_b32 s52, s44, 2
    s_and_b32 s49, s44, 1
    s_lshl_b32 s53, s45, 1
    s_add_u32 m0, s17, 32768
    s_nop 0
    buffer_load_dwordx4 v242, s[28:31], s7 offen lds
    s_add_u32 s7, s7, 4096
    s_add_u32 s53, s53, s52
    s_lshl_b32 s54, s46, 1
    s_add_u32 s54, s54, s51
    s_lshl_b32 s54, s54, 1
    v_exp_f32 v12, v130
    v_add_f32 v8, v8, v11
    v_cvt_pk_bf16_f32 v152, v10, v11
    v_exp_f32 v13, v131
    v_add_f32 v8, v8, v12
    v_exp_f32 v10, v132
    v_add_f32 v8, v8, v13
    v_cvt_pk_bf16_f32 v153, v12, v13
    v_exp_f32 v11, v133
    v_add_f32 v8, v8, v10
    v_exp_f32 v12, v134
    v_add_f32 v8, v8, v11
    v_cvt_pk_bf16_f32 v154, v10, v11
    v_mfma_f32_32x32x16_bf16 v[64:79], v[228:231], v[148:151], v[64:79]
    ds_read_b128 v[224:227], v2 offset:20480
    ds_read_b128 v[228:231], v2 offset:21504
    s_add_u32 m0, s17, 33792
    s_nop 0
    buffer_load_dwordx4 v242, s[28:31], s7 offen lds
    s_add_u32 s7, s7, 4096
    s_add_u32 s54, s54, s49
    s_lshl_b32 s55, s53, 15
    s_lshl_b32 s56, s54, 5
    s_add_u32 s55, s55, s56
    s_add_u32 m0, s17, 34816
    s_nop 0
    buffer_load_dwordx4 v242, s[28:31], s7 offen lds
    s_add_u32 s7, s7, 4096
    s_lshl_b32 s56, s53, 15
    s_lshl_b32 s57, s54, 10
    s_add_u32 s56, s56, s57
    s_add_u32 s56, s56, 62914560
    v_exp_f32 v13, v135
    v_add_f32 v8, v8, v12
    v_exp_f32 v10, v136
    v_add_f32 v8, v8, v13
    v_cvt_pk_bf16_f32 v155, v12, v13
    v_exp_f32 v11, v137
    v_add_f32 v8, v8, v10
    v_exp_f32 v12, v138
    v_add_f32 v8, v8, v11
    v_cvt_pk_bf16_f32 v156, v10, v11
    v_exp_f32 v13, v139
    v_add_f32 v8, v8, v12
    v_mfma_f32_32x32x16_bf16 v[80:95], v[232:235], v[148:151], v[80:95]
    ds_read_b128 v[232:235], v2 offset:22528
    s_add_u32 m0, s17, 35840
    s_nop 0
    buffer_load_dwordx4 v242, s[28:31], s7 offen lds
    s_add_u32 s7, s7, 118784
    s_bfe_u32 s48, s7, 0x20011
    s_cselect_b32 s48, 0, 0x80000
    s_sub_u32 s7, s7, s48
    s_lshl_b32 s57, s53, 13
    s_lshl_b32 s49, s54, 8
    s_add_u32 s57, s57, s49
    s_add_u32 s57, s57, 73400320
    s_add_u32 m0, s17, 65536
    s_nop 0
    buffer_load_dwordx4 v242, s[28:31], s7 offen lds
    s_add_u32 s7, s7, 4096
    s_mul_i32 s58, s46, 229376
    s_mul_i32 s50, s44, 14336
    s_add_u32 s58, s58, s50
    s_add_u32 s58, s58, 60817408
    v_exp_f32 v10, v140
    v_add_f32 v8, v8, v13
    v_cvt_pk_bf16_f32 v157, v12, v13
    v_exp_f32 v11, v141
    v_add_f32 v8, v8, v10
    v_exp_f32 v12, v142
    v_add_f32 v8, v8, v11
    v_cvt_pk_bf16_f32 v158, v10, v11
    v_exp_f32 v13, v143
    v_add_f32 v8, v8, v12
    v_add_f32 v8, v8, v13
    v_cvt_pk_bf16_f32 v159, v12, v13
    v_mfma_f32_32x32x16_bf16 v[96:111], v[236:239], v[148:151], v[96:111]
    ds_read_b128 v[236:239], v2 offset:23552
    s_add_u32 m0, s17, 66560
    s_nop 0
    buffer_load_dwordx4 v242, s[28:31], s7 offen lds
    s_add_u32 s7, s7, 4096
    s_mul_i32 s61, s46, 7
    s_add_u32 s61, s61, s44
    s_lshl_b32 s59, s61, 15
    s_add_u32 s59, s59, 58720256
    s_add_u32 m0, s17, 67584
    s_nop 0
    buffer_load_dwordx4 v242, s[28:31], s7 offen lds
    s_add_u32 s7, s7, 4096
    s_cmp_eq_u32 s44, 7
    s_cselect_b32 s59, 1073741824, s59
    s_cmp_eq_u32 s44, 6
    s_cselect_b32 s60, 0x02020202, 0
    s_add_u32 m0, s17, 68608
    s_nop 0
    buffer_load_dwordx4 v242, s[28:31], s7 offen lds
    s_add_u32 s7, s7, 118784
    s_bfe_u32 s48, s7, 0x20011
    s_cselect_b32 s48, 0, 0x80000
    s_sub_u32 s7, s7, s48
    v_cmp_nle_f32 vcc, v8, v250
    s_cbranch_vccnz fb_55
fbr_56:
    s_add_u32 s48, s40, 2
    s_cmp_gt_u32 s48, s41
    s_cselect_b64 vcc, -1, 0
    s_waitcnt lgkmcnt(7)
    s_cbranch_vccnz sk_57
    v_mfma_f32_32x32x16_bf16 v[48:63], v[180:183], v[152:155], v[48:63]
sk_57:
    s_waitcnt lgkmcnt(6)
    s_cbranch_vccnz sk_58
    v_mfma_f32_32x32x16_bf16 v[64:79], v[192:195], v[152:155], v[64:79]
sk_58:
    s_waitcnt lgkmcnt(5)
    s_cbranch_vccnz sk_59
    v_mfma_f32_32x32x16_bf16 v[80:95], v[204:207], v[152:155], v[80:95]
sk_59:
    s_waitcnt lgkmcnt(4)
    s_cbranch_vccnz sk_60
    v_mfma_f32_32x32x16_bf16 v[96:111], v[216:219], v[152:155], v[96:111]
sk_60:
    v_mov_b32 v249, v8
    s_nop 1
    v_permlane32_swap_b32 v8, v249
    v_add_f32 v253, v8, v249
    v_mov_b32 v252, v160
    ds_write_b64 v9, v[252:253]
    s_waitcnt lgkmcnt(0)
    s_barrier
    s_add_u32 s62, s62, 32768
    s_cmp_eq_u32 s62, 98304
    s_cselect_b32 s62, 0, s62
    v_add_u32 v2, s62, v3
    ds_read_b64 v[254:255], v15
    s_cbranch_vccnz sk_61
    v_mfma_f32_32x32x16_bf16 v[48:63], v[224:227], v[156:159], v[48:63]
sk_61:
    s_add_u32 m0, s17, 0
    s_nop 0
    buffer_load_dwordx4 v242, s[28:31], s7 offen lds
    s_add_u32 s7, s7, 4096
    s_cbranch_vccnz sk_62
    v_mfma_f32_32x32x16_bf16 v[64:79], v[228:231], v[156:159], v[64:79]
sk_62:
    s_add_u32 m0, s17, 1024
    s_nop 0
    buffer_load_dwordx4 v242, s[28:31], s7 offen lds
    s_add_u32 s7, s7, 4096
    s_cbranch_vccnz sk_63
    v_mfma_f32_32x32x16_bf16 v[80:95], v[232:235], v[156:159], v[80:95]
sk_63:
    s_add_u32 m0, s17, 2048
    s_nop 0
    buffer_load_dwordx4 v242, s[28:31], s7 offen lds
    s_add_u32 s7, s7, 4096
    s_cbranch_vccnz sk_64
    v_mfma_f32_32x32x16_bf16 v[96:111], v[236:239], v[156:159], v[96:111]
sk_64:
    s_add_u32 m0, s17, 3072
    s_nop 0
    buffer_load_dwordx4 v242, s[28:31], s7 offen lds
    s_add_u32 s7, s7, 118784
    s_bfe_u32 s48, s7, 0x20011
    s_cselect_b32 s48, 0, 0x80000
    s_sub_u32 s7, s7, s48
    s_waitcnt vmcnt(13)
    v_and_b32 v247, 4, v247
    v_cmp_ne_u32 vcc, 4, v247
    s_cbranch_vccnz spin_65
spb_66:
    s_waitcnt vmcnt(12)
    v_and_b32 v245, s60, v245
    v_cmp_ne_u32 vcc, s60, v245
    s_cbranch_vccnz spin_67
spb_68:
    buffer_load_dwordx4 v[16:19], v4, s[32:35], s12 offen offset:0 sc1
    buffer_load_dwordx4 v[20:23], v4, s[32:35], s12 offen offset:1024 sc1
    buffer_load_dwordx4 v[24:27], v4, s[32:35], s12 offen offset:2048 sc1
    buffer_load_dwordx4 v[28:31], v4, s[32:35], s12 offen offset:3072 sc1
    s_add_u32 s12, s12, 4096
    buffer_load_dwordx4 v[32:35], v4, s[32:35], s12 offen offset:0 sc1
    buffer_load_dwordx4 v[36:39], v4, s[32:35], s12 offen offset:1024 sc1
    buffer_load_dwordx4 v[40:43], v4, s[32:35], s12 offen offset:2048 sc1
    buffer_load_dwordx4 v[44:47], v4, s[32:35], s12 offen offset:3072 sc1
    s_add_u32 s12, s12, 4096
    s_bfe_u32 s48, s12, 0x2000d
    s_cselect_b32 s48, 0, 0x8000
    s_sub_u32 s12, s12, s48
    s_waitcnt lgkmcnt(0)
    v_min_f32 v0, v252, v254
    v_sub_f32 v252, v0, v252
    v_sub_f32 v254, v0, v254
    v_exp_f32 v252, v252
    v_exp_f32 v254, v254
    v_mul_f32 v253, v253, v252
    v_fmac_f32 v253, v255, v254
    v_rcp_f32 v253, v253
    s_nop 0
    v_mul_f32 v252, v252, v253
    s_lshl_b32 s48, s63, 2
    s_add_u32 s48, s48, s41
    s_lshl_b32 s48, s48, 18
    s_lshl_b32 s49, s45, 13
    s_add_u32 s48, s48, s49
    s_lshl_b32 s49, s40, 12
    s_add_u32 s48, s48, s49
    s_add_u32 s48, s48, 37748736
    s_cmp_eq_u32 s40, 0
    s_cbranch_scc0 mg_70
    v_mul_f32 v80, v80, v252
    v_mul_f32 v81, v81, v252
    v_mul_f32 v82, v82, v252
    v_mul_f32 v83, v83, v252
    ds_write_b128 v15, v[80:83] offset:0
    v_mul_f32 v84, v84, v252
    v_mul_f32 v85, v85, v252
    v_mul_f32 v86, v86, v252
    v_mul_f32 v87, v87, v252
    ds_write_b128 v15, v[84:87] offset:1024
    v_mul_f32 v88, v88, v252
    v_mul_f32 v89, v89, v252
    v_mul_f32 v90, v90, v252
    v_mul_f32 v91, v91, v252
    ds_write_b128 v15, v[88:91] offset:2048
    v_mul_f32 v92, v92, v252
    v_mul_f32 v93, v93, v252
    v_mul_f32 v94, v94, v252
    v_mul_f32 v95, v95, v252
    ds_write_b128 v15, v[92:95] offset:3072
    v_mul_f32 v96, v96, v252
    v_mul_f32 v97, v97, v252
    v_mul_f32 v98, v98, v252
    v_mul_f32 v99, v99, v252
    ds_write_b128 v15, v[96:99] offset:4096
    v_mul_f32 v100, v100, v252
    v_mul_f32 v101, v101, v252
    v_mul_f32 v102, v102, v252
    v_mul_f32 v103, v103, v252
    ds_write_b128 v15, v[100:103] offset:5120
    v_mul_f32 v104, v104, v252
    v_mul_f32 v105, v105, v252
    v_mul_f32 v106, v106, v252
    v_mul_f32 v107, v107, v252
    ds_write_b128 v15, v[104:107] offset:6144
    v_mul_f32 v108, v108, v252
    v_mul_f32 v109, v109, v252
    v_mul_f32 v110, v110, v252
    v_mul_f32 v111, v111, v252
    ds_write_b128 v15, v[108:111] offset:7168
    s_waitcnt vmcnt(12)
    s_waitcnt lgkmcnt(0)
    s_barrier
    ds_read_b128 v[112:115], v9 offset:0
    ds_read_b128 v[116:119], v9 offset:1024
    ds_read_b128 v[120:123], v9 offset:2048
    ds_read_b128 v[124:127], v9 offset:3072
    ds_read_b128 v[128:131], v9 offset:4096
    ds_read_b128 v[132:135], v9 offset:5120
    ds_read_b128 v[136:139], v9 offset:6144
    ds_read_b128 v[140:143], v9 offset:7168
    s_waitcnt lgkmcnt(7)
    v_fmac_f32 v112, v48, v252
    v_fmac_f32 v113, v49, v252
    v_fmac_f32 v114, v50, v252
    v_fmac_f32 v115, v51, v252
    s_waitcnt lgkmcnt(6)
    v_fmac_f32 v116, v52, v252
    v_fmac_f32 v117, v53, v252
    v_fmac_f32 v118, v54, v252
    v_fmac_f32 v119, v55, v252
    v_cvt_pk_bf16_f32 v144, v112, v113
    v_cvt_pk_bf16_f32 v145, v114, v115
    v_cvt_pk_bf16_f32 v146, v116, v117
    v_cvt_pk_bf16_f32 v147, v118, v119
    buffer_store_dwordx4 v[144:147], v4, s[32:35], s48 offen offset:0 sc1
    s_waitcnt lgkmcnt(5)
    v_fmac_f32 v120, v56, v252
    v_fmac_f32 v121, v57, v252
    v_fmac_f32 v122, v58, v252
    v_fmac_f32 v123, v59, v252
    s_waitcnt lgkmcnt(4)
    v_fmac_f32 v124, v60, v252
    v_fmac_f32 v125, v61, v252
    v_fmac_f32 v126, v62, v252
    v_fmac_f32 v127, v63, v252
    v_cvt_pk_bf16_f32 v148, v120, v121
    v_cvt_pk_bf16_f32 v149, v122, v123
    v_cvt_pk_bf16_f32 v150, v124, v125
    v_cvt_pk_bf16_f32 v151, v126, v127
    buffer_store_dwordx4 v[148:151], v4, s[32:35], s48 offen offset:1024 sc1
    s_waitcnt lgkmcnt(3)
    v_fmac_f32 v128, v64, v252
    v_fmac_f32 v129, v65, v252
    v_fmac_f32 v130, v66, v252
    v_fmac_f32 v131, v67, v252
    s_waitcnt lgkmcnt(2)
    v_fmac_f32 v132, v68, v252
    v_fmac_f32 v133, v69, v252
    v_fmac_f32 v134, v70, v252
    v_fmac_f32 v135, v71, v252
    v_cvt_pk_bf16_f32 v152, v128, v129
    v_cvt_pk_bf16_f32 v153, v130, v131
    v_cvt_pk_bf16_f32 v154, v132, v133
    v_cvt_pk_bf16_f32 v155, v134, v135
    buffer_store_dwordx4 v[152:155], v4, s[32:35], s48 offen offset:2048 sc1
    s_waitcnt lgkmcnt(1)
    v_fmac_f32 v136, v72, v252
    v_fmac_f32 v137, v73, v252
    v_fmac_f32 v138, v74, v252
    v_fmac_f32 v139, v75, v252
    s_waitcnt lgkmcnt(0)
    v_fmac_f32 v140, v76, v252
    v_fmac_f32 v141, v77, v252
    v_fmac_f32 v142, v78, v252
    v_fmac_f32 v143, v79, v252
    v_cvt_pk_bf16_f32 v156, v136, v137
    v_cvt_pk_bf16_f32 v157, v138, v139
    v_cvt_pk_bf16_f32 v158, v140, v141
    v_cvt_pk_bf16_f32 v159, v142, v143
    buffer_store_dwordx4 v[156:159], v4, s[32:35], s48 offen offset:3072 sc1
    s_lshl_b32 s48, s17, 1
    s_add_u32 m0, s48, 98304
    s_nop 0
    buffer_load_dwordx4 v242, s[28:31], s7 offen lds
    s_add_u32 s7, s7, 4096
    s_lshl_b32 s48, s17, 1
    s_add_u32 m0, s48, 99328
    s_nop 0
    buffer_load_dwordx4 v242, s[28:31], s7 offen lds
    s_add_u32 s7, s7, 4096
    s_lshl_b32 s48, s17, 1
    s_add_u32 m0, s48, 100352
    s_nop 0
    buffer_load_dwordx4 v242, s[28:31], s7 offen lds
    s_add_u32 s7, s7, 4096
    s_lshl_b32 s48, s17, 1
    s_add_u32 m0, s48, 101376
    s_nop 0
    buffer_load_dwordx4 v242, s[28:31], s7 offen lds
    s_add_u32 s7, s7, 118784
    v_xor_b32 v244, 64, v243
    v_xor_b32 v245, 128, v243
    v_xor_b32 v246, 192, v243
    v_add_u32 v248, 0x10000, v243
    v_add_u32 v249, 0x10000, v244
    v_add_u32 v250, 0x10000, v245
    v_add_u32 v251, 0x10000, v246
    ds_read_b64_tr_b16 v[112:113], v243 offset:32768
    ds_read_b64_tr_b16 v[114:115], v243 offset:34816
    ds_read_b64_tr_b16 v[116:117], v244 offset:32768
    ds_read_b64_tr_b16 v[118:119], v244 offset:34816
    ds_read_b64_tr_b16 v[120:121], v245 offset:32768
    ds_read_b64_tr_b16 v[122:123], v245 offset:34816
    ds_read_b64_tr_b16 v[124:125], v246 offset:32768
    ds_read_b64_tr_b16 v[126:127], v246 offset:34816
    ds_read_b64_tr_b16 v[128:129], v243 offset:36864
    ds_read_b64_tr_b16 v[130:131], v243 offset:38912
    ds_read_b64_tr_b16 v[132:133], v244 offset:36864
    ds_read_b64_tr_b16 v[134:135], v244 offset:38912
    ds_read_b64_tr_b16 v[136:137], v245 offset:36864
    ds_read_b64_tr_b16 v[138:139], v245 offset:38912
    ds_read_b64_tr_b16 v[140:141], v246 offset:36864
    ds_read_b64_tr_b16 v[142:143], v246 offset:38912
    buffer_load_dwordx4 v[176:179], v4, s[32:35], s12 offen offset:0 sc1
    buffer_load_dwordx4 v[184:187], v4, s[32:35], s12 offen offset:1024 sc1
    buffer_load_dwordx4 v[188:191], v4, s[32:35], s12 offen offset:2048 sc1
    buffer_load_dwordx4 v[196:199], v4, s[32:35], s12 offen offset:3072 sc1
    s_add_u32 s12, s12, 4096
    buffer_load_dwordx4 v[200:203], v4, s[32:35], s12 offen offset:0 sc1
    buffer_load_dwordx4 v[208:211], v4, s[32:35], s12 offen offset:1024 sc1
    buffer_load_dwordx4 v[212:215], v4, s[32:35], s12 offen offset:2048 sc1
    buffer_load_dwordx4 v[220:223], v4, s[32:35], s12 offen offset:3072 sc1
    s_add_u32 s12, s12, 4096
    s_bfe_u32 s48, s12, 0x2000d
    s_cselect_b32 s48, 0, 0x8000
    s_sub_u32 s12, s12, s48
    buffer_load_dwordx4 v[180:183], v4, s[32:35], s12 offen offset:0 sc1
    buffer_load_dwordx4 v[192:195], v4, s[32:35], s12 offen offset:1024 sc1
    buffer_load_dwordx4 v[204:207], v4, s[32:35], s12 offen offset:2048 sc1
    buffer_load_dwordx4 v[216:219], v4, s[32:35], s12 offen offset:3072 sc1
    s_add_u32 s12, s12, 4096
    buffer_load_dwordx4 v[224:227], v4, s[32:35], s12 offen offset:0 sc1
    buffer_load_dwordx4 v[228:231], v4, s[32:35], s12 offen offset:1024 sc1
    buffer_load_dwordx4 v[232:235], v4, s[32:35], s12 offen offset:2048 sc1
    buffer_load_dwordx4 v[236:239], v4, s[32:35], s12 offen offset:3072 sc1
    s_add_u32 s12, s12, 4096
    s_bfe_u32 s48, s12, 0x2000d
    s_cselect_b32 s48, 0, 0x8000
    s_sub_u32 s12, s12, s48
    buffer_load_dwordx4 v[144:147], v4, s[32:35], s12 offen offset:0 sc1
    buffer_load_dwordx4 v[148:151], v4, s[32:35], s12 offen offset:1024 sc1
    buffer_load_dwordx4 v[152:155], v4, s[32:35], s12 offen offset:2048 sc1
    buffer_load_dwordx4 v[156:159], v4, s[32:35], s12 offen offset:3072 sc1
    s_add_u32 s12, s12, 4096
    s_waitcnt vmcnt(35) lgkmcnt(14)
    v_mfma_f32_32x32x16_bf16 v[48:63], v[112:115], v[16:19], 0
    ds_read_b64_tr_b16 v[160:161], v243 offset:40960
    ds_read_b64_tr_b16 v[162:163], v243 offset:43008
    v_and_b32 v2, 31, v1
    v_lshrrev_b32 v3, 5, v1
    s_waitcnt lgkmcnt(14)
    v_mfma_f32_32x32x16_bf16 v[64:79], v[116:119], v[16:19], 0
    ds_read_b64_tr_b16 v[164:165], v244 offset:40960
    ds_read_b64_tr_b16 v[166:167], v244 offset:43008
    v_lshlrev_b32 v9, 10, v2
    s_waitcnt lgkmcnt(14)
    v_mfma_f32_32x32x16_bf16 v[80:95], v[120:123], v[16:19], 0
    ds_read_b64_tr_b16 v[168:169], v245 offset:40960
    ds_read_b64_tr_b16 v[170:171], v245 offset:43008
    v_lshlrev_b32 v10, 4, v3
    s_waitcnt lgkmcnt(14)
    v_mfma_f32_32x32x16_bf16 v[96:111], v[124:127], v[16:19], 0
    ds_read_b64_tr_b16 v[172:173], v246 offset:40960
    ds_read_b64_tr_b16 v[174:175], v246 offset:43008
    v_add_u32 v9, v9, v10
    s_waitcnt vmcnt(34) lgkmcnt(14)
    v_mfma_f32_32x32x16_bf16 v[48:63], v[128:131], v[20:23], v[48:63]
    ds_read_b64_tr_b16 v[112:113], v243 offset:45056
    ds_read_b64_tr_b16 v[114:115], v243 offset:47104
    buffer_load_dwordx4 v[16:19], v4, s[32:35], s12 offen offset:0 sc1
    s_waitcnt lgkmcnt(14)
    v_mfma_f32_32x32x16_bf16 v[64:79], v[132:135], v[20:23], v[64:79]
    ds_read_b64_tr_b16 v[116:117], v244 offset:45056
    ds_read_b64_tr_b16 v[118:119], v244 offset:47104
    s_waitcnt lgkmcnt(14)
    v_mfma_f32_32x32x16_bf16 v[80:95], v[136:139], v[20:23], v[80:95]
    ds_read_b64_tr_b16 v[120:121], v245 offset:45056
    ds_read_b64_tr_b16 v[122:123], v245 offset:47104
    s_waitcnt lgkmcnt(14)
    v_mfma_f32_32x32x16_bf16 v[96:111], v[140:143], v[20:23], v[96:111]
    ds_read_b64_tr_b16 v[124:125], v246 offset:45056
    ds_read_b64_tr_b16 v[126:127], v246 offset:47104
    s_waitcnt vmcnt(34) lgkmcnt(14)
    v_mfma_f32_32x32x16_bf16 v[48:63], v[160:163], v[24:27], v[48:63]
    ds_read_b64_tr_b16 v[128:129], v243 offset:49152
    ds_read_b64_tr_b16 v[130:131], v243 offset:51200
    buffer_load_dwordx4 v[20:23], v4, s[32:35], s12 offen offset:1024 sc1
    s_waitcnt lgkmcnt(14)
    v_mfma_f32_32x32x16_bf16 v[64:79], v[164:167], v[24:27], v[64:79]
    ds_read_b64_tr_b16 v[132:133], v244 offset:49152
    ds_read_b64_tr_b16 v[134:135], v244 offset:51200
    s_waitcnt lgkmcnt(14)
    v_mfma_f32_32x32x16_bf16 v[80:95], v[168:171], v[24:27], v[80:95]
    ds_read_b64_tr_b16 v[136:137], v245 offset:49152
    ds_read_b64_tr_b16 v[138:139], v245 offset:51200
    s_waitcnt lgkmcnt(14)
    v_mfma_f32_32x32x16_bf16 v[96:111], v[172:175], v[24:27], v[96:111]
    ds_read_b64_tr_b16 v[140:141], v246 offset:49152
    ds_read_b64_tr_b16 v[142:143], v246 offset:51200
    s_waitcnt vmcnt(34) lgkmcnt(14)
    v_mfma_f32_32x32x16_bf16 v[48:63], v[112:115], v[28:31], v[48:63]
    ds_read_b64_tr_b16 v[160:161], v243 offset:53248
    ds_read_b64_tr_b16 v[162:163], v243 offset:55296
    buffer_load_dwordx4 v[24:27], v4, s[32:35], s12 offen offset:2048 sc1
    s_waitcnt lgkmcnt(14)
    v_mfma_f32_32x32x16_bf16 v[64:79], v[116:119], v[28:31], v[64:79]
    ds_read_b64_tr_b16 v[164:165], v244 offset:53248
    ds_read_b64_tr_b16 v[166:167], v244 offset:55296
    s_waitcnt lgkmcnt(14)
    v_mfma_f32_32x32x16_bf16 v[80:95], v[120:123], v[28:31], v[80:95]
    ds_read_b64_tr_b16 v[168:169], v245 offset:53248
    ds_read_b64_tr_b16 v[170:171], v245 offset:55296
    s_waitcnt lgkmcnt(14)
    v_mfma_f32_32x32x16_bf16 v[96:111], v[124:127], v[28:31], v[96:111]
    ds_read_b64_tr_b16 v[172:173], v246 offset:53248
    ds_read_b64_tr_b16 v[174:175], v246 offset:55296
    s_waitcnt vmcnt(34) lgkmcnt(14)
    v_mfma_f32_32x32x16_bf16 v[48:63], v[128:131], v[32:35], v[48:63]
    ds_read_b64_tr_b16 v[112:113], v243 offset:57344
    ds_read_b64_tr_b16 v[114:115], v243 offset:59392
    buffer_load_dwordx4 v[28:31], v4, s[32:35], s12 offen offset:3072 sc1
    s_add_u32 s12, s12, 4096
    s_waitcnt lgkmcnt(14)
    v_mfma_f32_32x32x16_bf16 v[64:79], v[132:135], v[32:35], v[64:79]
    ds_read_b64_tr_b16 v[116:117], v244 offset:57344
    ds_read_b64_tr_b16 v[118:119], v244 offset:59392
    s_waitcnt lgkmcnt(14)
    v_mfma_f32_32x32x16_bf16 v[80:95], v[136:139], v[32:35], v[80:95]
    ds_read_b64_tr_b16 v[120:121], v245 offset:57344
    ds_read_b64_tr_b16 v[122:123], v245 offset:59392
    s_waitcnt lgkmcnt(14)
    v_mfma_f32_32x32x16_bf16 v[96:111], v[140:143], v[32:35], v[96:111]
    ds_read_b64_tr_b16 v[124:125], v246 offset:57344
    ds_read_b64_tr_b16 v[126:127], v246 offset:59392
    s_waitcnt vmcnt(34) lgkmcnt(14)
    v_mfma_f32_32x32x16_bf16 v[48:63], v[160:163], v[36:39], v[48:63]
    ds_read_b64_tr_b16 v[128:129], v243 offset:61440
    ds_read_b64_tr_b16 v[130:131], v243 offset:63488
    s_waitcnt lgkmcnt(14)
    v_mfma_f32_32x32x16_bf16 v[64:79], v[164:167], v[36:39], v[64:79]
    ds_read_b64_tr_b16 v[132:133], v244 offset:61440
    ds_read_b64_tr_b16 v[134:135], v244 offset:63488
    s_waitcnt lgkmcnt(14)
    v_mfma_f32_32x32x16_bf16 v[80:95], v[168:171], v[36:39], v[80:95]
    ds_read_b64_tr_b16 v[136:137], v245 offset:61440
    ds_read_b64_tr_b16 v[138:139], v245 offset:63488
    s_waitcnt lgkmcnt(14)
    v_mfma_f32_32x32x16_bf16 v[96:111], v[172:175], v[36:39], v[96:111]
    ds_read_b64_tr_b16 v[140:141], v246 offset:61440
    ds_read_b64_tr_b16 v[142:143], v246 offset:63488
    s_waitcnt vmcnt(33) lgkmcnt(14)
    v_mfma_f32_32x32x16_bf16 v[48:63], v[112:115], v[40:43], v[48:63]
    ds_read_b64_tr_b16 v[160:161], v248 offset:0
    ds_read_b64_tr_b16 v[162:163], v248 offset:2048
    s_waitcnt lgkmcnt(14)
    v_mfma_f32_32x32x16_bf16 v[64:79], v[116:119], v[40:43], v[64:79]
    ds_read_b64_tr_b16 v[164:165], v249 offset:0
    ds_read_b64_tr_b16 v[166:167], v249 offset:2048
    s_waitcnt lgkmcnt(14)
    v_mfma_f32_32x32x16_bf16 v[80:95], v[120:123], v[40:43], v[80:95]
    ds_read_b64_tr_b16 v[168:169], v250 offset:0
    ds_read_b64_tr_b16 v[170:171], v250 offset:2048
    s_waitcnt lgkmcnt(14)
    v_mfma_f32_32x32x16_bf16 v[96:111], v[124:127], v[40:43], v[96:111]
    ds_read_b64_tr_b16 v[172:173], v251 offset:0
    ds_read_b64_tr_b16 v[174:175], v251 offset:2048
    s_waitcnt vmcnt(32) lgkmcnt(14)
    v_mfma_f32_32x32x16_bf16 v[48:63], v[128:131], v[44:47], v[48:63]
    ds_read_b64_tr_b16 v[112:113], v248 offset:4096
    ds_read_b64_tr_b16 v[114:115], v248 offset:6144
    s_waitcnt lgkmcnt(14)
    v_mfma_f32_32x32x16_bf16 v[64:79], v[132:135], v[44:47], v[64:79]
    ds_read_b64_tr_b16 v[116:117], v249 offset:4096
    ds_read_b64_tr_b16 v[118:119], v249 offset:6144
    s_waitcnt lgkmcnt(14)
    v_mfma_f32_32x32x16_bf16 v[80:95], v[136:139], v[44:47], v[80:95]
    ds_read_b64_tr_b16 v[120:121], v250 offset:4096
    ds_read_b64_tr_b16 v[122:123], v250 offset:6144
    s_waitcnt lgkmcnt(14)
    v_mfma_f32_32x32x16_bf16 v[96:111], v[140:143], v[44:47], v[96:111]
    ds_read_b64_tr_b16 v[124:125], v251 offset:4096
    ds_read_b64_tr_b16 v[126:127], v251 offset:6144
    s_waitcnt vmcnt(23) lgkmcnt(14)
    v_mfma_f32_32x32x16_bf16 v[48:63], v[160:163], v[176:179], v[48:63]
    ds_read_b64_tr_b16 v[128:129], v248 offset:8192
    ds_read_b64_tr_b16 v[130:131], v248 offset:10240
    s_waitcnt lgkmcnt(14)
    v_mfma_f32_32x32x16_bf16 v[64:79], v[164:167], v[176:179], v[64:79]
    ds_read_b64_tr_b16 v[132:133], v249 offset:8192
    ds_read_b64_tr_b16 v[134:135], v249 offset:10240
    s_waitcnt lgkmcnt(14)
    v_mfma_f32_32x32x16_bf16 v[80:95], v[168:171], v[176:179], v[80:95]
    ds_read_b64_tr_b16 v[136:137], v250 offset:8192
    ds_read_b64_tr_b16 v[138:139], v250 offset:10240
    s_waitcnt lgkmcnt(14)
    v_mfma_f32_32x32x16_bf16 v[96:111], v[172:175], v[176:179], v[96:111]
    ds_read_b64_tr_b16 v[140:141], v251 offset:8192
    ds_read_b64_tr_b16 v[142:143], v251 offset:10240
    s_waitcnt vmcnt(22) lgkmcnt(14)
    v_mfma_f32_32x32x16_bf16 v[48:63], v[112:115], v[184:187], v[48:63]
    ds_read_b64_tr_b16 v[160:161], v248 offset:12288
    ds_read_b64_tr_b16 v[162:163], v248 offset:14336
    s_waitcnt lgkmcnt(14)
    v_mfma_f32_32x32x16_bf16 v[64:79], v[116:119], v[184:187], v[64:79]
    ds_read_b64_tr_b16 v[164:165], v249 offset:12288
    ds_read_b64_tr_b16 v[166:167], v249 offset:14336
    s_waitcnt lgkmcnt(14)
    v_mfma_f32_32x32x16_bf16 v[80:95], v[120:123], v[184:187], v[80:95]
    ds_read_b64_tr_b16 v[168:169], v250 offset:12288
    ds_read_b64_tr_b16 v[170:171], v250 offset:14336
    s_waitcnt lgkmcnt(14)
    v_mfma_f32_32x32x16_bf16 v[96:111], v[124:127], v[184:187], v[96:111]
    ds_read_b64_tr_b16 v[172:173], v251 offset:12288
    ds_read_b64_tr_b16 v[174:175], v251 offset:14336
    s_waitcnt vmcnt(21) lgkmcnt(14)
    v_mfma_f32_32x32x16_bf16 v[48:63], v[128:131], v[188:191], v[48:63]
    ds_read_b64_tr_b16 v[112:113], v248 offset:16384
    ds_read_b64_tr_b16 v[114:115], v248 offset:18432
    s_waitcnt lgkmcnt(14)
    v_mfma_f32_32x32x16_bf16 v[64:79], v[132:135], v[188:191], v[64:79]
    ds_read_b64_tr_b16 v[116:117], v249 offset:16384
    ds_read_b64_tr_b16 v[118:119], v249 offset:18432
    s_waitcnt lgkmcnt(14)
    v_mfma_f32_32x32x16_bf16 v[80:95], v[136:139], v[188:191], v[80:95]
    ds_read_b64_tr_b16 v[120:121], v250 offset:16384
    ds_read_b64_tr_b16 v[122:123], v250 offset:18432
    s_waitcnt lgkmcnt(14)
    v_mfma_f32_32x32x16_bf16 v[96:111], v[140:143], v[188:191], v[96:111]
    ds_read_b64_tr_b16 v[124:125], v251 offset:16384
    ds_read_b64_tr_b16 v[126:127], v251 offset:18432
    s_waitcnt vmcnt(20) lgkmcnt(14)
    v_mfma_f32_32x32x16_bf16 v[48:63], v[160:163], v[196:199], v[48:63]
    ds_read_b64_tr_b16 v[128:129], v248 offset:20480
    ds_read_b64_tr_b16 v[130:131], v248 offset:22528
    s_waitcnt lgkmcnt(14)
    v_mfma_f32_32x32x16_bf16 v[64:79], v[164:167], v[196:199], v[64:79]
    ds_read_b64_tr_b16 v[132:133], v249 offset:20480
    ds_read_b64_tr_b16 v[134:135], v249 offset:22528
    s_waitcnt lgkmcnt(14)
    v_mfma_f32_32x32x16_bf16 v[80:95], v[168:171], v[196:199], v[80:95]
    ds_read_b64_tr_b16 v[136:137], v250 offset:20480
    ds_read_b64_tr_b16 v[138:139], v250 offset:22528
    s_waitcnt lgkmcnt(14)
    v_mfma_f32_32x32x16_bf16 v[96:111], v[172:175], v[196:199], v[96:111]
    ds_read_b64_tr_b16 v[140:141], v251 offset:20480
    ds_read_b64_tr_b16 v[142:143], v251 offset:22528
    s_waitcnt vmcnt(19) lgkmcnt(14)
    v_mfma_f32_32x32x16_bf16 v[48:63], v[112:115], v[200:203], v[48:63]
    ds_read_b64_tr_b16 v[160:161], v248 offset:24576
    ds_read_b64_tr_b16 v[162:163], v248 offset:26624
    s_waitcnt lgkmcnt(14)
    v_mfma_f32_32x32x16_bf16 v[64:79], v[116:119], v[200:203], v[64:79]
    ds_read_b64_tr_b16 v[164:165], v249 offset:24576
    ds_read_b64_tr_b16 v[166:167], v249 offset:26624
    s_waitcnt lgkmcnt(14)
    v_mfma_f32_32x32x16_bf16 v[80:95], v[120:123], v[200:203], v[80:95]
    ds_read_b64_tr_b16 v[168:169], v250 offset:24576
    ds_read_b64_tr_b16 v[170:171], v250 offset:26624
    s_waitcnt lgkmcnt(14)
    v_mfma_f32_32x32x16_bf16 v[96:111], v[124:127], v[200:203], v[96:111]
    ds_read_b64_tr_b16 v[172:173], v251 offset:24576
    ds_read_b64_tr_b16 v[174:175], v251 offset:26624
    s_waitcnt vmcnt(18) lgkmcnt(14)
    v_mfma_f32_32x32x16_bf16 v[48:63], v[128:131], v[208:211], v[48:63]
    ds_read_b64_tr_b16 v[112:113], v248 offset:28672
    ds_read_b64_tr_b16 v[114:115], v248 offset:30720
    s_waitcnt lgkmcnt(14)
    v_mfma_f32_32x32x16_bf16 v[64:79], v[132:135], v[208:211], v[64:79]
    ds_read_b64_tr_b16 v[116:117], v249 offset:28672
    ds_read_b64_tr_b16 v[118:119], v249 offset:30720
    s_waitcnt lgkmcnt(14)
    v_mfma_f32_32x32x16_bf16 v[80:95], v[136:139], v[208:211], v[80:95]
    ds_read_b64_tr_b16 v[120:121], v250 offset:28672
    ds_read_b64_tr_b16 v[122:123], v250 offset:30720
    s_waitcnt lgkmcnt(14)
    v_mfma_f32_32x32x16_bf16 v[96:111], v[140:143], v[208:211], v[96:111]
    ds_read_b64_tr_b16 v[124:125], v251 offset:28672
    ds_read_b64_tr_b16 v[126:127], v251 offset:30720
    s_waitcnt vmcnt(17) lgkmcnt(14)
    v_mfma_f32_32x32x16_bf16 v[48:63], v[160:163], v[212:215], v[48:63]
    s_barrier
    ds_read_b64_tr_b16 v[128:129], v243 offset:0
    ds_read_b64_tr_b16 v[130:131], v243 offset:2048
    s_waitcnt lgkmcnt(14)
    v_mfma_f32_32x32x16_bf16 v[64:79], v[164:167], v[212:215], v[64:79]
    ds_read_b64_tr_b16 v[132:133], v244 offset:0
    ds_read_b64_tr_b16 v[134:135], v244 offset:2048
    s_waitcnt lgkmcnt(14)
    v_mfma_f32_32x32x16_bf16 v[80:95], v[168:171], v[212:215], v[80:95]
    ds_read_b64_tr_b16 v[136:137], v245 offset:0
    ds_read_b64_tr_b16 v[138:139], v245 offset:2048
    s_waitcnt lgkmcnt(14)
    v_mfma_f32_32x32x16_bf16 v[96:111], v[172:175], v[212:215], v[96:111]
    ds_read_b64_tr_b16 v[140:141], v246 offset:0
    ds_read_b64_tr_b16 v[142:143], v246 offset:2048
    s_waitcnt vmcnt(16) lgkmcnt(14)
    v_mfma_f32_32x32x16_bf16 v[48:63], v[112:115], v[220:223], v[48:63]
    ds_read_b64_tr_b16 v[160:161], v243 offset:4096
    ds_read_b64_tr_b16 v[162:163], v243 offset:6144
    s_waitcnt lgkmcnt(14)
    v_mfma_f32_32x32x16_bf16 v[64:79], v[116:119], v[220:223], v[64:79]
    ds_read_b64_tr_b16 v[164:165], v244 offset:4096
    ds_read_b64_tr_b16 v[166:167], v244 offset:6144
    s_waitcnt lgkmcnt(14)
    v_mfma_f32_32x32x16_bf16 v[80:95], v[120:123], v[220:223], v[80:95]
    ds_read_b64_tr_b16 v[168:169], v245 offset:4096
    ds_read_b64_tr_b16 v[170:171], v245 offset:6144
    s_waitcnt lgkmcnt(14)
    v_mfma_f32_32x32x16_bf16 v[96:111], v[124:127], v[220:223], v[96:111]
    ds_read_b64_tr_b16 v[172:173], v246 offset:4096
    ds_read_b64_tr_b16 v[174:175], v246 offset:6144
    s_waitcnt vmcnt(15) lgkmcnt(14)
    v_mfma_f32_32x32x16_bf16 v[48:63], v[128:131], v[180:183], v[48:63]
    ds_read_b64_tr_b16 v[112:113], v243 offset:8192
    ds_read_b64_tr_b16 v[114:115], v243 offset:10240
    s_waitcnt lgkmcnt(14)
    v_mfma_f32_32x32x16_bf16 v[64:79], v[132:135], v[180:183], v[64:79]
    ds_read_b64_tr_b16 v[116:117], v244 offset:8192
    ds_read_b64_tr_b16 v[118:119], v244 offset:10240
    s_waitcnt lgkmcnt(14)
    v_mfma_f32_32x32x16_bf16 v[80:95], v[136:139], v[180:183], v[80:95]
    ds_read_b64_tr_b16 v[120:121], v245 offset:8192
    ds_read_b64_tr_b16 v[122:123], v245 offset:10240
    s_waitcnt lgkmcnt(14)
    v_mfma_f32_32x32x16_bf16 v[96:111], v[140:143], v[180:183], v[96:111]
    ds_read_b64_tr_b16 v[124:125], v246 offset:8192
    ds_read_b64_tr_b16 v[126:127], v246 offset:10240
    s_waitcnt vmcnt(14) lgkmcnt(14)
    v_mfma_f32_32x32x16_bf16 v[48:63], v[160:163], v[192:195], v[48:63]
    ds_read_b64_tr_b16 v[128:129], v243 offset:12288
    ds_read_b64_tr_b16 v[130:131], v243 offset:14336
    s_waitcnt lgkmcnt(14)
    v_mfma_f32_32x32x16_bf16 v[64:79], v[164:167], v[192:195], v[64:79]
    ds_read_b64_tr_b16 v[132:133], v244 offset:12288
    ds_read_b64_tr_b16 v[134:135], v244 offset:14336
    s_waitcnt lgkmcnt(14)
    v_mfma_f32_32x32x16_bf16 v[80:95], v[168:171], v[192:195], v[80:95]
    ds_read_b64_tr_b16 v[136:137], v245 offset:12288
    ds_read_b64_tr_b16 v[138:139], v245 offset:14336
    s_waitcnt lgkmcnt(14)
    v_mfma_f32_32x32x16_bf16 v[96:111], v[172:175], v[192:195], v[96:111]
    ds_read_b64_tr_b16 v[140:141], v246 offset:12288
    ds_read_b64_tr_b16 v[142:143], v246 offset:14336
    s_waitcnt vmcnt(13) lgkmcnt(14)
    v_mfma_f32_32x32x16_bf16 v[48:63], v[112:115], v[204:207], v[48:63]
    ds_read_b64_tr_b16 v[160:161], v243 offset:16384
    ds_read_b64_tr_b16 v[162:163], v243 offset:18432
    s_waitcnt lgkmcnt(14)
    v_mfma_f32_32x32x16_bf16 v[64:79], v[116:119], v[204:207], v[64:79]
    ds_read_b64_tr_b16 v[164:165], v244 offset:16384
    ds_read_b64_tr_b16 v[166:167], v244 offset:18432
    s_waitcnt lgkmcnt(14)
    v_mfma_f32_32x32x16_bf16 v[80:95], v[120:123], v[204:207], v[80:95]
    ds_read_b64_tr_b16 v[168:169], v245 offset:16384
    ds_read_b64_tr_b16 v[170:171], v245 offset:18432
    s_waitcnt lgkmcnt(14)
    v_mfma_f32_32x32x16_bf16 v[96:111], v[124:127], v[204:207], v[96:111]
    ds_read_b64_tr_b16 v[172:173], v246 offset:16384
    ds_read_b64_tr_b16 v[174:175], v246 offset:18432
    s_waitcnt vmcnt(12) lgkmcnt(14)
    v_mfma_f32_32x32x16_bf16 v[48:63], v[128:131], v[216:219], v[48:63]
    ds_read_b64_tr_b16 v[112:113], v243 offset:20480
    ds_read_b64_tr_b16 v[114:115], v243 offset:22528
    s_waitcnt lgkmcnt(14)
    v_mfma_f32_32x32x16_bf16 v[64:79], v[132:135], v[216:219], v[64:79]
    ds_read_b64_tr_b16 v[116:117], v244 offset:20480
    ds_read_b64_tr_b16 v[118:119], v244 offset:22528
    s_waitcnt lgkmcnt(14)
    v_mfma_f32_32x32x16_bf16 v[80:95], v[136:139], v[216:219], v[80:95]
    ds_read_b64_tr_b16 v[120:121], v245 offset:20480
    ds_read_b64_tr_b16 v[122:123], v245 offset:22528
    s_waitcnt lgkmcnt(14)
    v_mfma_f32_32x32x16_bf16 v[96:111], v[140:143], v[216:219], v[96:111]
    ds_read_b64_tr_b16 v[124:125], v246 offset:20480
    ds_read_b64_tr_b16 v[126:127], v246 offset:22528
    s_waitcnt vmcnt(11) lgkmcnt(14)
    v_mfma_f32_32x32x16_bf16 v[48:63], v[160:163], v[224:227], v[48:63]
    ds_read_b64_tr_b16 v[128:129], v243 offset:24576
    ds_read_b64_tr_b16 v[130:131], v243 offset:26624
    buffer_load_dwordx4 v[12:15], v9, s[20:23], s55 offen
    s_waitcnt lgkmcnt(14)
    v_mfma_f32_32x32x16_bf16 v[64:79], v[164:167], v[224:227], v[64:79]
    ds_read_b64_tr_b16 v[132:133], v244 offset:24576
    ds_read_b64_tr_b16 v[134:135], v244 offset:26624
    s_waitcnt lgkmcnt(14)
    v_mfma_f32_32x32x16_bf16 v[80:95], v[168:171], v[224:227], v[80:95]
    ds_read_b64_tr_b16 v[136:137], v245 offset:24576
    ds_read_b64_tr_b16 v[138:139], v245 offset:26624
    s_waitcnt lgkmcnt(14)
    v_mfma_f32_32x32x16_bf16 v[96:111], v[172:175], v[224:227], v[96:111]
    ds_read_b64_tr_b16 v[140:141], v246 offset:24576
    ds_read_b64_tr_b16 v[142:143], v246 offset:26624
    s_waitcnt vmcnt(11) lgkmcnt(14)
    v_mfma_f32_32x32x16_bf16 v[48:63], v[112:115], v[228:231], v[48:63]
    ds_read_b64_tr_b16 v[160:161], v243 offset:28672
    ds_read_b64_tr_b16 v[162:163], v243 offset:30720
    s_waitcnt lgkmcnt(14)
    v_mfma_f32_32x32x16_bf16 v[64:79], v[116:119], v[228:231], v[64:79]
    ds_read_b64_tr_b16 v[164:165], v244 offset:28672
    ds_read_b64_tr_b16 v[166:167], v244 offset:30720
    s_waitcnt lgkmcnt(14)
    v_mfma_f32_32x32x16_bf16 v[80:95], v[120:123], v[228:231], v[80:95]
    ds_read_b64_tr_b16 v[168:169], v245 offset:28672
    ds_read_b64_tr_b16 v[170:171], v245 offset:30720
    s_waitcnt lgkmcnt(14)
    v_mfma_f32_32x32x16_bf16 v[96:111], v[124:127], v[228:231], v[96:111]
    ds_read_b64_tr_b16 v[172:173], v246 offset:28672
    ds_read_b64_tr_b16 v[174:175], v246 offset:30720
    s_waitcnt vmcnt(10) lgkmcnt(14)
    v_mfma_f32_32x32x16_bf16 v[48:63], v[128:131], v[232:235], v[48:63]
    s_barrier
    ds_read_b64_tr_b16 v[112:113], v248 offset:32768
    ds_read_b64_tr_b16 v[114:115], v248 offset:34816
    s_waitcnt lgkmcnt(14)
    v_mfma_f32_32x32x16_bf16 v[64:79], v[132:135], v[232:235], v[64:79]
    ds_read_b64_tr_b16 v[116:117], v249 offset:32768
    ds_read_b64_tr_b16 v[118:119], v249 offset:34816
    s_waitcnt lgkmcnt(14)
    v_mfma_f32_32x32x16_bf16 v[80:95], v[136:139], v[232:235], v[80:95]
    ds_read_b64_tr_b16 v[120:121], v250 offset:32768
    ds_read_b64_tr_b16 v[122:123], v250 offset:34816
    s_waitcnt lgkmcnt(14)
    v_mfma_f32_32x32x16_bf16 v[96:111], v[140:143], v[232:235], v[96:111]
    ds_read_b64_tr_b16 v[124:125], v251 offset:32768
    ds_read_b64_tr_b16 v[126:127], v251 offset:34816
    s_waitcnt vmcnt(9) lgkmcnt(14)
    v_mfma_f32_32x32x16_bf16 v[48:63], v[160:163], v[236:239], v[48:63]
    ds_read_b64_tr_b16 v[128:129], v248 offset:40960
    ds_read_b64_tr_b16 v[130:131], v248 offset:43008
    s_waitcnt lgkmcnt(14)
    v_mfma_f32_32x32x16_bf16 v[64:79], v[164:167], v[236:239], v[64:79]
    ds_read_b64_tr_b16 v[132:133], v249 offset:40960
    ds_read_b64_tr_b16 v[134:135], v249 offset:43008
    s_waitcnt lgkmcnt(14)
    v_mfma_f32_32x32x16_bf16 v[80:95], v[168:171], v[236:239], v[80:95]
    ds_read_b64_tr_b16 v[136:137], v250 offset:40960
    ds_read_b64_tr_b16 v[138:139], v250 offset:43008
    s_waitcnt lgkmcnt(14)
    v_mfma_f32_32x32x16_bf16 v[96:111], v[172:175], v[236:239], v[96:111]
    ds_read_b64_tr_b16 v[140:141], v251 offset:40960
    ds_read_b64_tr_b16 v[142:143], v251 offset:43008
    s_waitcnt vmcnt(8) lgkmcnt(14)
    v_mfma_f32_32x32x16_bf16 v[48:63], v[112:115], v[144:147], v[48:63]
    ds_read_b64_tr_b16 v[160:161], v248 offset:49152
    ds_read_b64_tr_b16 v[162:163], v248 offset:51200
    s_waitcnt lgkmcnt(14)
    v_mfma_f32_32x32x16_bf16 v[64:79], v[116:119], v[144:147], v[64:79]
    ds_read_b64_tr_b16 v[164:165], v249 offset:49152
    ds_read_b64_tr_b16 v[166:167], v249 offset:51200
    s_waitcnt lgkmcnt(14)
    v_mfma_f32_32x32x16_bf16 v[80:95], v[120:123], v[144:147], v[80:95]
    ds_read_b64_tr_b16 v[168:169], v250 offset:49152
    ds_read_b64_tr_b16 v[170:171], v250 offset:51200
    s_waitcnt lgkmcnt(14)
    v_mfma_f32_32x32x16_bf16 v[96:111], v[124:127], v[144:147], v[96:111]
    ds_read_b64_tr_b16 v[172:173], v251 offset:49152
    ds_read_b64_tr_b16 v[174:175], v251 offset:51200
    s_waitcnt vmcnt(7) lgkmcnt(14)
    v_mfma_f32_32x32x16_bf16 v[48:63], v[128:131], v[148:151], v[48:63]
    ds_read_b64_tr_b16 v[112:113], v248 offset:57344
    ds_read_b64_tr_b16 v[114:115], v248 offset:59392
    v_add_u32 v243, 0x20000, v243
    v_add_u32 v244, 0x20000, v244
    v_add_u32 v245, 0x20000, v245
    v_add_u32 v246, 0x20000, v246
    s_waitcnt lgkmcnt(14)
    v_mfma_f32_32x32x16_bf16 v[64:79], v[132:135], v[148:151], v[64:79]
    ds_read_b64_tr_b16 v[116:117], v249 offset:57344
    ds_read_b64_tr_b16 v[118:119], v249 offset:59392
    s_waitcnt lgkmcnt(14)
    v_mfma_f32_32x32x16_bf16 v[80:95], v[136:139], v[148:151], v[80:95]
    ds_read_b64_tr_b16 v[120:121], v250 offset:57344
    ds_read_b64_tr_b16 v[122:123], v250 offset:59392
    s_waitcnt lgkmcnt(14)
    v_mfma_f32_32x32x16_bf16 v[96:111], v[140:143], v[148:151], v[96:111]
    ds_read_b64_tr_b16 v[124:125], v251 offset:57344
    ds_read_b64_tr_b16 v[126:127], v251 offset:59392
    s_waitcnt vmcnt(6) lgkmcnt(14)
    v_mfma_f32_32x32x16_bf16 v[48:63], v[160:163], v[152:155], v[48:63]
    ds_read_b64_tr_b16 v[128:129], v243 offset:0
    ds_read_b64_tr_b16 v[130:131], v243 offset:2048
    s_waitcnt lgkmcnt(14)
    v_mfma_f32_32x32x16_bf16 v[64:79], v[164:167], v[152:155], v[64:79]
    ds_read_b64_tr_b16 v[132:133], v244 offset:0
    ds_read_b64_tr_b16 v[134:135], v244 offset:2048
    s_waitcnt lgkmcnt(14)
    v_mfma_f32_32x32x16_bf16 v[80:95], v[168:171], v[152:155], v[80:95]
    ds_read_b64_tr_b16 v[136:137], v245 offset:0
    ds_read_b64_tr_b16 v[138:139], v245 offset:2048
    s_waitcnt lgkmcnt(14)
    v_mfma_f32_32x32x16_bf16 v[96:111], v[172:175], v[152:155], v[96:111]
    ds_read_b64_tr_b16 v[140:141], v246 offset:0
    ds_read_b64_tr_b16 v[142:143], v246 offset:2048
    s_waitcnt vmcnt(5) lgkmcnt(14)
    v_mfma_f32_32x32x16_bf16 v[48:63], v[112:115], v[156:159], v[48:63]
    ds_read_b64_tr_b16 v[160:161], v243 offset:8192
    ds_read_b64_tr_b16 v[162:163], v243 offset:10240
    s_waitcnt lgkmcnt(14)
    v_mfma_f32_32x32x16_bf16 v[64:79], v[116:119], v[156:159], v[64:79]
    ds_read_b64_tr_b16 v[164:165], v244 offset:8192
    ds_read_b64_tr_b16 v[166:167], v244 offset:10240
    s_waitcnt lgkmcnt(14)
    v_mfma_f32_32x32x16_bf16 v[80:95], v[120:123], v[156:159], v[80:95]
    ds_read_b64_tr_b16 v[168:169], v245 offset:8192
    ds_read_b64_tr_b16 v[170:171], v245 offset:10240
    s_waitcnt lgkmcnt(14)
    v_mfma_f32_32x32x16_bf16 v[96:111], v[124:127], v[156:159], v[96:111]
    ds_read_b64_tr_b16 v[172:173], v246 offset:8192
    ds_read_b64_tr_b16 v[174:175], v246 offset:10240
    s_waitcnt vmcnt(4) lgkmcnt(14)
    v_mfma_f32_32x32x16_bf16 v[48:63], v[128:131], v[16:19], v[48:63]
    ds_read_b64_tr_b16 v[112:113], v243 offset:16384
    ds_read_b64_tr_b16 v[114:115], v243 offset:18432
    s_waitcnt lgkmcnt(14)
    v_mfma_f32_32x32x16_bf16 v[64:79], v[132:135], v[16:19], v[64:79]
    ds_read_b64_tr_b16 v[116:117], v244 offset:16384
    ds_read_b64_tr_b16 v[118:119], v244 offset:18432
    s_waitcnt lgkmcnt(14)
    v_mfma_f32_32x32x16_bf16 v[80:95], v[136:139], v[16:19], v[80:95]
    ds_read_b64_tr_b16 v[120:121], v245 offset:16384
    ds_read_b64_tr_b16 v[122:123], v245 offset:18432
    s_waitcnt lgkmcnt(14)
    v_mfma_f32_32x32x16_bf16 v[96:111], v[140:143], v[16:19], v[96:111]
    ds_read_b64_tr_b16 v[124:125], v246 offset:16384
    ds_read_b64_tr_b16 v[126:127], v246 offset:18432
    s_waitcnt vmcnt(3) lgkmcnt(14)
    v_mfma_f32_32x32x16_bf16 v[48:63], v[160:163], v[20:23], v[48:63]
    ds_read_b64_tr_b16 v[128:129], v243 offset:24576
    ds_read_b64_tr_b16 v[130:131], v243 offset:26624
    s_waitcnt lgkmcnt(14)
    v_mfma_f32_32x32x16_bf16 v[64:79], v[164:167], v[20:23], v[64:79]
    ds_read_b64_tr_b16 v[132:133], v244 offset:24576
    ds_read_b64_tr_b16 v[134:135], v244 offset:26624
    s_waitcnt lgkmcnt(14)
    v_mfma_f32_32x32x16_bf16 v[80:95], v[168:171], v[20:23], v[80:95]
    ds_read_b64_tr_b16 v[136:137], v245 offset:24576
    ds_read_b64_tr_b16 v[138:139], v245 offset:26624
    s_waitcnt lgkmcnt(14)
    v_mfma_f32_32x32x16_bf16 v[96:111], v[172:175], v[20:23], v[96:111]
    ds_read_b64_tr_b16 v[140:141], v246 offset:24576
    ds_read_b64_tr_b16 v[142:143], v246 offset:26624
    s_waitcnt vmcnt(2) lgkmcnt(14)
    v_mfma_f32_32x32x16_bf16 v[48:63], v[112:115], v[24:27], v[48:63]
    s_waitcnt lgkmcnt(12)
    v_mfma_f32_32x32x16_bf16 v[64:79], v[116:119], v[24:27], v[64:79]
    s_waitcnt lgkmcnt(10)
    v_mfma_f32_32x32x16_bf16 v[80:95], v[120:123], v[24:27], v[80:95]
    s_waitcnt lgkmcnt(8)
    v_mfma_f32_32x32x16_bf16 v[96:111], v[124:127], v[24:27], v[96:111]
    s_waitcnt vmcnt(1) lgkmcnt(6)
    v_mfma_f32_32x32x16_bf16 v[48:63], v[128:131], v[28:31], v[48:63]
    s_waitcnt lgkmcnt(4)
    v_mfma_f32_32x32x16_bf16 v[64:79], v[132:135], v[28:31], v[64:79]
    s_waitcnt lgkmcnt(2)
    v_mfma_f32_32x32x16_bf16 v[80:95], v[136:139], v[28:31], v[80:95]
    s_waitcnt lgkmcnt(0)
    v_mfma_f32_32x32x16_bf16 v[96:111], v[140:143], v[28:31], v[96:111]
    s_nop 5
    v_cvt_pk_bf16_f32 v112, v48, v49
    v_cvt_pk_bf16_f32 v113, v50, v51
    v_cvt_pk_bf16_f32 v114, v52, v53
    v_cvt_pk_bf16_f32 v115, v54, v55
    buffer_store_dwordx4 v[112:115], v4, s[32:35], s14 offen offset:0 sc1
    v_cvt_pk_bf16_f32 v116, v56, v57
    v_cvt_pk_bf16_f32 v117, v58, v59
    v_cvt_pk_bf16_f32 v118, v60, v61
    v_cvt_pk_bf16_f32 v119, v62, v63
    buffer_store_dwordx4 v[116:119], v4, s[32:35], s14 offen offset:1024 sc1
    v_cvt_pk_bf16_f32 v120, v64, v65
    v_cvt_pk_bf16_f32 v121, v66, v67
    v_cvt_pk_bf16_f32 v122, v68, v69
    v_cvt_pk_bf16_f32 v123, v70, v71
    buffer_store_dwordx4 v[120:123], v4, s[32:35], s14 offen offset:2048 sc1
    v_cvt_pk_bf16_f32 v124, v72, v73
    v_cvt_pk_bf16_f32 v125, v74, v75
    v_cvt_pk_bf16_f32 v126, v76, v77
    v_cvt_pk_bf16_f32 v127, v78, v79
    buffer_store_dwordx4 v[124:127], v4, s[32:35], s14 offen offset:3072 sc1
    v_cvt_pk_bf16_f32 v128, v80, v81
    v_cvt_pk_bf16_f32 v129, v82, v83
    v_cvt_pk_bf16_f32 v130, v84, v85
    v_cvt_pk_bf16_f32 v131, v86, v87
    s_add_u32 s14, s14, 4096
    buffer_store_dwordx4 v[128:131], v4, s[32:35], s14 offen offset:0 sc1
    v_cvt_pk_bf16_f32 v132, v88, v89
    v_cvt_pk_bf16_f32 v133, v90, v91
    v_cvt_pk_bf16_f32 v134, v92, v93
    v_cvt_pk_bf16_f32 v135, v94, v95
    buffer_store_dwordx4 v[132:135], v4, s[32:35], s14 offen offset:1024 sc1
    v_cvt_pk_bf16_f32 v136, v96, v97
    v_cvt_pk_bf16_f32 v137, v98, v99
    v_cvt_pk_bf16_f32 v138, v100, v101
    v_cvt_pk_bf16_f32 v139, v102, v103
    buffer_store_dwordx4 v[136:139], v4, s[32:35], s14 offen offset:2048 sc1
    v_cvt_pk_bf16_f32 v140, v104, v105
    v_cvt_pk_bf16_f32 v141, v106, v107
    v_cvt_pk_bf16_f32 v142, v108, v109
    v_cvt_pk_bf16_f32 v143, v110, v111
    buffer_store_dwordx4 v[140:143], v4, s[32:35], s14 offen offset:3072 sc1
    s_mul_i32 s62, s45, 229376
    s_add_u32 s62, s62, 65011712
    s_lshl_b32 s63, s61, 11
    s_add_u32 s63, s63, s62
    s_add_u32 s62, s62, s50
    s_lshl_b32 s48, s44, 11
    v_add_u32 v10, s48, v4
    s_lshl_b32 s48, s44, 14
    v_add_u32 v11, s48, v4
    s_and_b32 s48, s44, 3
    s_lshl_b32 s48, s48, 10
    s_lshl_b32 s49, s52, 15
    s_add_u32 s64, s48, s49
    s_lshl_b32 s65, s45, 16
    s_add_u32 s65, s65, s64
    s_add_u32 s65, s65, 62914560
    v_lshlrev_b32 v8, 3, v2
    v_add_u32 v6, 131072, v8
    s_add_u32 s14, s56, 20971520
    s_lshr_b32 s48, s45, 1
    s_sub_u32 s49, 15, s48
    s_min_u32 s48, s48, s49
    s_lshl_b32 s48, s48, 2
    s_lshr_b32 s49, s46, 1
    s_lshl_b32 s49, s49, 8
    s_add_u32 s48, s48, s49
    v_and_b32 v242, 7, v1
    v_lshlrev_b32 v241, 10, v242
    v_add_u32 v241, s48, v241
    v_lshlrev_b32 v242, 2, v242
    v_bfe_u32 v5, v2, 1, 1
    v_lshrrev_b32 v7, 3, v2
    v_lshl_add_u32 v5, v7, 1, v5
    v_bfe_u32 v7, v2, 2, 1
    v_xor_b32 v7, v7, v3
    v_lshl_add_u32 v5, v7, 3, v5
    v_and_b32 v7, 1, v2
    v_lshlrev_b32 v7, 4, v7
    v_mov_b32 v0, 0x3f80
    v_lshlrev_b32 v7, v7, v0
    v_cmp_eq_u32 vcc, 0, v5
    s_nop 1
    v_cndmask_b32 v96, 0, v7, vcc
    v_cmp_eq_u32 vcc, 1, v5
    s_nop 1
    v_cndmask_b32 v97, 0, v7, vcc
    v_cmp_eq_u32 vcc, 2, v5
    s_nop 1
    v_cndmask_b32 v98, 0, v7, vcc
    v_cmp_eq_u32 vcc, 3, v5
    s_nop 1
    v_cndmask_b32 v99, 0, v7, vcc
    s_waitcnt vmcnt(8)
    v_permlane32_swap_b32 v12, v14
    v_permlane32_swap_b32 v13, v15
    v_lshlrev_b32 v48, 16, v12
    v_and_b32 v49, 0xffff0000, v12
    v_lshlrev_b32 v50, 16, v13
    v_and_b32 v51, 0xffff0000, v13
    v_lshlrev_b32 v52, 16, v14
    v_and_b32 v53, 0xffff0000, v14
    v_lshlrev_b32 v54, 16, v15
    v_and_b32 v55, 0xffff0000, v15
    v_mov_b32 v252, 0x3f803f80
    v_mov_b32 v253, 0x3f803f80
    v_mov_b32 v254, 0x3f803f80
    v_mov_b32 v255, 0x3f803f80
    s_waitcnt vmcnt(0)
    s_barrier
    s_barrier
    buffer_load_dwordx4 v[180:183], v4, s[32:35], s59 offen offset:0 sc1
    buffer_load_dwordx4 v[192:195], v4, s[32:35], s59 offen offset:1024 sc1
    buffer_load_dwordx4 v[204:207], v4, s[32:35], s59 offen offset:2048 sc1
    buffer_load_dwordx4 v[216:219], v4, s[32:35], s59 offen offset:3072 sc1
    s_add_u32 s59, s59, 4096
    buffer_load_dwordx4 v[224:227], v4, s[32:35], s59 offen offset:0 sc1
    buffer_load_dwordx4 v[228:231], v4, s[32:35], s59 offen offset:1024 sc1
    buffer_load_dwordx4 v[232:235], v4, s[32:35], s59 offen offset:2048 sc1
    buffer_load_dwordx4 v[236:239], v4, s[32:35], s59 offen offset:3072 sc1
    s_add_u32 s59, s59, 4096
    buffer_load_dwordx4 v[144:147], v4, s[32:35], s59 offen offset:0 sc1
    buffer_load_dwordx4 v[148:151], v4, s[32:35], s59 offen offset:1024 sc1
    buffer_load_dwordx4 v[152:155], v4, s[32:35], s59 offen offset:2048 sc1
    buffer_load_dwordx4 v[156:159], v4, s[32:35], s59 offen offset:3072 sc1
    s_add_u32 s59, s59, 4096
    buffer_load_dwordx4 v[160:163], v4, s[32:35], s59 offen offset:0 sc1
    buffer_load_dwordx4 v[164:167], v4, s[32:35], s59 offen offset:1024 sc1
    buffer_load_dwordx4 v[168:171], v4, s[32:35], s59 offen offset:2048 sc1
    buffer_load_dwordx4 v[172:175], v4, s[32:35], s59 offen offset:3072 sc1
    s_add_u32 s59, s59, 4096
    buffer_load_dwordx4 v[16:19], v4, s[32:35], s59 offen offset:0 sc1
    buffer_load_dwordx4 v[20:23], v4, s[32:35], s59 offen offset:1024 sc1
    buffer_load_dwordx4 v[24:27], v4, s[32:35], s59 offen offset:2048 sc1
    buffer_load_dwordx4 v[28:31], v4, s[32:35], s59 offen offset:3072 sc1
    s_add_u32 s59, s59, 4096
    s_branch mg_71
mg_70:
    v_mul_f32 v48, v48, v252
    v_mul_f32 v49, v49, v252
    v_mul_f32 v50, v50, v252
    v_mul_f32 v51, v51, v252
    ds_write_b128 v15, v[48:51] offset:0
    v_mul_f32 v52, v52, v252
    v_mul_f32 v53, v53, v252
    v_mul_f32 v54, v54, v252
    v_mul_f32 v55, v55, v252
    ds_write_b128 v15, v[52:55] offset:1024
    v_mul_f32 v56, v56, v252
    v_mul_f32 v57, v57, v252
    v_mul_f32 v58, v58, v252
    v_mul_f32 v59, v59, v252
    ds_write_b128 v15, v[56:59] offset:2048
    v_mul_f32 v60, v60, v252
    v_mul_f32 v61, v61, v252
    v_mul_f32 v62, v62, v252
    v_mul_f32 v63, v63, v252
    ds_write_b128 v15, v[60:63] offset:3072
    v_mul_f32 v64, v64, v252
    v_mul_f32 v65, v65, v252
    v_mul_f32 v66, v66, v252
    v_mul_f32 v67, v67, v252
    ds_write_b128 v15, v[64:67] offset:4096
    v_mul_f32 v68, v68, v252
    v_mul_f32 v69, v69, v252
    v_mul_f32 v70, v70, v252
    v_mul_f32 v71, v71, v252
    ds_write_b128 v15, v[68:71] offset:5120
    v_mul_f32 v72, v72, v252
    v_mul_f32 v73, v73, v252
    v_mul_f32 v74, v74, v252
    v_mul_f32 v75, v75, v252
    ds_write_b128 v15, v[72:75] offset:6144
    v_mul_f32 v76, v76, v252
    v_mul_f32 v77, v77, v252
    v_mul_f32 v78, v78, v252
    v_mul_f32 v79, v79, v252
    ds_write_b128 v15, v[76:79] offset:7168
    s_waitcnt vmcnt(12)
    s_waitcnt lgkmcnt(0)
    s_barrier
    ds_read_b128 v[112:115], v9 offset:0
    ds_read_b128 v[116:119], v9 offset:1024
    ds_read_b128 v[120:123], v9 offset:2048
    ds_read_b128 v[124:127], v9 offset:3072
    ds_read_b128 v[128:131], v9 offset:4096
    ds_read_b128 v[132:135], v9 offset:5120
    ds_read_b128 v[136:139], v9 offset:6144
    ds_read_b128 v[140:143], v9 offset:7168
    s_waitcnt lgkmcnt(7)
    v_fmac_f32 v112, v80, v252
    v_fmac_f32 v113, v81, v252
    v_fmac_f32 v114, v82, v252
    v_fmac_f32 v115, v83, v252
    s_waitcnt lgkmcnt(6)
    v_fmac_f32 v116, v84, v252
    v_fmac_f32 v117, v85, v252
    v_fmac_f32 v118, v86, v252
    v_fmac_f32 v119, v87, v252
    v_cvt_pk_bf16_f32 v144, v112, v113
    v_cvt_pk_bf16_f32 v145, v114, v115
    v_cvt_pk_bf16_f32 v146, v116, v117
    v_cvt_pk_bf16_f32 v147, v118, v119
    buffer_store_dwordx4 v[144:147], v4, s[32:35], s48 offen offset:0 sc1
    s_waitcnt lgkmcnt(5)
    v_fmac_f32 v120, v88, v252
    v_fmac_f32 v121, v89, v252
    v_fmac_f32 v122, v90, v252
    v_fmac_f32 v123, v91, v252
    s_waitcnt lgkmcnt(4)
    v_fmac_f32 v124, v92, v252
    v_fmac_f32 v125, v93, v252
    v_fmac_f32 v126, v94, v252
    v_fmac_f32 v127, v95, v252
    v_cvt_pk_bf16_f32 v148, v120, v121
    v_cvt_pk_bf16_f32 v149, v122, v123
    v_cvt_pk_bf16_f32 v150, v124, v125
    v_cvt_pk_bf16_f32 v151, v126, v127
    buffer_store_dwordx4 v[148:151], v4, s[32:35], s48 offen offset:1024 sc1
    s_waitcnt lgkmcnt(3)
    v_fmac_f32 v128, v96, v252
    v_fmac_f32 v129, v97, v252
    v_fmac_f32 v130, v98, v252
    v_fmac_f32 v131, v99, v252
    s_waitcnt lgkmcnt(2)
    v_fmac_f32 v132, v100, v252
    v_fmac_f32 v133, v101, v252
    v_fmac_f32 v134, v102, v252
    v_fmac_f32 v135, v103, v252
    v_cvt_pk_bf16_f32 v152, v128, v129
    v_cvt_pk_bf16_f32 v153, v130, v131
    v_cvt_pk_bf16_f32 v154, v132, v133
    v_cvt_pk_bf16_f32 v155, v134, v135
    buffer_store_dwordx4 v[152:155], v4, s[32:35], s48 offen offset:2048 sc1
    s_waitcnt lgkmcnt(1)
    v_fmac_f32 v136, v104, v252
    v_fmac_f32 v137, v105, v252
    v_fmac_f32 v138, v106, v252
    v_fmac_f32 v139, v107, v252
    s_waitcnt lgkmcnt(0)
    v_fmac_f32 v140, v108, v252
    v_fmac_f32 v141, v109, v252
    v_fmac_f32 v142, v110, v252
    v_fmac_f32 v143, v111, v252
    v_cvt_pk_bf16_f32 v156, v136, v137
    v_cvt_pk_bf16_f32 v157, v138, v139
    v_cvt_pk_bf16_f32 v158, v140, v141
    v_cvt_pk_bf16_f32 v159, v142, v143
    buffer_store_dwordx4 v[156:159], v4, s[32:35], s48 offen offset:3072 sc1
    s_lshl_b32 s48, s17, 1
    s_add_u32 m0, s48, 98304
    s_nop 0
    buffer_load_dwordx4 v242, s[28:31], s7 offen lds
    s_add_u32 s7, s7, 4096
    s_lshl_b32 s48, s17, 1
    s_add_u32 m0, s48, 99328
    s_nop 0
    buffer_load_dwordx4 v242, s[28:31], s7 offen lds
    s_add_u32 s7, s7, 4096
    s_lshl_b32 s48, s17, 1
    s_add_u32 m0, s48, 100352
    s_nop 0
    buffer_load_dwordx4 v242, s[28:31], s7 offen lds
    s_add_u32 s7, s7, 4096
    s_lshl_b32 s48, s17, 1
    s_add_u32 m0, s48, 101376
    s_nop 0
    buffer_load_dwordx4 v242, s[28:31], s7 offen lds
    s_add_u32 s7, s7, 118784
    v_xor_b32 v244, 64, v243
    v_xor_b32 v245, 128, v243
    v_xor_b32 v246, 192, v243
    v_add_u32 v248, 0x10000, v243
    v_add_u32 v249, 0x10000, v244
    v_add_u32 v250, 0x10000, v245
    v_add_u32 v251, 0x10000, v246
    v_and_b32 v2, 31, v1
    v_lshrrev_b32 v3, 5, v1
    v_lshlrev_b32 v9, 10, v2
    v_lshlrev_b32 v10, 4, v3
    v_add_u32 v9, v9, v10
    buffer_load_dwordx4 v[12:15], v9, s[20:23], s55 offen
    ds_read_b64_tr_b16 v[112:113], v243 offset:32768
    ds_read_b64_tr_b16 v[114:115], v243 offset:34816
    ds_read_b64_tr_b16 v[116:117], v244 offset:32768
    ds_read_b64_tr_b16 v[118:119], v244 offset:34816
    ds_read_b64_tr_b16 v[120:121], v245 offset:32768
    ds_read_b64_tr_b16 v[122:123], v245 offset:34816
    ds_read_b64_tr_b16 v[124:125], v246 offset:32768
    ds_read_b64_tr_b16 v[126:127], v246 offset:34816
    ds_read_b64_tr_b16 v[128:129], v243 offset:36864
    ds_read_b64_tr_b16 v[130:131], v243 offset:38912
    ds_read_b64_tr_b16 v[132:133], v244 offset:36864
    ds_read_b64_tr_b16 v[134:135], v244 offset:38912
    ds_read_b64_tr_b16 v[136:137], v245 offset:36864
    ds_read_b64_tr_b16 v[138:139], v245 offset:38912
    ds_read_b64_tr_b16 v[140:141], v246 offset:36864
    ds_read_b64_tr_b16 v[142:143], v246 offset:38912
    s_waitcnt vmcnt(1)
    s_barrier
    v_mov_b32 v247, 15
    buffer_store_dword v247, v240, s[32:35], s6 offen sc1
    buffer_load_dwordx4 v[16:19], v4, s[32:35], s13 offen offset:0 sc1
    buffer_load_dwordx4 v[20:23], v4, s[32:35], s13 offen offset:1024 sc1
    buffer_load_dwordx4 v[24:27], v4, s[32:35], s13 offen offset:2048 sc1
    buffer_load_dwordx4 v[28:31], v4, s[32:35], s13 offen offset:3072 sc1
    s_add_u32 s13, s13, 4096
    buffer_load_dwordx4 v[32:35], v4, s[32:35], s13 offen offset:0 sc1
    buffer_load_dwordx4 v[36:39], v4, s[32:35], s13 offen offset:1024 sc1
    buffer_load_dwordx4 v[40:43], v4, s[32:35], s13 offen offset:2048 sc1
    buffer_load_dwordx4 v[44:47], v4, s[32:35], s13 offen offset:3072 sc1
    s_add_u32 s13, s13, 4096
    s_bfe_u32 s48, s13, 0x2000d
    s_cselect_b32 s48, 0, 0x8000
    s_sub_u32 s13, s13, s48
    s_waitcnt vmcnt(7) lgkmcnt(14)
    v_mfma_f32_32x32x16_bf16 v[48:63], v[112:115], v[16:19], 0
    ds_read_b64_tr_b16 v[160:161], v243 offset:40960
    ds_read_b64_tr_b16 v[162:163], v243 offset:43008
    s_waitcnt lgkmcnt(14)
    v_mfma_f32_32x32x16_bf16 v[64:79], v[116:119], v[16:19], 0
    ds_read_b64_tr_b16 v[164:165], v244 offset:40960
    ds_read_b64_tr_b16 v[166:167], v244 offset:43008
    s_waitcnt lgkmcnt(14)
    v_mfma_f32_32x32x16_bf16 v[80:95], v[120:123], v[16:19], 0
    ds_read_b64_tr_b16 v[168:169], v245 offset:40960
    ds_read_b64_tr_b16 v[170:171], v245 offset:43008
    s_waitcnt lgkmcnt(14)
    v_mfma_f32_32x32x16_bf16 v[96:111], v[124:127], v[16:19], 0
    ds_read_b64_tr_b16 v[172:173], v246 offset:40960
    ds_read_b64_tr_b16 v[174:175], v246 offset:43008
    s_waitcnt vmcnt(6) lgkmcnt(14)
    v_mfma_f32_32x32x16_bf16 v[48:63], v[128:131], v[20:23], v[48:63]
    ds_read_b64_tr_b16 v[112:113], v243 offset:45056
    ds_read_b64_tr_b16 v[114:115], v243 offset:47104
    s_waitcnt lgkmcnt(14)
    v_mfma_f32_32x32x16_bf16 v[64:79], v[132:135], v[20:23], v[64:79]
    ds_read_b64_tr_b16 v[116:117], v244 offset:45056
    ds_read_b64_tr_b16 v[118:119], v244 offset:47104
    s_waitcnt lgkmcnt(14)
    v_mfma_f32_32x32x16_bf16 v[80:95], v[136:139], v[20:23], v[80:95]
    ds_read_b64_tr_b16 v[120:121], v245 offset:45056
    ds_read_b64_tr_b16 v[122:123], v245 offset:47104
    s_waitcnt lgkmcnt(14)
    v_mfma_f32_32x32x16_bf16 v[96:111], v[140:143], v[20:23], v[96:111]
    ds_read_b64_tr_b16 v[124:125], v246 offset:45056
    ds_read_b64_tr_b16 v[126:127], v246 offset:47104
    s_waitcnt vmcnt(5) lgkmcnt(14)
    v_mfma_f32_32x32x16_bf16 v[48:63], v[160:163], v[24:27], v[48:63]
    ds_read_b64_tr_b16 v[128:129], v243 offset:49152
    ds_read_b64_tr_b16 v[130:131], v243 offset:51200
    s_waitcnt lgkmcnt(14)
    v_mfma_f32_32x32x16_bf16 v[64:79], v[164:167], v[24:27], v[64:79]
    ds_read_b64_tr_b16 v[132:133], v244 offset:49152
    ds_read_b64_tr_b16 v[134:135], v244 offset:51200
    s_waitcnt lgkmcnt(14)
    v_mfma_f32_32x32x16_bf16 v[80:95], v[168:171], v[24:27], v[80:95]
    ds_read_b64_tr_b16 v[136:137], v245 offset:49152
    ds_read_b64_tr_b16 v[138:139], v245 offset:51200
    s_waitcnt lgkmcnt(14)
    v_mfma_f32_32x32x16_bf16 v[96:111], v[172:175], v[24:27], v[96:111]
    ds_read_b64_tr_b16 v[140:141], v246 offset:49152
    ds_read_b64_tr_b16 v[142:143], v246 offset:51200
    s_waitcnt vmcnt(4) lgkmcnt(14)
    v_mfma_f32_32x32x16_bf16 v[48:63], v[112:115], v[28:31], v[48:63]
    ds_read_b64_tr_b16 v[160:161], v243 offset:53248
    ds_read_b64_tr_b16 v[162:163], v243 offset:55296
    s_waitcnt lgkmcnt(14)
    v_mfma_f32_32x32x16_bf16 v[64:79], v[116:119], v[28:31], v[64:79]
    ds_read_b64_tr_b16 v[164:165], v244 offset:53248
    ds_read_b64_tr_b16 v[166:167], v244 offset:55296
    s_waitcnt lgkmcnt(14)
    v_mfma_f32_32x32x16_bf16 v[80:95], v[120:123], v[28:31], v[80:95]
    ds_read_b64_tr_b16 v[168:169], v245 offset:53248
    ds_read_b64_tr_b16 v[170:171], v245 offset:55296
    s_waitcnt lgkmcnt(14)
    v_mfma_f32_32x32x16_bf16 v[96:111], v[124:127], v[28:31], v[96:111]
    ds_read_b64_tr_b16 v[172:173], v246 offset:53248
    ds_read_b64_tr_b16 v[174:175], v246 offset:55296
    s_waitcnt vmcnt(3) lgkmcnt(14)
    v_mfma_f32_32x32x16_bf16 v[48:63], v[128:131], v[32:35], v[48:63]
    ds_read_b64_tr_b16 v[112:113], v243 offset:57344
    ds_read_b64_tr_b16 v[114:115], v243 offset:59392
    buffer_load_dword v247, v241, s[32:35], s4 offen sc1
    s_waitcnt lgkmcnt(14)
    v_mfma_f32_32x32x16_bf16 v[64:79], v[132:135], v[32:35], v[64:79]
    ds_read_b64_tr_b16 v[116:117], v244 offset:57344
    ds_read_b64_tr_b16 v[118:119], v244 offset:59392
    s_waitcnt lgkmcnt(14)
    v_mfma_f32_32x32x16_bf16 v[80:95], v[136:139], v[32:35], v[80:95]
    ds_read_b64_tr_b16 v[120:121], v245 offset:57344
    ds_read_b64_tr_b16 v[122:123], v245 offset:59392
    s_waitcnt lgkmcnt(14)
    v_mfma_f32_32x32x16_bf16 v[96:111], v[140:143], v[32:35], v[96:111]
    ds_read_b64_tr_b16 v[124:125], v246 offset:57344
    ds_read_b64_tr_b16 v[126:127], v246 offset:59392
    s_waitcnt vmcnt(3) lgkmcnt(14)
    v_mfma_f32_32x32x16_bf16 v[48:63], v[160:163], v[36:39], v[48:63]
    ds_read_b64_tr_b16 v[128:129], v243 offset:61440
    ds_read_b64_tr_b16 v[130:131], v243 offset:63488
    s_waitcnt lgkmcnt(14)
    v_mfma_f32_32x32x16_bf16 v[64:79], v[164:167], v[36:39], v[64:79]
    ds_read_b64_tr_b16 v[132:133], v244 offset:61440
    ds_read_b64_tr_b16 v[134:135], v244 offset:63488
    s_waitcnt lgkmcnt(14)
    v_mfma_f32_32x32x16_bf16 v[80:95], v[168:171], v[36:39], v[80:95]
    ds_read_b64_tr_b16 v[136:137], v245 offset:61440
    ds_read_b64_tr_b16 v[138:139], v245 offset:63488
    s_waitcnt lgkmcnt(14)
    v_mfma_f32_32x32x16_bf16 v[96:111], v[172:175], v[36:39], v[96:111]
    ds_read_b64_tr_b16 v[140:141], v246 offset:61440
    ds_read_b64_tr_b16 v[142:143], v246 offset:63488
    s_waitcnt vmcnt(2) lgkmcnt(14)
    v_mfma_f32_32x32x16_bf16 v[48:63], v[112:115], v[40:43], v[48:63]
    ds_read_b64_tr_b16 v[160:161], v248 offset:0
    ds_read_b64_tr_b16 v[162:163], v248 offset:2048
    s_waitcnt lgkmcnt(14)
    v_mfma_f32_32x32x16_bf16 v[64:79], v[116:119], v[40:43], v[64:79]
    ds_read_b64_tr_b16 v[164:165], v249 offset:0
    ds_read_b64_tr_b16 v[166:167], v249 offset:2048
    s_waitcnt lgkmcnt(14)
    v_mfma_f32_32x32x16_bf16 v[80:95], v[120:123], v[40:43], v[80:95]
    ds_read_b64_tr_b16 v[168:169], v250 offset:0
    ds_read_b64_tr_b16 v[170:171], v250 offset:2048
    s_waitcnt lgkmcnt(14)
    v_mfma_f32_32x32x16_bf16 v[96:111], v[124:127], v[40:43], v[96:111]
    ds_read_b64_tr_b16 v[172:173], v251 offset:0
    ds_read_b64_tr_b16 v[174:175], v251 offset:2048
    s_waitcnt vmcnt(1) lgkmcnt(14)
    v_mfma_f32_32x32x16_bf16 v[48:63], v[128:131], v[44:47], v[48:63]
    ds_read_b64_tr_b16 v[112:113], v248 offset:4096
    ds_read_b64_tr_b16 v[114:115], v248 offset:6144
    s_waitcnt lgkmcnt(14)
    v_mfma_f32_32x32x16_bf16 v[64:79], v[132:135], v[44:47], v[64:79]
    ds_read_b64_tr_b16 v[116:117], v249 offset:4096
    ds_read_b64_tr_b16 v[118:119], v249 offset:6144
    s_waitcnt lgkmcnt(14)
    v_mfma_f32_32x32x16_bf16 v[80:95], v[136:139], v[44:47], v[80:95]
    ds_read_b64_tr_b16 v[120:121], v250 offset:4096
    ds_read_b64_tr_b16 v[122:123], v250 offset:6144
    s_waitcnt lgkmcnt(14)
    v_mfma_f32_32x32x16_bf16 v[96:111], v[140:143], v[44:47], v[96:111]
    ds_read_b64_tr_b16 v[124:125], v251 offset:4096
    ds_read_b64_tr_b16 v[126:127], v251 offset:6144
    s_cmp_lg_u32 s44, 4
    s_cbranch_scc1 np_72
    s_waitcnt vmcnt(0)
    v_and_b32 v247, 8, v247
    v_cmp_ne_u32 vcc, 8, v247
    s_cbranch_vccz np_72
    s_mov_b32 s48, 0x40000
pl_73:
    buffer_load_dword v247, v241, s[32:35], s4 offen sc1
    s_waitcnt vmcnt(0)
    v_and_b32 v247, 8, v247
    v_cmp_ne_u32 vcc, 8, v247
    s_sub_u32 s48, s48, 1
    s_cmp_eq_u32 s48, 0
    s_cbranch_scc1 pd_74
    s_cbranch_vccnz pl_73
pd_74:
np_72:
    s_barrier
    buffer_load_dwordx4 v[176:179], v4, s[32:35], s13 offen offset:0 sc1
    buffer_load_dwordx4 v[184:187], v4, s[32:35], s13 offen offset:1024 sc1
    buffer_load_dwordx4 v[188:191], v4, s[32:35], s13 offen offset:2048 sc1
    buffer_load_dwordx4 v[196:199], v4, s[32:35], s13 offen offset:3072 sc1
    s_add_u32 s13, s13, 4096
    buffer_load_dwordx4 v[200:203], v4, s[32:35], s13 offen offset:0 sc1
    buffer_load_dwordx4 v[208:211], v4, s[32:35], s13 offen offset:1024 sc1
    buffer_load_dwordx4 v[212:215], v4, s[32:35], s13 offen offset:2048 sc1
    buffer_load_dwordx4 v[220:223], v4, s[32:35], s13 offen offset:3072 sc1
    s_add_u32 s13, s13, 4096
    s_bfe_u32 s48, s13, 0x2000d
    s_cselect_b32 s48, 0, 0x8000
    s_sub_u32 s13, s13, s48
    buffer_load_dwordx4 v[16:19], v4, s[32:35], s13 offen offset:0 sc1
    buffer_load_dwordx4 v[20:23], v4, s[32:35], s13 offen offset:1024 sc1
    buffer_load_dwordx4 v[24:27], v4, s[32:35], s13 offen offset:2048 sc1
    buffer_load_dwordx4 v[28:31], v4, s[32:35], s13 offen offset:3072 sc1
    s_add_u32 s13, s13, 4096
    buffer_load_dwordx4 v[32:35], v4, s[32:35], s13 offen offset:0 sc1
    buffer_load_dwordx4 v[36:39], v4, s[32:35], s13 offen offset:1024 sc1
    buffer_load_dwordx4 v[40:43], v4, s[32:35], s13 offen offset:2048 sc1
    buffer_load_dwordx4 v[44:47], v4, s[32:35], s13 offen offset:3072 sc1
    s_add_u32 s13, s13, 4096
    s_bfe_u32 s48, s13, 0x2000d
    s_cselect_b32 s48, 0, 0x8000
    s_sub_u32 s13, s13, s48
    s_waitcnt vmcnt(15) lgkmcnt(14)
    v_mfma_f32_32x32x16_bf16 v[48:63], v[160:163], v[176:179], v[48:63]
    ds_read_b64_tr_b16 v[128:129], v248 offset:8192
    ds_read_b64_tr_b16 v[130:131], v248 offset:10240
    s_waitcnt lgkmcnt(14)
    v_mfma_f32_32x32x16_bf16 v[64:79], v[164:167], v[176:179], v[64:79]
    ds_read_b64_tr_b16 v[132:133], v249 offset:8192
    ds_read_b64_tr_b16 v[134:135], v249 offset:10240
    s_waitcnt lgkmcnt(14)
    v_mfma_f32_32x32x16_bf16 v[80:95], v[168:171], v[176:179], v[80:95]
    ds_read_b64_tr_b16 v[136:137], v250 offset:8192
    ds_read_b64_tr_b16 v[138:139], v250 offset:10240
    s_waitcnt lgkmcnt(14)
    v_mfma_f32_32x32x16_bf16 v[96:111], v[172:175], v[176:179], v[96:111]
    ds_read_b64_tr_b16 v[140:141], v251 offset:8192
    ds_read_b64_tr_b16 v[142:143], v251 offset:10240
    s_waitcnt vmcnt(14) lgkmcnt(14)
    v_mfma_f32_32x32x16_bf16 v[48:63], v[112:115], v[184:187], v[48:63]
    ds_read_b64_tr_b16 v[160:161], v248 offset:12288
    ds_read_b64_tr_b16 v[162:163], v248 offset:14336
    buffer_load_dwordx4 v[176:179], v4, s[32:35], s13 offen offset:0 sc1
    s_waitcnt lgkmcnt(14)
    v_mfma_f32_32x32x16_bf16 v[64:79], v[116:119], v[184:187], v[64:79]
    ds_read_b64_tr_b16 v[164:165], v249 offset:12288
    ds_read_b64_tr_b16 v[166:167], v249 offset:14336
    s_waitcnt lgkmcnt(14)
    v_mfma_f32_32x32x16_bf16 v[80:95], v[120:123], v[184:187], v[80:95]
    ds_read_b64_tr_b16 v[168:169], v250 offset:12288
    ds_read_b64_tr_b16 v[170:171], v250 offset:14336
    s_waitcnt lgkmcnt(14)
    v_mfma_f32_32x32x16_bf16 v[96:111], v[124:127], v[184:187], v[96:111]
    ds_read_b64_tr_b16 v[172:173], v251 offset:12288
    ds_read_b64_tr_b16 v[174:175], v251 offset:14336
    s_waitcnt vmcnt(14) lgkmcnt(14)
    v_mfma_f32_32x32x16_bf16 v[48:63], v[128:131], v[188:191], v[48:63]
    ds_read_b64_tr_b16 v[112:113], v248 offset:16384
    ds_read_b64_tr_b16 v[114:115], v248 offset:18432
    buffer_load_dwordx4 v[184:187], v4, s[32:35], s13 offen offset:1024 sc1
    s_waitcnt lgkmcnt(14)
    v_mfma_f32_32x32x16_bf16 v[64:79], v[132:135], v[188:191], v[64:79]
    ds_read_b64_tr_b16 v[116:117], v249 offset:16384
    ds_read_b64_tr_b16 v[118:119], v249 offset:18432
    s_waitcnt lgkmcnt(14)
    v_mfma_f32_32x32x16_bf16 v[80:95], v[136:139], v[188:191], v[80:95]
    ds_read_b64_tr_b16 v[120:121], v250 offset:16384
    ds_read_b64_tr_b16 v[122:123], v250 offset:18432
    s_waitcnt lgkmcnt(14)
    v_mfma_f32_32x32x16_bf16 v[96:111], v[140:143], v[188:191], v[96:111]
    ds_read_b64_tr_b16 v[124:125], v251 offset:16384
    ds_read_b64_tr_b16 v[126:127], v251 offset:18432
    s_waitcnt vmcnt(14) lgkmcnt(14)
    v_mfma_f32_32x32x16_bf16 v[48:63], v[160:163], v[196:199], v[48:63]
    ds_read_b64_tr_b16 v[128:129], v248 offset:20480
    ds_read_b64_tr_b16 v[130:131], v248 offset:22528
    buffer_load_dwordx4 v[188:191], v4, s[32:35], s13 offen offset:2048 sc1
    s_waitcnt lgkmcnt(14)
    v_mfma_f32_32x32x16_bf16 v[64:79], v[164:167], v[196:199], v[64:79]
    ds_read_b64_tr_b16 v[132:133], v249 offset:20480
    ds_read_b64_tr_b16 v[134:135], v249 offset:22528
    s_waitcnt lgkmcnt(14)
    v_mfma_f32_32x32x16_bf16 v[80:95], v[168:171], v[196:199], v[80:95]
    ds_read_b64_tr_b16 v[136:137], v250 offset:20480
    ds_read_b64_tr_b16 v[138:139], v250 offset:22528
    s_waitcnt lgkmcnt(14)
    v_mfma_f32_32x32x16_bf16 v[96:111], v[172:175], v[196:199], v[96:111]
    ds_read_b64_tr_b16 v[140:141], v251 offset:20480
    ds_read_b64_tr_b16 v[142:143], v251 offset:22528
    s_waitcnt vmcnt(14) lgkmcnt(14)
    v_mfma_f32_32x32x16_bf16 v[48:63], v[112:115], v[200:203], v[48:63]
    ds_read_b64_tr_b16 v[160:161], v248 offset:24576
    ds_read_b64_tr_b16 v[162:163], v248 offset:26624
    buffer_load_dwordx4 v[196:199], v4, s[32:35], s13 offen offset:3072 sc1
    s_add_u32 s13, s13, 4096
    s_waitcnt lgkmcnt(14)
    v_mfma_f32_32x32x16_bf16 v[64:79], v[116:119], v[200:203], v[64:79]
    ds_read_b64_tr_b16 v[164:165], v249 offset:24576
    ds_read_b64_tr_b16 v[166:167], v249 offset:26624
    s_waitcnt lgkmcnt(14)
    v_mfma_f32_32x32x16_bf16 v[80:95], v[120:123], v[200:203], v[80:95]
    ds_read_b64_tr_b16 v[168:169], v250 offset:24576
    ds_read_b64_tr_b16 v[170:171], v250 offset:26624
    s_waitcnt lgkmcnt(14)
    v_mfma_f32_32x32x16_bf16 v[96:111], v[124:127], v[200:203], v[96:111]
    ds_read_b64_tr_b16 v[172:173], v251 offset:24576
    ds_read_b64_tr_b16 v[174:175], v251 offset:26624
    s_waitcnt vmcnt(14) lgkmcnt(14)
    v_mfma_f32_32x32x16_bf16 v[48:63], v[128:131], v[208:211], v[48:63]
    ds_read_b64_tr_b16 v[112:113], v248 offset:28672
    ds_read_b64_tr_b16 v[114:115], v248 offset:30720
    buffer_load_dwordx4 v[200:203], v4, s[32:35], s13 offen offset:0 sc1
    s_waitcnt lgkmcnt(14)
    v_mfma_f32_32x32x16_bf16 v[64:79], v[132:135], v[208:211], v[64:79]
    ds_read_b64_tr_b16 v[116:117], v249 offset:28672
    ds_read_b64_tr_b16 v[118:119], v249 offset:30720
    s_waitcnt lgkmcnt(14)
    v_mfma_f32_32x32x16_bf16 v[80:95], v[136:139], v[208:211], v[80:95]
    ds_read_b64_tr_b16 v[120:121], v250 offset:28672
    ds_read_b64_tr_b16 v[122:123], v250 offset:30720
    s_waitcnt lgkmcnt(14)
    v_mfma_f32_32x32x16_bf16 v[96:111], v[140:143], v[208:211], v[96:111]
    ds_read_b64_tr_b16 v[124:125], v251 offset:28672
    ds_read_b64_tr_b16 v[126:127], v251 offset:30720
    s_waitcnt vmcnt(14) lgkmcnt(14)
    v_mfma_f32_32x32x16_bf16 v[48:63], v[160:163], v[212:215], v[48:63]
    ds_read_b64_tr_b16 v[128:129], v243 offset:0
    ds_read_b64_tr_b16 v[130:131], v243 offset:2048
    buffer_load_dwordx4 v[208:211], v4, s[32:35], s13 offen offset:1024 sc1
    s_waitcnt lgkmcnt(14)
    v_mfma_f32_32x32x16_bf16 v[64:79], v[164:167], v[212:215], v[64:79]
    ds_read_b64_tr_b16 v[132:133], v244 offset:0
    ds_read_b64_tr_b16 v[134:135], v244 offset:2048
    s_waitcnt lgkmcnt(14)
    v_mfma_f32_32x32x16_bf16 v[80:95], v[168:171], v[212:215], v[80:95]
    ds_read_b64_tr_b16 v[136:137], v245 offset:0
    ds_read_b64_tr_b16 v[138:139], v245 offset:2048
    s_waitcnt lgkmcnt(14)
    v_mfma_f32_32x32x16_bf16 v[96:111], v[172:175], v[212:215], v[96:111]
    ds_read_b64_tr_b16 v[140:141], v246 offset:0
    ds_read_b64_tr_b16 v[142:143], v246 offset:2048
    s_waitcnt vmcnt(14) lgkmcnt(14)
    v_mfma_f32_32x32x16_bf16 v[48:63], v[112:115], v[220:223], v[48:63]
    ds_read_b64_tr_b16 v[160:161], v243 offset:4096
    ds_read_b64_tr_b16 v[162:163], v243 offset:6144
    buffer_load_dwordx4 v[212:215], v4, s[32:35], s13 offen offset:2048 sc1
    s_waitcnt lgkmcnt(14)
    v_mfma_f32_32x32x16_bf16 v[64:79], v[116:119], v[220:223], v[64:79]
    ds_read_b64_tr_b16 v[164:165], v244 offset:4096
    ds_read_b64_tr_b16 v[166:167], v244 offset:6144
    s_waitcnt lgkmcnt(14)
    v_mfma_f32_32x32x16_bf16 v[80:95], v[120:123], v[220:223], v[80:95]
    ds_read_b64_tr_b16 v[168:169], v245 offset:4096
    ds_read_b64_tr_b16 v[170:171], v245 offset:6144
    s_waitcnt lgkmcnt(14)
    v_mfma_f32_32x32x16_bf16 v[96:111], v[124:127], v[220:223], v[96:111]
    ds_read_b64_tr_b16 v[172:173], v246 offset:4096
    ds_read_b64_tr_b16 v[174:175], v246 offset:6144
    s_waitcnt vmcnt(14) lgkmcnt(14)
    v_mfma_f32_32x32x16_bf16 v[48:63], v[128:131], v[16:19], v[48:63]
    ds_read_b64_tr_b16 v[112:113], v243 offset:8192
    ds_read_b64_tr_b16 v[114:115], v243 offset:10240
    buffer_load_dwordx4 v[220:223], v4, s[32:35], s13 offen offset:3072 sc1
    s_add_u32 s13, s13, 4096
    s_waitcnt lgkmcnt(14)
    v_mfma_f32_32x32x16_bf16 v[64:79], v[132:135], v[16:19], v[64:79]
    ds_read_b64_tr_b16 v[116:117], v244 offset:8192
    ds_read_b64_tr_b16 v[118:119], v244 offset:10240
    s_waitcnt lgkmcnt(14)
    v_mfma_f32_32x32x16_bf16 v[80:95], v[136:139], v[16:19], v[80:95]
    ds_read_b64_tr_b16 v[120:121], v245 offset:8192
    ds_read_b64_tr_b16 v[122:123], v245 offset:10240
    s_waitcnt lgkmcnt(14)
    v_mfma_f32_32x32x16_bf16 v[96:111], v[140:143], v[16:19], v[96:111]
    ds_read_b64_tr_b16 v[124:125], v246 offset:8192
    ds_read_b64_tr_b16 v[126:127], v246 offset:10240
    s_waitcnt vmcnt(14) lgkmcnt(14)
    v_mfma_f32_32x32x16_bf16 v[48:63], v[160:163], v[20:23], v[48:63]
    ds_read_b64_tr_b16 v[128:129], v243 offset:12288
    ds_read_b64_tr_b16 v[130:131], v243 offset:14336
    s_waitcnt lgkmcnt(14)
    v_mfma_f32_32x32x16_bf16 v[64:79], v[164:167], v[20:23], v[64:79]
    ds_read_b64_tr_b16 v[132:133], v244 offset:12288
    ds_read_b64_tr_b16 v[134:135], v244 offset:14336
    s_waitcnt lgkmcnt(14)
    v_mfma_f32_32x32x16_bf16 v[80:95], v[168:171], v[20:23], v[80:95]
    ds_read_b64_tr_b16 v[136:137], v245 offset:12288
    ds_read_b64_tr_b16 v[138:139], v245 offset:14336
    s_waitcnt lgkmcnt(14)
    v_mfma_f32_32x32x16_bf16 v[96:111], v[172:175], v[20:23], v[96:111]
    ds_read_b64_tr_b16 v[140:141], v246 offset:12288
    ds_read_b64_tr_b16 v[142:143], v246 offset:14336
    s_waitcnt vmcnt(13) lgkmcnt(14)
    v_mfma_f32_32x32x16_bf16 v[48:63], v[112:115], v[24:27], v[48:63]
    ds_read_b64_tr_b16 v[160:161], v243 offset:16384
    ds_read_b64_tr_b16 v[162:163], v243 offset:18432
    s_waitcnt lgkmcnt(14)
    v_mfma_f32_32x32x16_bf16 v[64:79], v[116:119], v[24:27], v[64:79]
    ds_read_b64_tr_b16 v[164:165], v244 offset:16384
    ds_read_b64_tr_b16 v[166:167], v244 offset:18432
    s_waitcnt lgkmcnt(14)
    v_mfma_f32_32x32x16_bf16 v[80:95], v[120:123], v[24:27], v[80:95]
    ds_read_b64_tr_b16 v[168:169], v245 offset:16384
    ds_read_b64_tr_b16 v[170:171], v245 offset:18432
    s_waitcnt lgkmcnt(14)
    v_mfma_f32_32x32x16_bf16 v[96:111], v[124:127], v[24:27], v[96:111]
    ds_read_b64_tr_b16 v[172:173], v246 offset:16384
    ds_read_b64_tr_b16 v[174:175], v246 offset:18432
    s_waitcnt vmcnt(12) lgkmcnt(14)
    v_mfma_f32_32x32x16_bf16 v[48:63], v[128:131], v[28:31], v[48:63]
    ds_read_b64_tr_b16 v[112:113], v243 offset:20480
    ds_read_b64_tr_b16 v[114:115], v243 offset:22528
    s_waitcnt lgkmcnt(14)
    v_mfma_f32_32x32x16_bf16 v[64:79], v[132:135], v[28:31], v[64:79]
    ds_read_b64_tr_b16 v[116:117], v244 offset:20480
    ds_read_b64_tr_b16 v[118:119], v244 offset:22528
    s_waitcnt lgkmcnt(14)
    v_mfma_f32_32x32x16_bf16 v[80:95], v[136:139], v[28:31], v[80:95]
    ds_read_b64_tr_b16 v[120:121], v245 offset:20480
    ds_read_b64_tr_b16 v[122:123], v245 offset:22528
    s_waitcnt lgkmcnt(14)
    v_mfma_f32_32x32x16_bf16 v[96:111], v[140:143], v[28:31], v[96:111]
    ds_read_b64_tr_b16 v[124:125], v246 offset:20480
    ds_read_b64_tr_b16 v[126:127], v246 offset:22528
    s_waitcnt vmcnt(11) lgkmcnt(14)
    v_mfma_f32_32x32x16_bf16 v[48:63], v[160:163], v[32:35], v[48:63]
    ds_read_b64_tr_b16 v[128:129], v243 offset:24576
    ds_read_b64_tr_b16 v[130:131], v243 offset:26624
    s_waitcnt lgkmcnt(14)
    v_mfma_f32_32x32x16_bf16 v[64:79], v[164:167], v[32:35], v[64:79]
    ds_read_b64_tr_b16 v[132:133], v244 offset:24576
    ds_read_b64_tr_b16 v[134:135], v244 offset:26624
    s_waitcnt lgkmcnt(14)
    v_mfma_f32_32x32x16_bf16 v[80:95], v[168:171], v[32:35], v[80:95]
    ds_read_b64_tr_b16 v[136:137], v245 offset:24576
    ds_read_b64_tr_b16 v[138:139], v245 offset:26624
    s_waitcnt lgkmcnt(14)
    v_mfma_f32_32x32x16_bf16 v[96:111], v[172:175], v[32:35], v[96:111]
    ds_read_b64_tr_b16 v[140:141], v246 offset:24576
    ds_read_b64_tr_b16 v[142:143], v246 offset:26624
    s_waitcnt vmcnt(10) lgkmcnt(14)
    v_mfma_f32_32x32x16_bf16 v[48:63], v[112:115], v[36:39], v[48:63]
    ds_read_b64_tr_b16 v[160:161], v243 offset:28672
    ds_read_b64_tr_b16 v[162:163], v243 offset:30720
    s_waitcnt lgkmcnt(14)
    v_mfma_f32_32x32x16_bf16 v[64:79], v[116:119], v[36:39], v[64:79]
    ds_read_b64_tr_b16 v[164:165], v244 offset:28672
    ds_read_b64_tr_b16 v[166:167], v244 offset:30720
    s_waitcnt lgkmcnt(14)
    v_mfma_f32_32x32x16_bf16 v[80:95], v[120:123], v[36:39], v[80:95]
    ds_read_b64_tr_b16 v[168:169], v245 offset:28672
    ds_read_b64_tr_b16 v[170:171], v245 offset:30720
    s_waitcnt lgkmcnt(14)
    v_mfma_f32_32x32x16_bf16 v[96:111], v[124:127], v[36:39], v[96:111]
    ds_read_b64_tr_b16 v[172:173], v246 offset:28672
    ds_read_b64_tr_b16 v[174:175], v246 offset:30720
    s_waitcnt vmcnt(9) lgkmcnt(14)
    v_mfma_f32_32x32x16_bf16 v[48:63], v[128:131], v[40:43], v[48:63]
    ds_read_b64_tr_b16 v[112:113], v248 offset:32768
    ds_read_b64_tr_b16 v[114:115], v248 offset:34816
    s_waitcnt lgkmcnt(14)
    v_mfma_f32_32x32x16_bf16 v[64:79], v[132:135], v[40:43], v[64:79]
    ds_read_b64_tr_b16 v[116:117], v249 offset:32768
    ds_read_b64_tr_b16 v[118:119], v249 offset:34816
    s_waitcnt lgkmcnt(14)
    v_mfma_f32_32x32x16_bf16 v[80:95], v[136:139], v[40:43], v[80:95]
    ds_read_b64_tr_b16 v[120:121], v250 offset:32768
    ds_read_b64_tr_b16 v[122:123], v250 offset:34816
    s_waitcnt lgkmcnt(14)
    v_mfma_f32_32x32x16_bf16 v[96:111], v[140:143], v[40:43], v[96:111]
    ds_read_b64_tr_b16 v[124:125], v251 offset:32768
    ds_read_b64_tr_b16 v[126:127], v251 offset:34816
    s_waitcnt vmcnt(8) lgkmcnt(14)
    v_mfma_f32_32x32x16_bf16 v[48:63], v[160:163], v[44:47], v[48:63]
    ds_read_b64_tr_b16 v[128:129], v248 offset:40960
    ds_read_b64_tr_b16 v[130:131], v248 offset:43008
    s_waitcnt lgkmcnt(14)
    v_mfma_f32_32x32x16_bf16 v[64:79], v[164:167], v[44:47], v[64:79]
    ds_read_b64_tr_b16 v[132:133], v249 offset:40960
    ds_read_b64_tr_b16 v[134:135], v249 offset:43008
    s_waitcnt lgkmcnt(14)
    v_mfma_f32_32x32x16_bf16 v[80:95], v[168:171], v[44:47], v[80:95]
    ds_read_b64_tr_b16 v[136:137], v250 offset:40960
    ds_read_b64_tr_b16 v[138:139], v250 offset:43008
    s_waitcnt lgkmcnt(14)
    v_mfma_f32_32x32x16_bf16 v[96:111], v[172:175], v[44:47], v[96:111]
    ds_read_b64_tr_b16 v[140:141], v251 offset:40960
    ds_read_b64_tr_b16 v[142:143], v251 offset:43008
    s_waitcnt vmcnt(7) lgkmcnt(14)
    v_mfma_f32_32x32x16_bf16 v[48:63], v[112:115], v[176:179], v[48:63]
    ds_read_b64_tr_b16 v[160:161], v248 offset:49152
    ds_read_b64_tr_b16 v[162:163], v248 offset:51200
    s_waitcnt lgkmcnt(14)
    v_mfma_f32_32x32x16_bf16 v[64:79], v[116:119], v[176:179], v[64:79]
    ds_read_b64_tr_b16 v[164:165], v249 offset:49152
    ds_read_b64_tr_b16 v[166:167], v249 offset:51200
    s_waitcnt lgkmcnt(14)
    v_mfma_f32_32x32x16_bf16 v[80:95], v[120:123], v[176:179], v[80:95]
    ds_read_b64_tr_b16 v[168:169], v250 offset:49152
    ds_read_b64_tr_b16 v[170:171], v250 offset:51200
    s_waitcnt lgkmcnt(14)
    v_mfma_f32_32x32x16_bf16 v[96:111], v[124:127], v[176:179], v[96:111]
    ds_read_b64_tr_b16 v[172:173], v251 offset:49152
    ds_read_b64_tr_b16 v[174:175], v251 offset:51200
    s_waitcnt vmcnt(6) lgkmcnt(14)
    v_mfma_f32_32x32x16_bf16 v[48:63], v[128:131], v[184:187], v[48:63]
    ds_read_b64_tr_b16 v[112:113], v248 offset:57344
    ds_read_b64_tr_b16 v[114:115], v248 offset:59392
    v_add_u32 v243, 0x20000, v243
    v_add_u32 v244, 0x20000, v244
    v_add_u32 v245, 0x20000, v245
    v_add_u32 v246, 0x20000, v246
    s_waitcnt lgkmcnt(14)
    v_mfma_f32_32x32x16_bf16 v[64:79], v[132:135], v[184:187], v[64:79]
    ds_read_b64_tr_b16 v[116:117], v249 offset:57344
    ds_read_b64_tr_b16 v[118:119], v249 offset:59392
    s_waitcnt lgkmcnt(14)
    v_mfma_f32_32x32x16_bf16 v[80:95], v[136:139], v[184:187], v[80:95]
    ds_read_b64_tr_b16 v[120:121], v250 offset:57344
    ds_read_b64_tr_b16 v[122:123], v250 offset:59392
    s_waitcnt lgkmcnt(14)
    v_mfma_f32_32x32x16_bf16 v[96:111], v[140:143], v[184:187], v[96:111]
    ds_read_b64_tr_b16 v[124:125], v251 offset:57344
    ds_read_b64_tr_b16 v[126:127], v251 offset:59392
    s_waitcnt vmcnt(5) lgkmcnt(14)
    v_mfma_f32_32x32x16_bf16 v[48:63], v[160:163], v[188:191], v[48:63]
    ds_read_b64_tr_b16 v[128:129], v243 offset:0
    ds_read_b64_tr_b16 v[130:131], v243 offset:2048
    s_waitcnt lgkmcnt(14)
    v_mfma_f32_32x32x16_bf16 v[64:79], v[164:167], v[188:191], v[64:79]
    ds_read_b64_tr_b16 v[132:133], v244 offset:0
    ds_read_b64_tr_b16 v[134:135], v244 offset:2048
    s_waitcnt lgkmcnt(14)
    v_mfma_f32_32x32x16_bf16 v[80:95], v[168:171], v[188:191], v[80:95]
    ds_read_b64_tr_b16 v[136:137], v245 offset:0
    ds_read_b64_tr_b16 v[138:139], v245 offset:2048
    s_waitcnt lgkmcnt(14)
    v_mfma_f32_32x32x16_bf16 v[96:111], v[172:175], v[188:191], v[96:111]
    ds_read_b64_tr_b16 v[140:141], v246 offset:0
    ds_read_b64_tr_b16 v[142:143], v246 offset:2048
    s_waitcnt vmcnt(4) lgkmcnt(14)
    v_mfma_f32_32x32x16_bf16 v[48:63], v[112:115], v[196:199], v[48:63]
    ds_read_b64_tr_b16 v[160:161], v243 offset:8192
    ds_read_b64_tr_b16 v[162:163], v243 offset:10240
    s_waitcnt lgkmcnt(14)
    v_mfma_f32_32x32x16_bf16 v[64:79], v[116:119], v[196:199], v[64:79]
    ds_read_b64_tr_b16 v[164:165], v244 offset:8192
    ds_read_b64_tr_b16 v[166:167], v244 offset:10240
    s_waitcnt lgkmcnt(14)
    v_mfma_f32_32x32x16_bf16 v[80:95], v[120:123], v[196:199], v[80:95]
    ds_read_b64_tr_b16 v[168:169], v245 offset:8192
    ds_read_b64_tr_b16 v[170:171], v245 offset:10240
    s_waitcnt lgkmcnt(14)
    v_mfma_f32_32x32x16_bf16 v[96:111], v[124:127], v[196:199], v[96:111]
    ds_read_b64_tr_b16 v[172:173], v246 offset:8192
    ds_read_b64_tr_b16 v[174:175], v246 offset:10240
    s_waitcnt vmcnt(3) lgkmcnt(14)
    v_mfma_f32_32x32x16_bf16 v[48:63], v[128:131], v[200:203], v[48:63]
    ds_read_b64_tr_b16 v[112:113], v243 offset:16384
    ds_read_b64_tr_b16 v[114:115], v243 offset:18432
    s_waitcnt lgkmcnt(14)
    v_mfma_f32_32x32x16_bf16 v[64:79], v[132:135], v[200:203], v[64:79]
    ds_read_b64_tr_b16 v[116:117], v244 offset:16384
    ds_read_b64_tr_b16 v[118:119], v244 offset:18432
    s_waitcnt lgkmcnt(14)
    v_mfma_f32_32x32x16_bf16 v[80:95], v[136:139], v[200:203], v[80:95]
    ds_read_b64_tr_b16 v[120:121], v245 offset:16384
    ds_read_b64_tr_b16 v[122:123], v245 offset:18432
    s_waitcnt lgkmcnt(14)
    v_mfma_f32_32x32x16_bf16 v[96:111], v[140:143], v[200:203], v[96:111]
    ds_read_b64_tr_b16 v[124:125], v246 offset:16384
    ds_read_b64_tr_b16 v[126:127], v246 offset:18432
    s_waitcnt vmcnt(2) lgkmcnt(14)
    v_mfma_f32_32x32x16_bf16 v[48:63], v[160:163], v[208:211], v[48:63]
    ds_read_b64_tr_b16 v[128:129], v243 offset:24576
    ds_read_b64_tr_b16 v[130:131], v243 offset:26624
    s_waitcnt lgkmcnt(14)
    v_mfma_f32_32x32x16_bf16 v[64:79], v[164:167], v[208:211], v[64:79]
    ds_read_b64_tr_b16 v[132:133], v244 offset:24576
    ds_read_b64_tr_b16 v[134:135], v244 offset:26624
    s_waitcnt lgkmcnt(14)
    v_mfma_f32_32x32x16_bf16 v[80:95], v[168:171], v[208:211], v[80:95]
    ds_read_b64_tr_b16 v[136:137], v245 offset:24576
    ds_read_b64_tr_b16 v[138:139], v245 offset:26624
    s_waitcnt lgkmcnt(14)
    v_mfma_f32_32x32x16_bf16 v[96:111], v[172:175], v[208:211], v[96:111]
    ds_read_b64_tr_b16 v[140:141], v246 offset:24576
    ds_read_b64_tr_b16 v[142:143], v246 offset:26624
    s_waitcnt vmcnt(1) lgkmcnt(14)
    v_mfma_f32_32x32x16_bf16 v[48:63], v[112:115], v[212:215], v[48:63]
    s_waitcnt lgkmcnt(12)
    v_mfma_f32_32x32x16_bf16 v[64:79], v[116:119], v[212:215], v[64:79]
    s_waitcnt lgkmcnt(10)
    v_mfma_f32_32x32x16_bf16 v[80:95], v[120:123], v[212:215], v[80:95]
    s_waitcnt lgkmcnt(8)
    v_mfma_f32_32x32x16_bf16 v[96:111], v[124:127], v[212:215], v[96:111]
    s_waitcnt vmcnt(0) lgkmcnt(6)
    v_mfma_f32_32x32x16_bf16 v[48:63], v[128:131], v[220:223], v[48:63]
    s_waitcnt lgkmcnt(4)
    v_mfma_f32_32x32x16_bf16 v[64:79], v[132:135], v[220:223], v[64:79]
    s_waitcnt lgkmcnt(2)
    v_mfma_f32_32x32x16_bf16 v[80:95], v[136:139], v[220:223], v[80:95]
    s_waitcnt lgkmcnt(0)
    v_mfma_f32_32x32x16_bf16 v[96:111], v[140:143], v[220:223], v[96:111]
    s_nop 5
    v_cvt_pk_bf16_f32 v112, v48, v49
    v_cvt_pk_bf16_f32 v113, v50, v51
    v_cvt_pk_bf16_f32 v114, v52, v53
    v_cvt_pk_bf16_f32 v115, v54, v55
    buffer_store_dwordx4 v[112:115], v4, s[32:35], s14 offen offset:0 sc1
    v_cvt_pk_bf16_f32 v116, v56, v57
    v_cvt_pk_bf16_f32 v117, v58, v59
    v_cvt_pk_bf16_f32 v118, v60, v61
    v_cvt_pk_bf16_f32 v119, v62, v63
    buffer_store_dwordx4 v[116:119], v4, s[32:35], s14 offen offset:1024 sc1
    v_cvt_pk_bf16_f32 v120, v64, v65
    v_cvt_pk_bf16_f32 v121, v66, v67
    v_cvt_pk_bf16_f32 v122, v68, v69
    v_cvt_pk_bf16_f32 v123, v70, v71
    buffer_store_dwordx4 v[120:123], v4, s[32:35], s14 offen offset:2048 sc1
    v_cvt_pk_bf16_f32 v124, v72, v73
    v_cvt_pk_bf16_f32 v125, v74, v75
    v_cvt_pk_bf16_f32 v126, v76, v77
    v_cvt_pk_bf16_f32 v127, v78, v79
    buffer_store_dwordx4 v[124:127], v4, s[32:35], s14 offen offset:3072 sc1
    v_cvt_pk_bf16_f32 v128, v80, v81
    v_cvt_pk_bf16_f32 v129, v82, v83
    v_cvt_pk_bf16_f32 v130, v84, v85
    v_cvt_pk_bf16_f32 v131, v86, v87
    s_add_u32 s14, s14, 4096
    buffer_store_dwordx4 v[128:131], v4, s[32:35], s14 offen offset:0 sc1
    v_cvt_pk_bf16_f32 v132, v88, v89
    v_cvt_pk_bf16_f32 v133, v90, v91
    v_cvt_pk_bf16_f32 v134, v92, v93
    v_cvt_pk_bf16_f32 v135, v94, v95
    buffer_store_dwordx4 v[132:135], v4, s[32:35], s14 offen offset:1024 sc1
    v_cvt_pk_bf16_f32 v136, v96, v97
    v_cvt_pk_bf16_f32 v137, v98, v99
    v_cvt_pk_bf16_f32 v138, v100, v101
    v_cvt_pk_bf16_f32 v139, v102, v103
    buffer_store_dwordx4 v[136:139], v4, s[32:35], s14 offen offset:2048 sc1
    v_cvt_pk_bf16_f32 v140, v104, v105
    v_cvt_pk_bf16_f32 v141, v106, v107
    v_cvt_pk_bf16_f32 v142, v108, v109
    v_cvt_pk_bf16_f32 v143, v110, v111
    buffer_store_dwordx4 v[140:143], v4, s[32:35], s14 offen offset:3072 sc1
    s_mul_i32 s62, s45, 229376
    s_add_u32 s62, s62, 65011712
    s_lshl_b32 s63, s61, 11
    s_add_u32 s63, s63, s62
    s_add_u32 s62, s62, s50
    s_lshl_b32 s48, s44, 11
    v_add_u32 v10, s48, v4
    s_lshl_b32 s48, s44, 14
    v_add_u32 v11, s48, v4
    s_and_b32 s48, s44, 3
    s_lshl_b32 s48, s48, 10
    s_lshl_b32 s49, s52, 15
    s_add_u32 s64, s48, s49
    s_lshl_b32 s65, s45, 16
    s_add_u32 s65, s65, s64
    s_add_u32 s65, s65, 62914560
    v_lshlrev_b32 v8, 3, v2
    v_add_u32 v6, 131072, v8
    s_add_u32 s14, s56, 20971520
    s_lshr_b32 s48, s45, 1
    s_sub_u32 s49, 15, s48
    s_min_u32 s48, s48, s49
    s_lshl_b32 s48, s48, 2
    s_lshr_b32 s49, s46, 1
    s_lshl_b32 s49, s49, 8
    s_add_u32 s48, s48, s49
    v_and_b32 v242, 7, v1
    v_lshlrev_b32 v241, 10, v242
    v_add_u32 v241, s48, v241
    v_lshlrev_b32 v242, 2, v242
    v_bfe_u32 v5, v2, 1, 1
    v_lshrrev_b32 v7, 3, v2
    v_lshl_add_u32 v5, v7, 1, v5
    v_bfe_u32 v7, v2, 2, 1
    v_xor_b32 v7, v7, v3
    v_lshl_add_u32 v5, v7, 3, v5
    v_and_b32 v7, 1, v2
    v_lshlrev_b32 v7, 4, v7
    v_mov_b32 v0, 0x3f80
    v_lshlrev_b32 v7, v7, v0
    v_cmp_eq_u32 vcc, 0, v5
    s_nop 1
    v_cndmask_b32 v96, 0, v7, vcc
    v_cmp_eq_u32 vcc, 1, v5
    s_nop 1
    v_cndmask_b32 v97, 0, v7, vcc
    v_cmp_eq_u32 vcc, 2, v5
    s_nop 1
    v_cndmask_b32 v98, 0, v7, vcc
    v_cmp_eq_u32 vcc, 3, v5
    s_nop 1
    v_cndmask_b32 v99, 0, v7, vcc
    v_permlane32_swap_b32 v12, v14
    v_permlane32_swap_b32 v13, v15
    v_lshlrev_b32 v48, 16, v12
    v_and_b32 v49, 0xffff0000, v12
    v_lshlrev_b32 v50, 16, v13
    v_and_b32 v51, 0xffff0000, v13
    v_lshlrev_b32 v52, 16, v14
    v_and_b32 v53, 0xffff0000, v14
    v_lshlrev_b32 v54, 16, v15
    v_and_b32 v55, 0xffff0000, v15
    v_mov_b32 v252, 0x3f803f80
    v_mov_b32 v253, 0x3f803f80
    v_mov_b32 v254, 0x3f803f80
    v_mov_b32 v255, 0x3f803f80
    s_waitcnt vmcnt(0)
    s_barrier
    s_cmp_lg_u32 s44, 7
    s_cbranch_scc1 w7_75
    v_mov_b32 v243, 31
    buffer_store_dword v243, v240, s[32:35], s16 offen sc1
    s_barrier
    s_mov_b32 s48, 0x40000
pl_77:
    buffer_load_dword v247, v241, s[32:35], s4 offen sc1
    s_waitcnt vmcnt(0)
    v_and_b32 v247, 16, v247
    v_cmp_ne_u32 vcc, 16, v247
    s_sub_u32 s48, s48, 1
    s_cmp_eq_u32 s48, 0
    s_cbranch_scc1 pd_78
    s_cbranch_vccnz pl_77
pd_78:
    s_branch tj_76
w7_75:
    s_barrier
    buffer_load_dwordx4 v[180:183], v4, s[32:35], s59 offen offset:0 sc1
    buffer_load_dwordx4 v[192:195], v4, s[32:35], s59 offen offset:1024 sc1
    buffer_load_dwordx4 v[204:207], v4, s[32:35], s59 offen offset:2048 sc1
    buffer_load_dwordx4 v[216:219], v4, s[32:35], s59 offen offset:3072 sc1
    s_add_u32 s59, s59, 4096
    buffer_load_dwordx4 v[224:227], v4, s[32:35], s59 offen offset:0 sc1
    buffer_load_dwordx4 v[228:231], v4, s[32:35], s59 offen offset:1024 sc1
    buffer_load_dwordx4 v[232:235], v4, s[32:35], s59 offen offset:2048 sc1
    buffer_load_dwordx4 v[236:239], v4, s[32:35], s59 offen offset:3072 sc1
    s_add_u32 s59, s59, 4096
    buffer_load_dwordx4 v[144:147], v4, s[32:35], s59 offen offset:0 sc1
    buffer_load_dwordx4 v[148:151], v4, s[32:35], s59 offen offset:1024 sc1
    buffer_load_dwordx4 v[152:155], v4, s[32:35], s59 offen offset:2048 sc1
    buffer_load_dwordx4 v[156:159], v4, s[32:35], s59 offen offset:3072 sc1
    s_add_u32 s59, s59, 4096
    buffer_load_dwordx4 v[160:163], v4, s[32:35], s59 offen offset:0 sc1
    buffer_load_dwordx4 v[164:167], v4, s[32:35], s59 offen offset:1024 sc1
    buffer_load_dwordx4 v[168:171], v4, s[32:35], s59 offen offset:2048 sc1
    buffer_load_dwordx4 v[172:175], v4, s[32:35], s59 offen offset:3072 sc1
    s_add_u32 s59, s59, 4096
    buffer_load_dwordx4 v[16:19], v4, s[32:35], s59 offen offset:0 sc1
    buffer_load_dwordx4 v[20:23], v4, s[32:35], s59 offen offset:1024 sc1
    buffer_load_dwordx4 v[24:27], v4, s[32:35], s59 offen offset:2048 sc1
    buffer_load_dwordx4 v[28:31], v4, s[32:35], s59 offen offset:3072 sc1
    s_add_u32 s59, s59, 4096
tj_76:
mg_71:
    s_barrier
    buffer_load_dwordx4 v[112:115], v4, s[32:35], s14 offen sc1
    s_add_u32 s14, s14, 2097152
    buffer_load_dwordx4 v[116:119], v4, s[32:35], s14 offen sc1
    s_add_u32 s14, s14, 2097152
    buffer_load_dwordx4 v[120:123], v4, s[32:35], s14 offen sc1
    s_add_u32 s14, s14, 2097152
    buffer_load_dwordx4 v[124:127], v4, s[32:35], s14 offen sc1
    s_add_u32 s14, s14, 2097152
    buffer_load_dwordx4 v[128:131], v4, s[32:35], s14 offen sc1
    s_add_u32 s14, s14, 2097152
    buffer_load_dwordx4 v[132:135], v4, s[32:35], s14 offen sc1
    s_add_u32 s14, s14, 2097152
    buffer_load_dwordx4 v[136:139], v4, s[32:35], s14 offen sc1
    s_add_u32 s14, s14, 2097152
    buffer_load_dwordx4 v[140:143], v4, s[32:35], s14 offen sc1
    s_waitcnt vmcnt(7)
    v_mfma_f32_32x32x16_bf16 v[48:63], v[96:99], v[112:115], v[48:63]
    s_waitcnt vmcnt(6)
    v_mfma_f32_32x32x16_bf16 v[48:63], v[96:99], v[116:119], v[48:63]
    s_waitcnt vmcnt(5)
    v_mfma_f32_32x32x16_bf16 v[48:63], v[96:99], v[120:123], v[48:63]
    s_waitcnt vmcnt(4)
    v_mfma_f32_32x32x16_bf16 v[48:63], v[96:99], v[124:127], v[48:63]
    s_waitcnt vmcnt(3)
    v_mfma_f32_32x32x16_bf16 v[48:63], v[96:99], v[128:131], v[48:63]
    s_waitcnt vmcnt(2)
    v_mfma_f32_32x32x16_bf16 v[48:63], v[96:99], v[132:135], v[48:63]
    s_waitcnt vmcnt(1)
    v_mfma_f32_32x32x16_bf16 v[48:63], v[96:99], v[136:139], v[48:63]
    s_waitcnt vmcnt(0)
    v_mfma_f32_32x32x16_bf16 v[48:63], v[96:99], v[140:143], v[48:63]
    s_nop 11
    v_cvt_pk_bf16_f32 v12, v48, v49
    v_cvt_pk_bf16_f32 v13, v50, v51
    v_cvt_pk_bf16_f32 v14, v52, v53
    v_cvt_pk_bf16_f32 v15, v54, v55
    buffer_store_dwordx4 v[12:15], v4, s[32:35], s56 offen sc1
    v_lshlrev_b32 v48, 16, v12
    v_and_b32 v49, 0xffff0000, v12
    v_lshlrev_b32 v50, 16, v13
    v_and_b32 v51, 0xffff0000, v13
    v_lshlrev_b32 v52, 16, v14
    v_and_b32 v53, 0xffff0000, v14
    v_lshlrev_b32 v54, 16, v15
    v_and_b32 v55, 0xffff0000, v15
    v_add_f32 v64, v48, v49
    v_add_f32 v64, v64, v50
    v_add_f32 v64, v64, v51
    v_add_f32 v64, v64, v52
    v_add_f32 v64, v64, v53
    v_add_f32 v64, v64, v54
    v_add_f32 v64, v64, v55
    v_mov_b32 v65, v64
    s_nop 1
    v_permlane32_swap_b32 v64, v65
    v_add_f32 v64, v64, v65
    v_mul_f32 v66, 0x3d800000, v64
    v_sub_f32 v48, v48, v66
    v_sub_f32 v49, v49, v66
    v_sub_f32 v50, v50, v66
    v_sub_f32 v51, v51, v66
    v_sub_f32 v52, v52, v66
    v_sub_f32 v53, v53, v66
    v_sub_f32 v54, v54, v66
    v_sub_f32 v55, v55, v66
    v_mul_f32 v65, v48, v48
    v_fmac_f32 v65, v49, v49
    v_fmac_f32 v65, v50, v50
    v_fmac_f32 v65, v51, v51
    v_fmac_f32 v65, v52, v52
    v_fmac_f32 v65, v53, v53
    v_fmac_f32 v65, v54, v54
    v_fmac_f32 v65, v55, v55
    v_mov_b32 v66, v65
    s_nop 1
    v_permlane32_swap_b32 v65, v66
    v_add_f32 v65, v65, v66
    v_lshlrev_b32 v67, 30, v3
    v_add_u32 v67, v8, v67
    buffer_store_dwordx2 v[64:65], v67, s[32:35], s57 offen sc1
    s_waitcnt vmcnt(0)
    s_barrier
    s_cmp_eq_u32 s44, 7
    s_cbranch_scc1 w7_79
    s_barrier
    buffer_load_dwordx4 v[32:35], v4, s[32:35], s59 offen offset:0 sc1
    buffer_load_dwordx4 v[36:39], v4, s[32:35], s59 offen offset:1024 sc1
    buffer_load_dwordx4 v[40:43], v4, s[32:35], s59 offen offset:2048 sc1
    buffer_load_dwordx4 v[44:47], v4, s[32:35], s59 offen offset:3072 sc1
    s_add_u32 s59, s59, 4096
    buffer_load_dwordx4 v[176:179], v4, s[32:35], s59 offen offset:0 sc1
    buffer_load_dwordx4 v[184:187], v4, s[32:35], s59 offen offset:1024 sc1
    buffer_load_dwordx4 v[188:191], v4, s[32:35], s59 offen offset:2048 sc1
    buffer_load_dwordx4 v[196:199], v4, s[32:35], s59 offen offset:3072 sc1
    s_add_u32 s59, s59, 4096
    buffer_load_dwordx4 v[200:203], v4, s[32:35], s59 offen offset:0 sc1
    buffer_load_dwordx4 v[208:211], v4, s[32:35], s59 offen offset:1024 sc1
    buffer_load_dwordx4 v[212:215], v4, s[32:35], s59 offen offset:2048 sc1
    buffer_load_dwordx4 v[220:223], v4, s[32:35], s59 offen offset:3072 sc1
    v_mfma_f32_32x32x16_bf16 v[80:95], v[180:183], v[252:255], 0
    v_mfma_f32_32x32x16_bf16 v[80:95], v[192:195], v[252:255], v[80:95]
    v_mfma_f32_32x32x16_bf16 v[80:95], v[204:207], v[252:255], v[80:95]
    v_mfma_f32_32x32x16_bf16 v[80:95], v[216:219], v[252:255], v[80:95]
    v_mfma_f32_32x32x16_bf16 v[80:95], v[224:227], v[252:255], v[80:95]
    v_mfma_f32_32x32x16_bf16 v[80:95], v[228:231], v[252:255], v[80:95]
    v_mfma_f32_32x32x16_bf16 v[80:95], v[232:235], v[252:255], v[80:95]
    v_mfma_f32_32x32x16_bf16 v[80:95], v[236:239], v[252:255], v[80:95]
    v_mfma_f32_32x32x16_bf16 v[80:95], v[144:147], v[252:255], v[80:95]
    v_mfma_f32_32x32x16_bf16 v[80:95], v[148:151], v[252:255], v[80:95]
    v_mfma_f32_32x32x16_bf16 v[80:95], v[152:155], v[252:255], v[80:95]
    v_mfma_f32_32x32x16_bf16 v[80:95], v[156:159], v[252:255], v[80:95]
    v_mfma_f32_32x32x16_bf16 v[80:95], v[160:163], v[252:255], v[80:95]
    v_mfma_f32_32x32x16_bf16 v[80:95], v[164:167], v[252:255], v[80:95]
    v_mfma_f32_32x32x16_bf16 v[80:95], v[168:171], v[252:255], v[80:95]
    v_mfma_f32_32x32x16_bf16 v[80:95], v[172:175], v[252:255], v[80:95]
    v_mfma_f32_32x32x16_bf16 v[80:95], v[16:19], v[252:255], v[80:95]
    v_mfma_f32_32x32x16_bf16 v[80:95], v[20:23], v[252:255], v[80:95]
    v_mfma_f32_32x32x16_bf16 v[80:95], v[24:27], v[252:255], v[80:95]
    v_mfma_f32_32x32x16_bf16 v[80:95], v[28:31], v[252:255], v[80:95]
    s_waitcnt vmcnt(11)
    v_mfma_f32_32x32x16_bf16 v[80:95], v[32:35], v[252:255], v[80:95]
    s_waitcnt vmcnt(10)
    v_mfma_f32_32x32x16_bf16 v[80:95], v[36:39], v[252:255], v[80:95]
    s_waitcnt vmcnt(9)
    v_mfma_f32_32x32x16_bf16 v[80:95], v[40:43], v[252:255], v[80:95]
    s_waitcnt vmcnt(8)
    v_mfma_f32_32x32x16_bf16 v[80:95], v[44:47], v[252:255], v[80:95]
    s_waitcnt vmcnt(7)
    v_mfma_f32_32x32x16_bf16 v[80:95], v[176:179], v[252:255], v[80:95]
    s_waitcnt vmcnt(6)
    v_mfma_f32_32x32x16_bf16 v[80:95], v[184:187], v[252:255], v[80:95]
    s_waitcnt vmcnt(5)
    v_mfma_f32_32x32x16_bf16 v[80:95], v[188:191], v[252:255], v[80:95]
    s_waitcnt vmcnt(4)
    v_mfma_f32_32x32x16_bf16 v[80:95], v[196:199], v[252:255], v[80:95]
    s_waitcnt vmcnt(3)
    v_mfma_f32_32x32x16_bf16 v[80:95], v[200:203], v[252:255], v[80:95]
    s_waitcnt vmcnt(2)
    v_mfma_f32_32x32x16_bf16 v[80:95], v[208:211], v[252:255], v[80:95]
    s_waitcnt vmcnt(1)
    v_mfma_f32_32x32x16_bf16 v[80:95], v[212:215], v[252:255], v[80:95]
    s_waitcnt vmcnt(0)
    v_mfma_f32_32x32x16_bf16 v[80:95], v[220:223], v[252:255], v[80:95]
    s_barrier
    s_add_u32 m0, s64, 0
    s_nop 0
    buffer_load_dwordx4 v4, s[32:35], s65 offen sc1 lds
    s_add_u32 s65, s65, 4096
    s_add_u32 m0, s64, 4096
    s_nop 0
    buffer_load_dwordx4 v4, s[32:35], s65 offen sc1 lds
    s_add_u32 s65, s65, 4096
    s_add_u32 m0, s64, 8192
    s_nop 0
    buffer_load_dwordx4 v4, s[32:35], s65 offen sc1 lds
    s_add_u32 s65, s65, 4096
    s_add_u32 m0, s64, 12288
    s_nop 0
    buffer_load_dwordx4 v4, s[32:35], s65 offen sc1 lds
    s_add_u32 s65, s65, 4096
    s_add_u32 m0, s64, 16384
    s_nop 0
    buffer_load_dwordx4 v4, s[32:35], s65 offen sc1 lds
    s_add_u32 s65, s65, 4096
    s_add_u32 m0, s64, 20480
    s_nop 0
    buffer_load_dwordx4 v4, s[32:35], s65 offen sc1 lds
    s_add_u32 s65, s65, 4096
    s_add_u32 m0, s64, 24576
    s_nop 0
    buffer_load_dwordx4 v4, s[32:35], s65 offen sc1 lds
    s_add_u32 s65, s65, 4096
    s_add_u32 m0, s64, 28672
    s_nop 0
    buffer_load_dwordx4 v4, s[32:35], s65 offen sc1 lds
    s_add_u32 s65, s65, 4096
    s_waitcnt vmcnt(0)
    s_barrier
    ds_read_b128 v[112:115], v4 offset:0
    ds_read_b128 v[116:119], v4 offset:32768
    ds_read_b128 v[120:123], v4 offset:1024
    ds_read_b128 v[124:127], v4 offset:33792
    ds_read_b128 v[128:131], v4 offset:2048
    ds_read_b128 v[132:135], v4 offset:34816
    ds_read_b128 v[136:139], v4 offset:3072
    ds_read_b128 v[140:143], v4 offset:35840
    s_waitcnt lgkmcnt(7)
    v_mfma_f32_32x32x16_bf16 v[48:63], v[180:183], v[112:115], 0
    ds_read_b128 v[112:115], v4 offset:4096
    s_waitcnt lgkmcnt(7)
    v_mfma_f32_32x32x16_bf16 v[64:79], v[180:183], v[116:119], 0
    buffer_load_dwordx4 v[180:183], v4, s[32:35], s58 offen offset:0 sc1
    ds_read_b128 v[116:119], v4 offset:36864
    s_waitcnt lgkmcnt(7)
    v_mfma_f32_32x32x16_bf16 v[48:63], v[192:195], v[120:123], v[48:63]
    ds_read_b128 v[120:123], v4 offset:5120
    s_waitcnt lgkmcnt(7)
    v_mfma_f32_32x32x16_bf16 v[64:79], v[192:195], v[124:127], v[64:79]
    buffer_load_dwordx4 v[192:195], v4, s[32:35], s58 offen offset:1024 sc1
    ds_read_b128 v[124:127], v4 offset:37888
    s_waitcnt lgkmcnt(7)
    v_mfma_f32_32x32x16_bf16 v[48:63], v[204:207], v[128:131], v[48:63]
    ds_read_b128 v[128:131], v4 offset:6144
    s_waitcnt lgkmcnt(7)
    v_mfma_f32_32x32x16_bf16 v[64:79], v[204:207], v[132:135], v[64:79]
    buffer_load_dwordx4 v[204:207], v4, s[32:35], s58 offen offset:2048 sc1
    ds_read_b128 v[132:135], v4 offset:38912
    s_waitcnt lgkmcnt(7)
    v_mfma_f32_32x32x16_bf16 v[48:63], v[216:219], v[136:139], v[48:63]
    ds_read_b128 v[136:139], v4 offset:7168
    s_waitcnt lgkmcnt(7)
    v_mfma_f32_32x32x16_bf16 v[64:79], v[216:219], v[140:143], v[64:79]
    buffer_load_dwordx4 v[216:219], v4, s[32:35], s58 offen offset:3072 sc1
    s_add_u32 s58, s58, 4096
    ds_read_b128 v[140:143], v4 offset:39936
    s_waitcnt lgkmcnt(7)
    v_mfma_f32_32x32x16_bf16 v[48:63], v[224:227], v[112:115], v[48:63]
    ds_read_b128 v[112:115], v4 offset:8192
    s_waitcnt lgkmcnt(7)
    v_mfma_f32_32x32x16_bf16 v[64:79], v[224:227], v[116:119], v[64:79]
    buffer_load_dwordx4 v[224:227], v4, s[32:35], s58 offen offset:0 sc1
    ds_read_b128 v[116:119], v4 offset:40960
    s_waitcnt lgkmcnt(7)
    v_mfma_f32_32x32x16_bf16 v[48:63], v[228:231], v[120:123], v[48:63]
    ds_read_b128 v[120:123], v4 offset:9216
    s_waitcnt lgkmcnt(7)
    v_mfma_f32_32x32x16_bf16 v[64:79], v[228:231], v[124:127], v[64:79]
    buffer_load_dwordx4 v[228:231], v4, s[32:35], s58 offen offset:1024 sc1
    ds_read_b128 v[124:127], v4 offset:41984
    s_waitcnt lgkmcnt(7)
    v_mfma_f32_32x32x16_bf16 v[48:63], v[232:235], v[128:131], v[48:63]
    ds_read_b128 v[128:131], v4 offset:10240
    s_waitcnt lgkmcnt(7)
    v_mfma_f32_32x32x16_bf16 v[64:79], v[232:235], v[132:135], v[64:79]
    buffer_load_dwordx4 v[232:235], v4, s[32:35], s58 offen offset:2048 sc1
    ds_read_b128 v[132:135], v4 offset:43008
    s_waitcnt lgkmcnt(7)
    v_mfma_f32_32x32x16_bf16 v[48:63], v[236:239], v[136:139], v[48:63]
    ds_read_b128 v[136:139], v4 offset:11264
    s_waitcnt lgkmcnt(7)
    v_mfma_f32_32x32x16_bf16 v[64:79], v[236:239], v[140:143], v[64:79]
    buffer_load_dwordx4 v[236:239], v4, s[32:35], s58 offen offset:3072 sc1
    s_add_u32 s58, s58, 4096
    ds_read_b128 v[140:143], v4 offset:44032
    s_waitcnt lgkmcnt(7)
    v_mfma_f32_32x32x16_bf16 v[48:63], v[144:147], v[112:115], v[48:63]
    ds_read_b128 v[112:115], v4 offset:12288
    s_waitcnt lgkmcnt(7)
    v_mfma_f32_32x32x16_bf16 v[64:79], v[144:147], v[116:119], v[64:79]
    buffer_load_dwordx4 v[144:147], v4, s[32:35], s58 offen offset:0 sc1
    ds_read_b128 v[116:119], v4 offset:45056
    s_waitcnt lgkmcnt(7)
    v_mfma_f32_32x32x16_bf16 v[48:63], v[148:151], v[120:123], v[48:63]
    ds_read_b128 v[120:123], v4 offset:13312
    s_waitcnt lgkmcnt(7)
    v_mfma_f32_32x32x16_bf16 v[64:79], v[148:151], v[124:127], v[64:79]
    buffer_load_dwordx4 v[148:151], v4, s[32:35], s58 offen offset:1024 sc1
    ds_read_b128 v[124:127], v4 offset:46080
    s_waitcnt lgkmcnt(7)
    v_mfma_f32_32x32x16_bf16 v[48:63], v[152:155], v[128:131], v[48:63]
    ds_read_b128 v[128:131], v4 offset:14336
    s_waitcnt lgkmcnt(7)
    v_mfma_f32_32x32x16_bf16 v[64:79], v[152:155], v[132:135], v[64:79]
    buffer_load_dwordx4 v[152:155], v4, s[32:35], s58 offen offset:2048 sc1
    ds_read_b128 v[132:135], v4 offset:47104
    s_waitcnt lgkmcnt(7)
    v_mfma_f32_32x32x16_bf16 v[48:63], v[156:159], v[136:139], v[48:63]
    ds_read_b128 v[136:139], v4 offset:15360
    s_waitcnt lgkmcnt(7)
    v_mfma_f32_32x32x16_bf16 v[64:79], v[156:159], v[140:143], v[64:79]
    buffer_load_dwordx4 v[156:159], v4, s[32:35], s58 offen offset:3072 sc1
    s_add_u32 s58, s58, 4096
    ds_read_b128 v[140:143], v4 offset:48128
    s_waitcnt lgkmcnt(7)
    v_mfma_f32_32x32x16_bf16 v[48:63], v[160:163], v[112:115], v[48:63]
    ds_read_b128 v[112:115], v4 offset:16384
    s_waitcnt lgkmcnt(7)
    v_mfma_f32_32x32x16_bf16 v[64:79], v[160:163], v[116:119], v[64:79]
    buffer_load_dwordx4 v[160:163], v4, s[32:35], s58 offen offset:0 sc1
    ds_read_b128 v[116:119], v4 offset:49152
    s_waitcnt lgkmcnt(7)
    v_mfma_f32_32x32x16_bf16 v[48:63], v[164:167], v[120:123], v[48:63]
    ds_read_b128 v[120:123], v4 offset:17408
    s_waitcnt lgkmcnt(7)
    v_mfma_f32_32x32x16_bf16 v[64:79], v[164:167], v[124:127], v[64:79]
    buffer_load_dwordx4 v[164:167], v4, s[32:35], s58 offen offset:1024 sc1
    s_add_u32 s58, s58, 102400
    ds_read_b128 v[124:127], v4 offset:50176
    s_waitcnt lgkmcnt(7)
    v_mfma_f32_32x32x16_bf16 v[48:63], v[168:171], v[128:131], v[48:63]
    ds_read_b128 v[128:131], v4 offset:18432
    s_waitcnt lgkmcnt(7)
    v_mfma_f32_32x32x16_bf16 v[64:79], v[168:171], v[132:135], v[64:79]
    ds_read_b128 v[132:135], v4 offset:51200
    s_waitcnt lgkmcnt(7)
    v_mfma_f32_32x32x16_bf16 v[48:63], v[172:175], v[136:139], v[48:63]
    ds_read_b128 v[136:139], v4 offset:19456
    s_waitcnt lgkmcnt(7)
    v_mfma_f32_32x32x16_bf16 v[64:79], v[172:175], v[140:143], v[64:79]
    ds_read_b128 v[140:143], v4 offset:52224
    s_waitcnt lgkmcnt(7)
    v_mfma_f32_32x32x16_bf16 v[48:63], v[16:19], v[112:115], v[48:63]
    ds_read_b128 v[112:115], v4 offset:20480
    s_waitcnt lgkmcnt(7)
    v_mfma_f32_32x32x16_bf16 v[64:79], v[16:19], v[116:119], v[64:79]
    buffer_load_dwordx4 v[16:19], v4, s[32:35], s58 offen offset:0 sc1
    ds_read_b128 v[116:119], v4 offset:53248
    s_waitcnt lgkmcnt(7)
    v_mfma_f32_32x32x16_bf16 v[48:63], v[20:23], v[120:123], v[48:63]
    ds_read_b128 v[120:123], v4 offset:21504
    s_waitcnt lgkmcnt(7)
    v_mfma_f32_32x32x16_bf16 v[64:79], v[20:23], v[124:127], v[64:79]
    buffer_load_dwordx4 v[20:23], v4, s[32:35], s58 offen offset:1024 sc1
    ds_read_b128 v[124:127], v4 offset:54272
    s_waitcnt lgkmcnt(7)
    v_mfma_f32_32x32x16_bf16 v[48:63], v[24:27], v[128:131], v[48:63]
    ds_read_b128 v[128:131], v4 offset:22528
    s_waitcnt lgkmcnt(7)
    v_mfma_f32_32x32x16_bf16 v[64:79], v[24:27], v[132:135], v[64:79]
    buffer_load_dwordx4 v[24:27], v4, s[32:35], s58 offen offset:2048 sc1
    ds_read_b128 v[132:135], v4 offset:55296
    s_waitcnt lgkmcnt(7)
    v_mfma_f32_32x32x16_bf16 v[48:63], v[28:31], v[136:139], v[48:63]
    ds_read_b128 v[136:139], v4 offset:23552
    s_waitcnt lgkmcnt(7)
    v_mfma_f32_32x32x16_bf16 v[64:79], v[28:31], v[140:143], v[64:79]
    buffer_load_dwordx4 v[28:31], v4, s[32:35], s58 offen offset:3072 sc1
    s_add_u32 s58, s58, 4096
    ds_read_b128 v[140:143], v4 offset:56320
    s_waitcnt lgkmcnt(7)
    v_mfma_f32_32x32x16_bf16 v[48:63], v[32:35], v[112:115], v[48:63]
    ds_read_b128 v[112:115], v4 offset:24576
    s_waitcnt lgkmcnt(7)
    v_mfma_f32_32x32x16_bf16 v[64:79], v[32:35], v[116:119], v[64:79]
    buffer_load_dwordx4 v[32:35], v4, s[32:35], s58 offen offset:0 sc1
    ds_read_b128 v[116:119], v4 offset:57344
    s_waitcnt lgkmcnt(7)
    v_mfma_f32_32x32x16_bf16 v[48:63], v[36:39], v[120:123], v[48:63]
    ds_read_b128 v[120:123], v4 offset:25600
    s_waitcnt lgkmcnt(7)
    v_mfma_f32_32x32x16_bf16 v[64:79], v[36:39], v[124:127], v[64:79]
    buffer_load_dwordx4 v[36:39], v4, s[32:35], s58 offen offset:1024 sc1
    ds_read_b128 v[124:127], v4 offset:58368
    s_waitcnt lgkmcnt(7)
    v_mfma_f32_32x32x16_bf16 v[48:63], v[40:43], v[128:131], v[48:63]
    ds_read_b128 v[128:131], v4 offset:26624
    s_waitcnt lgkmcnt(7)
    v_mfma_f32_32x32x16_bf16 v[64:79], v[40:43], v[132:135], v[64:79]
    buffer_load_dwordx4 v[40:43], v4, s[32:35], s58 offen offset:2048 sc1
    ds_read_b128 v[132:135], v4 offset:59392
    s_waitcnt lgkmcnt(7)
    v_mfma_f32_32x32x16_bf16 v[48:63], v[44:47], v[136:139], v[48:63]
    ds_read_b128 v[136:139], v4 offset:27648
    s_waitcnt lgkmcnt(7)
    v_mfma_f32_32x32x16_bf16 v[64:79], v[44:47], v[140:143], v[64:79]
    buffer_load_dwordx4 v[44:47], v4, s[32:35], s58 offen offset:3072 sc1
    s_add_u32 s58, s58, 4096
    ds_read_b128 v[140:143], v4 offset:60416
    s_waitcnt lgkmcnt(7)
    v_mfma_f32_32x32x16_bf16 v[48:63], v[176:179], v[112:115], v[48:63]
    ds_read_b128 v[112:115], v4 offset:28672
    s_waitcnt lgkmcnt(7)
    v_mfma_f32_32x32x16_bf16 v[64:79], v[176:179], v[116:119], v[64:79]
    buffer_load_dwordx4 v[176:179], v4, s[32:35], s58 offen offset:0 sc1
    ds_read_b128 v[116:119], v4 offset:61440
    s_waitcnt lgkmcnt(7)
    v_mfma_f32_32x32x16_bf16 v[48:63], v[184:187], v[120:123], v[48:63]
    ds_read_b128 v[120:123], v4 offset:29696
    s_waitcnt lgkmcnt(7)
    v_mfma_f32_32x32x16_bf16 v[64:79], v[184:187], v[124:127], v[64:79]
    buffer_load_dwordx4 v[184:187], v4, s[32:35], s58 offen offset:1024 sc1
    ds_read_b128 v[124:127], v4 offset:62464
    s_waitcnt lgkmcnt(7)
    v_mfma_f32_32x32x16_bf16 v[48:63], v[188:191], v[128:131], v[48:63]
    ds_read_b128 v[128:131], v4 offset:30720
    s_waitcnt lgkmcnt(7)
    v_mfma_f32_32x32x16_bf16 v[64:79], v[188:191], v[132:135], v[64:79]
    buffer_load_dwordx4 v[188:191], v4, s[32:35], s58 offen offset:2048 sc1
    ds_read_b128 v[132:135], v4 offset:63488
    s_waitcnt lgkmcnt(7)
    v_mfma_f32_32x32x16_bf16 v[48:63], v[196:199], v[136:139], v[48:63]
    ds_read_b128 v[136:139], v4 offset:31744
    s_waitcnt lgkmcnt(7)
    v_mfma_f32_32x32x16_bf16 v[64:79], v[196:199], v[140:143], v[64:79]
    buffer_load_dwordx4 v[196:199], v4, s[32:35], s58 offen offset:3072 sc1
    s_add_u32 s58, s58, 4096
    ds_read_b128 v[140:143], v4 offset:64512
    s_waitcnt lgkmcnt(7)
    v_mfma_f32_32x32x16_bf16 v[48:63], v[200:203], v[112:115], v[48:63]
    s_barrier
    ds_read_b64 v[244:245], v6
    ds_read_b64 v[246:247], v6 offset:256
    s_waitcnt lgkmcnt(8)
    v_mfma_f32_32x32x16_bf16 v[64:79], v[200:203], v[116:119], v[64:79]
    buffer_load_dwordx4 v[200:203], v4, s[32:35], s58 offen offset:0 sc1
    s_waitcnt lgkmcnt(7)
    v_mfma_f32_32x32x16_bf16 v[48:63], v[208:211], v[120:123], v[48:63]
    s_waitcnt lgkmcnt(6)
    v_mfma_f32_32x32x16_bf16 v[64:79], v[208:211], v[124:127], v[64:79]
    buffer_load_dwordx4 v[208:211], v4, s[32:35], s58 offen offset:1024 sc1
    s_waitcnt lgkmcnt(5)
    v_mfma_f32_32x32x16_bf16 v[48:63], v[212:215], v[128:131], v[48:63]
    s_waitcnt lgkmcnt(4)
    v_mfma_f32_32x32x16_bf16 v[64:79], v[212:215], v[132:135], v[64:79]
    s_waitcnt lgkmcnt(3)
    v_mfma_f32_32x32x16_bf16 v[48:63], v[220:223], v[136:139], v[48:63]
    s_waitcnt lgkmcnt(2)
    v_mfma_f32_32x32x16_bf16 v[64:79], v[220:223], v[140:143], v[64:79]
    v_mov_b32 v0, 0
    s_waitcnt lgkmcnt(1)
    s_nop 7
    v_fma_f32 v48, -v244, v80, v48
    v_fma_f32 v49, -v244, v81, v49
    v_fma_f32 v50, -v244, v82, v50
    v_fma_f32 v51, -v244, v83, v51
    v_fma_f32 v52, -v244, v84, v52
    v_fma_f32 v53, -v244, v85, v53
    v_fma_f32 v54, -v244, v86, v54
    v_fma_f32 v55, -v244, v87, v55
    v_cvt_pk_bf16_f32 v96, v48, v49
    v_cvt_pk_bf16_f32 v97, v50, v51
    v_cvt_pk_bf16_f32 v98, v52, v53
    v_cvt_pk_bf16_f32 v99, v54, v55
    v_pk_max_i16 v96, v96, v0
    v_pk_max_i16 v97, v97, v0
    v_pk_max_i16 v98, v98, v0
    v_pk_max_i16 v99, v99, v0
    buffer_store_dwordx4 v[96:99], v4, s[32:35], s63 offen offset:0 sc1
    v_fma_f32 v56, -v244, v88, v56
    v_fma_f32 v57, -v244, v89, v57
    v_fma_f32 v58, -v244, v90, v58
    v_fma_f32 v59, -v244, v91, v59
    v_fma_f32 v60, -v244, v92, v60
    v_fma_f32 v61, -v244, v93, v61
    v_fma_f32 v62, -v244, v94, v62
    v_fma_f32 v63, -v244, v95, v63
    v_cvt_pk_bf16_f32 v100, v56, v57
    v_cvt_pk_bf16_f32 v101, v58, v59
    v_cvt_pk_bf16_f32 v102, v60, v61
    v_cvt_pk_bf16_f32 v103, v62, v63
    v_pk_max_i16 v100, v100, v0
    v_pk_max_i16 v101, v101, v0
    v_pk_max_i16 v102, v102, v0
    v_pk_max_i16 v103, v103, v0
    buffer_store_dwordx4 v[100:103], v4, s[32:35], s63 offen offset:1024 sc1
    s_add_u32 s63, s63, 114688
    s_waitcnt lgkmcnt(0)
    v_fma_f32 v64, -v246, v80, v64
    v_fma_f32 v65, -v246, v81, v65
    v_fma_f32 v66, -v246, v82, v66
    v_fma_f32 v67, -v246, v83, v67
    v_fma_f32 v68, -v246, v84, v68
    v_fma_f32 v69, -v246, v85, v69
    v_fma_f32 v70, -v246, v86, v70
    v_fma_f32 v71, -v246, v87, v71
    v_cvt_pk_bf16_f32 v104, v64, v65
    v_cvt_pk_bf16_f32 v105, v66, v67
    v_cvt_pk_bf16_f32 v106, v68, v69
    v_cvt_pk_bf16_f32 v107, v70, v71
    v_pk_max_i16 v104, v104, v0
    v_pk_max_i16 v105, v105, v0
    v_pk_max_i16 v106, v106, v0
    v_pk_max_i16 v107, v107, v0
    buffer_store_dwordx4 v[104:107], v4, s[32:35], s63 offen offset:0 sc1
    v_fma_f32 v72, -v246, v88, v72
    v_fma_f32 v73, -v246, v89, v73
    v_fma_f32 v74, -v246, v90, v74
    v_fma_f32 v75, -v246, v91, v75
    v_fma_f32 v76, -v246, v92, v76
    v_fma_f32 v77, -v246, v93, v77
    v_fma_f32 v78, -v246, v94, v78
    v_fma_f32 v79, -v246, v95, v79
    v_cvt_pk_bf16_f32 v108, v72, v73
    v_cvt_pk_bf16_f32 v109, v74, v75
    v_cvt_pk_bf16_f32 v110, v76, v77
    v_cvt_pk_bf16_f32 v111, v78, v79
    v_pk_max_i16 v108, v108, v0
    v_pk_max_i16 v109, v109, v0
    v_pk_max_i16 v110, v110, v0
    v_pk_max_i16 v111, v111, v0
    buffer_store_dwordx4 v[108:111], v4, s[32:35], s63 offen offset:1024 sc1
    s_waitcnt vmcnt(0)
    s_barrier
    s_branch tj_80
w7_79:
    v_mov_b32 v243, 63
    buffer_store_dword v243, v240, s[32:35], s16 offen sc1
    s_barrier
    s_mov_b32 s48, 0x40000
pl_81:
    buffer_load_dword v247, v242, s[32:35], s16 offen sc1
    s_waitcnt vmcnt(0)
    v_and_b32 v247, 32, v247
    v_cmp_ne_u32 vcc, 32, v247
    s_sub_u32 s48, s48, 1
    s_cmp_eq_u32 s48, 0
    s_cbranch_scc1 pd_82
    s_cbranch_vccnz pl_81
pd_82:
    s_barrier
    s_add_u32 m0, s64, 0
    s_nop 0
    buffer_load_dwordx4 v4, s[32:35], s65 offen sc1 lds
    s_add_u32 s65, s65, 4096
    s_add_u32 m0, s64, 4096
    s_nop 0
    buffer_load_dwordx4 v4, s[32:35], s65 offen sc1 lds
    s_add_u32 s65, s65, 4096
    s_add_u32 m0, s64, 8192
    s_nop 0
    buffer_load_dwordx4 v4, s[32:35], s65 offen sc1 lds
    s_add_u32 s65, s65, 4096
    s_add_u32 m0, s64, 12288
    s_nop 0
    buffer_load_dwordx4 v4, s[32:35], s65 offen sc1 lds
    s_add_u32 s65, s65, 4096
    s_add_u32 m0, s64, 16384
    s_nop 0
    buffer_load_dwordx4 v4, s[32:35], s65 offen sc1 lds
    s_add_u32 s65, s65, 4096
    s_add_u32 m0, s64, 20480
    s_nop 0
    buffer_load_dwordx4 v4, s[32:35], s65 offen sc1 lds
    s_add_u32 s65, s65, 4096
    s_add_u32 m0, s64, 24576
    s_nop 0
    buffer_load_dwordx4 v4, s[32:35], s65 offen sc1 lds
    s_add_u32 s65, s65, 4096
    s_add_u32 m0, s64, 28672
    s_nop 0
    buffer_load_dwordx4 v4, s[32:35], s65 offen sc1 lds
    s_add_u32 s65, s65, 4096
    v_lshlrev_b32 v5, 13, v3
    v_add_u32 v5, v5, v8
    s_lshl_b32 s48, s45, 14
    s_add_u32 s48, s48, 73400320
    buffer_load_dwordx2 v[48:49], v5, s[32:35], s48 offen offset:0 sc1
    buffer_load_dwordx2 v[50:51], v5, s[32:35], s48 offen offset:256 sc1
    buffer_load_dwordx2 v[52:53], v5, s[32:35], s48 offen offset:512 sc1
    buffer_load_dwordx2 v[54:55], v5, s[32:35], s48 offen offset:768 sc1
    buffer_load_dwordx2 v[56:57], v5, s[32:35], s48 offen offset:1024 sc1
    buffer_load_dwordx2 v[58:59], v5, s[32:35], s48 offen offset:1280 sc1
    buffer_load_dwordx2 v[60:61], v5, s[32:35], s48 offen offset:1536 sc1
    buffer_load_dwordx2 v[62:63], v5, s[32:35], s48 offen offset:1792 sc1
    buffer_load_dwordx2 v[64:65], v5, s[32:35], s48 offen offset:2048 sc1
    buffer_load_dwordx2 v[66:67], v5, s[32:35], s48 offen offset:2304 sc1
    buffer_load_dwordx2 v[68:69], v5, s[32:35], s48 offen offset:2560 sc1
    buffer_load_dwordx2 v[70:71], v5, s[32:35], s48 offen offset:2816 sc1
    buffer_load_dwordx2 v[72:73], v5, s[32:35], s48 offen offset:3072 sc1
    buffer_load_dwordx2 v[74:75], v5, s[32:35], s48 offen offset:3328 sc1
    buffer_load_dwordx2 v[76:77], v5, s[32:35], s48 offen offset:3584 sc1
    buffer_load_dwordx2 v[78:79], v5, s[32:35], s48 offen offset:3840 sc1
    s_add_u32 s48, s48, 4096
    buffer_load_dwordx2 v[80:81], v5, s[32:35], s48 offen offset:0 sc1
    buffer_load_dwordx2 v[82:83], v5, s[32:35], s48 offen offset:256 sc1
    buffer_load_dwordx2 v[84:85], v5, s[32:35], s48 offen offset:512 sc1
    buffer_load_dwordx2 v[86:87], v5, s[32:35], s48 offen offset:768 sc1
    buffer_load_dwordx2 v[88:89], v5, s[32:35], s48 offen offset:1024 sc1
    buffer_load_dwordx2 v[90:91], v5, s[32:35], s48 offen offset:1280 sc1
    buffer_load_dwordx2 v[92:93], v5, s[32:35], s48 offen offset:1536 sc1
    buffer_load_dwordx2 v[94:95], v5, s[32:35], s48 offen offset:1792 sc1
    buffer_load_dwordx2 v[96:97], v5, s[32:35], s48 offen offset:2048 sc1
    buffer_load_dwordx2 v[98:99], v5, s[32:35], s48 offen offset:2304 sc1
    buffer_load_dwordx2 v[100:101], v5, s[32:35], s48 offen offset:2560 sc1
    buffer_load_dwordx2 v[102:103], v5, s[32:35], s48 offen offset:2816 sc1
    buffer_load_dwordx2 v[104:105], v5, s[32:35], s48 offen offset:3072 sc1
    buffer_load_dwordx2 v[106:107], v5, s[32:35], s48 offen offset:3328 sc1
    buffer_load_dwordx2 v[108:109], v5, s[32:35], s48 offen offset:3584 sc1
    buffer_load_dwordx2 v[110:111], v5, s[32:35], s48 offen offset:3840 sc1
    s_waitcnt vmcnt(32)
    s_barrier
    buffer_load_dwordx4 v[180:183], v4, s[32:35], s58 offen offset:0 sc1
    buffer_load_dwordx4 v[192:195], v4, s[32:35], s58 offen offset:1024 sc1
    buffer_load_dwordx4 v[204:207], v4, s[32:35], s58 offen offset:2048 sc1
    buffer_load_dwordx4 v[216:219], v4, s[32:35], s58 offen offset:3072 sc1
    s_add_u32 s58, s58, 4096
    buffer_load_dwordx4 v[224:227], v4, s[32:35], s58 offen offset:0 sc1
    buffer_load_dwordx4 v[228:231], v4, s[32:35], s58 offen offset:1024 sc1
    buffer_load_dwordx4 v[232:235], v4, s[32:35], s58 offen offset:2048 sc1
    buffer_load_dwordx4 v[236:239], v4, s[32:35], s58 offen offset:3072 sc1
    s_add_u32 s58, s58, 4096
    buffer_load_dwordx4 v[144:147], v4, s[32:35], s58 offen offset:0 sc1
    buffer_load_dwordx4 v[148:151], v4, s[32:35], s58 offen offset:1024 sc1
    buffer_load_dwordx4 v[152:155], v4, s[32:35], s58 offen offset:2048 sc1
    buffer_load_dwordx4 v[156:159], v4, s[32:35], s58 offen offset:3072 sc1
    s_add_u32 s58, s58, 4096
    buffer_load_dwordx4 v[160:163], v4, s[32:35], s58 offen offset:0 sc1
    buffer_load_dwordx4 v[164:167], v4, s[32:35], s58 offen offset:1024 sc1
    s_add_u32 s58, s58, 102400
    buffer_load_dwordx4 v[16:19], v4, s[32:35], s58 offen offset:0 sc1
    buffer_load_dwordx4 v[20:23], v4, s[32:35], s58 offen offset:1024 sc1
    buffer_load_dwordx4 v[24:27], v4, s[32:35], s58 offen offset:2048 sc1
    buffer_load_dwordx4 v[28:31], v4, s[32:35], s58 offen offset:3072 sc1
    s_add_u32 s58, s58, 4096
    buffer_load_dwordx4 v[32:35], v4, s[32:35], s58 offen offset:0 sc1
    buffer_load_dwordx4 v[36:39], v4, s[32:35], s58 offen offset:1024 sc1
    buffer_load_dwordx4 v[40:43], v4, s[32:35], s58 offen offset:2048 sc1
    buffer_load_dwordx4 v[44:47], v4, s[32:35], s58 offen offset:3072 sc1
    s_add_u32 s58, s58, 4096
    buffer_load_dwordx4 v[176:179], v4, s[32:35], s58 offen offset:0 sc1
    buffer_load_dwordx4 v[184:187], v4, s[32:35], s58 offen offset:1024 sc1
    buffer_load_dwordx4 v[188:191], v4, s[32:35], s58 offen offset:2048 sc1
    buffer_load_dwordx4 v[196:199], v4, s[32:35], s58 offen offset:3072 sc1
    s_add_u32 s58, s58, 4096
    buffer_load_dwordx4 v[200:203], v4, s[32:35], s58 offen offset:0 sc1
    buffer_load_dwordx4 v[208:211], v4, s[32:35], s58 offen offset:1024 sc1
    s_waitcnt vmcnt(58)
    v_add_f32 v112, v48, v50
    v_add_f32 v113, v49, v51
    s_waitcnt vmcnt(57)
    v_add_f32 v112, v112, v52
    v_add_f32 v113, v113, v53
    s_waitcnt vmcnt(56)
    v_add_f32 v112, v112, v54
    v_add_f32 v113, v113, v55
    s_waitcnt vmcnt(55)
    v_add_f32 v112, v112, v56
    v_add_f32 v113, v113, v57
    s_waitcnt vmcnt(54)
    v_add_f32 v112, v112, v58
    v_add_f32 v113, v113, v59
    s_waitcnt vmcnt(53)
    v_add_f32 v112, v112, v60
    v_add_f32 v113, v113, v61
    s_waitcnt vmcnt(52)
    v_add_f32 v112, v112, v62
    v_add_f32 v113, v113, v63
    s_waitcnt vmcnt(51)
    v_add_f32 v112, v112, v64
    v_add_f32 v113, v113, v65
    s_waitcnt vmcnt(50)
    v_add_f32 v112, v112, v66
    v_add_f32 v113, v113, v67
    s_waitcnt vmcnt(49)
    v_add_f32 v112, v112, v68
    v_add_f32 v113, v113, v69
    s_waitcnt vmcnt(48)
    v_add_f32 v112, v112, v70
    v_add_f32 v113, v113, v71
    s_waitcnt vmcnt(47)
    v_add_f32 v112, v112, v72
    v_add_f32 v113, v113, v73
    s_waitcnt vmcnt(46)
    v_add_f32 v112, v112, v74
    v_add_f32 v113, v113, v75
    s_waitcnt vmcnt(45)
    v_add_f32 v112, v112, v76
    v_add_f32 v113, v113, v77
    s_waitcnt vmcnt(44)
    v_add_f32 v112, v112, v78
    v_add_f32 v113, v113, v79
    s_waitcnt vmcnt(43)
    v_add_f32 v112, v112, v80
    v_add_f32 v113, v113, v81
    s_waitcnt vmcnt(42)
    v_add_f32 v112, v112, v82
    v_add_f32 v113, v113, v83
    s_waitcnt vmcnt(41)
    v_add_f32 v112, v112, v84
    v_add_f32 v113, v113, v85
    s_waitcnt vmcnt(40)
    v_add_f32 v112, v112, v86
    v_add_f32 v113, v113, v87
    s_waitcnt vmcnt(39)
    v_add_f32 v112, v112, v88
    v_add_f32 v113, v113, v89
    s_waitcnt vmcnt(38)
    v_add_f32 v112, v112, v90
    v_add_f32 v113, v113, v91
    s_waitcnt vmcnt(37)
    v_add_f32 v112, v112, v92
    v_add_f32 v113, v113, v93
    s_waitcnt vmcnt(36)
    v_add_f32 v112, v112, v94
    v_add_f32 v113, v113, v95
    s_waitcnt vmcnt(35)
    v_add_f32 v112, v112, v96
    v_add_f32 v113, v113, v97
    s_waitcnt vmcnt(34)
    v_add_f32 v112, v112, v98
    v_add_f32 v113, v113, v99
    s_waitcnt vmcnt(33)
    v_add_f32 v112, v112, v100
    v_add_f32 v113, v113, v101
    s_waitcnt vmcnt(32)
    v_add_f32 v112, v112, v102
    v_add_f32 v113, v113, v103
    s_waitcnt vmcnt(31)
    v_add_f32 v112, v112, v104
    v_add_f32 v113, v113, v105
    s_waitcnt vmcnt(30)
    v_add_f32 v112, v112, v106
    v_add_f32 v113, v113, v107
    s_waitcnt vmcnt(29)
    v_add_f32 v112, v112, v108
    v_add_f32 v113, v113, v109
    s_waitcnt vmcnt(28)
    v_add_f32 v112, v112, v110
    v_add_f32 v113, v113, v111
    v_mul_f32 v112, 0x3b000000, v112
    v_mov_b32 v114, 0
    s_mov_b32 s48, 0x3d800000
    v_fma_f32 v48, v48, s48, -v112
    v_fmac_f32 v114, v48, v48
    v_fma_f32 v50, v50, s48, -v112
    v_fmac_f32 v114, v50, v50
    v_fma_f32 v52, v52, s48, -v112
    v_fmac_f32 v114, v52, v52
    v_fma_f32 v54, v54, s48, -v112
    v_fmac_f32 v114, v54, v54
    v_fma_f32 v56, v56, s48, -v112
    v_fmac_f32 v114, v56, v56
    v_fma_f32 v58, v58, s48, -v112
    v_fmac_f32 v114, v58, v58
    v_fma_f32 v60, v60, s48, -v112
    v_fmac_f32 v114, v60, v60
    v_fma_f32 v62, v62, s48, -v112
    v_fmac_f32 v114, v62, v62
    v_fma_f32 v64, v64, s48, -v112
    v_fmac_f32 v114, v64, v64
    v_fma_f32 v66, v66, s48, -v112
    v_fmac_f32 v114, v66, v66
    v_fma_f32 v68, v68, s48, -v112
    v_fmac_f32 v114, v68, v68
    v_fma_f32 v70, v70, s48, -v112
    v_fmac_f32 v114, v70, v70
    v_fma_f32 v72, v72, s48, -v112
    v_fmac_f32 v114, v72, v72
    v_fma_f32 v74, v74, s48, -v112
    v_fmac_f32 v114, v74, v74
    v_fma_f32 v76, v76, s48, -v112
    v_fmac_f32 v114, v76, v76
    v_fma_f32 v78, v78, s48, -v112
    v_fmac_f32 v114, v78, v78
    v_fma_f32 v80, v80, s48, -v112
    v_fmac_f32 v114, v80, v80
    v_fma_f32 v82, v82, s48, -v112
    v_fmac_f32 v114, v82, v82
    v_fma_f32 v84, v84, s48, -v112
    v_fmac_f32 v114, v84, v84
    v_fma_f32 v86, v86, s48, -v112
    v_fmac_f32 v114, v86, v86
    v_fma_f32 v88, v88, s48, -v112
    v_fmac_f32 v114, v88, v88
    v_fma_f32 v90, v90, s48, -v112
    v_fmac_f32 v114, v90, v90
    v_fma_f32 v92, v92, s48, -v112
    v_fmac_f32 v114, v92, v92
    v_fma_f32 v94, v94, s48, -v112
    v_fmac_f32 v114, v94, v94
    v_fma_f32 v96, v96, s48, -v112
    v_fmac_f32 v114, v96, v96
    v_fma_f32 v98, v98, s48, -v112
    v_fmac_f32 v114, v98, v98
    v_fma_f32 v100, v100, s48, -v112
    v_fmac_f32 v114, v100, v100
    v_fma_f32 v102, v102, s48, -v112
    v_fmac_f32 v114, v102, v102
    v_fma_f32 v104, v104, s48, -v112
    v_fmac_f32 v114, v104, v104
    v_fma_f32 v106, v106, s48, -v112
    v_fmac_f32 v114, v106, v106
    v_fma_f32 v108, v108, s48, -v112
    v_fmac_f32 v114, v108, v108
    v_fma_f32 v110, v110, s48, -v112
    v_fmac_f32 v114, v110, v110
    v_fmac_f32 v113, 0x41800000, v114
    v_mov_b32 v114, 0x3727c5ac
    v_fmac_f32 v114, 0x3b000000, v113
    v_rsq_f32 v113, v114
    v_lshlrev_b32 v5, 3, v1
    v_add_u32 v5, 131072, v5
    ds_write_b64 v5, v[112:113]
    s_waitcnt lgkmcnt(0)
    s_barrier
    s_waitcnt vmcnt(0)
    s_barrier
tj_80:
    s_lshl_b32 s48, s52, 8
    v_add_u32 v6, s48, v6
    ds_read_b32 v3, v6 offset:4
    v_add_u32 v7, 114688, v4
    s_mov_b32 s63, s62
    buffer_load_dwordx4 v[112:115], v4, s[32:35], s62 offen offset:0 sc1
    buffer_load_dwordx4 v[116:119], v7, s[32:35], s62 offen offset:0 sc1
    buffer_load_dwordx4 v[120:123], v4, s[32:35], s62 offen offset:1024 sc1
    buffer_load_dwordx4 v[124:127], v7, s[32:35], s62 offen offset:1024 sc1
    buffer_load_dwordx4 v[128:131], v4, s[32:35], s62 offen offset:2048 sc1
    buffer_load_dwordx4 v[132:135], v7, s[32:35], s62 offen offset:2048 sc1
    buffer_load_dwordx4 v[136:139], v4, s[32:35], s62 offen offset:3072 sc1
    buffer_load_dwordx4 v[140:143], v7, s[32:35], s62 offen offset:3072 sc1
    s_add_u32 s62, s62, 4096
    buffer_load_dwordx4 v[168:171], v4, s[32:35], s62 offen offset:0 sc1
    buffer_load_dwordx4 v[172:175], v7, s[32:35], s62 offen offset:0 sc1
    buffer_load_dwordx4 v[212:215], v4, s[32:35], s62 offen offset:1024 sc1
    buffer_load_dwordx4 v[220:223], v7, s[32:35], s62 offen offset:1024 sc1
    v_lshlrev_b32 v244, 16, v12
    v_and_b32 v245, 0xffff0000, v12
    v_lshlrev_b32 v246, 16, v13
    v_and_b32 v247, 0xffff0000, v13
    v_lshlrev_b32 v248, 16, v14
    v_and_b32 v249, 0xffff0000, v14
    v_lshlrev_b32 v250, 16, v15
    v_and_b32 v251, 0xffff0000, v15
    s_waitcnt vmcnt(11)
    v_or3_b32 v0, v112, v113, v114
    s_waitcnt vmcnt(10)
    v_or3_b32 v5, v116, v117, v118
    v_or3_b32 v0, v0, v115, v119
    v_or_b32 v0, v0, v5
    v_cmp_gt_i32 vcc, 0, v0
    s_cbranch_vccnz spin_83
spb_84:
    v_mfma_f32_32x32x16_bf16 v[48:63], v[180:183], v[112:115], 0
    v_mfma_f32_32x32x16_bf16 v[64:79], v[16:19], v[112:115], 0
    v_mfma_f32_32x32x16_bf16 v[80:95], v[180:183], v[116:119], 0
    v_mfma_f32_32x32x16_bf16 v[96:111], v[16:19], v[116:119], 0
    buffer_load_dwordx4 v[112:115], v4, s[32:35], s62 offen offset:2048 sc1
    buffer_load_dwordx4 v[116:119], v7, s[32:35], s62 offen offset:2048 sc1
    s_waitcnt vmcnt(11)
    v_or3_b32 v0, v120, v121, v122
    s_waitcnt vmcnt(10)
    v_or3_b32 v5, v124, v125, v126
    v_or3_b32 v0, v0, v123, v127
    v_or_b32 v0, v0, v5
    v_cmp_gt_i32 vcc, 0, v0
    s_cbranch_vccnz spin_85
spb_86:
    v_mfma_f32_32x32x16_bf16 v[48:63], v[192:195], v[120:123], v[48:63]
    v_mfma_f32_32x32x16_bf16 v[64:79], v[20:23], v[120:123], v[64:79]
    v_mfma_f32_32x32x16_bf16 v[80:95], v[192:195], v[124:127], v[80:95]
    v_mfma_f32_32x32x16_bf16 v[96:111], v[20:23], v[124:127], v[96:111]
    buffer_load_dwordx4 v[120:123], v4, s[32:35], s62 offen offset:3072 sc1
    buffer_load_dwordx4 v[124:127], v7, s[32:35], s62 offen offset:3072 sc1
    s_add_u32 s62, s62, 4096
    s_waitcnt vmcnt(11)
    v_or3_b32 v0, v128, v129, v130
    s_waitcnt vmcnt(10)
    v_or3_b32 v5, v132, v133, v134
    v_or3_b32 v0, v0, v131, v135
    v_or_b32 v0, v0, v5
    v_cmp_gt_i32 vcc, 0, v0
    s_cbranch_vccnz spin_87
spb_88:
    v_mfma_f32_32x32x16_bf16 v[48:63], v[204:207], v[128:131], v[48:63]
    v_mfma_f32_32x32x16_bf16 v[64:79], v[24:27], v[128:131], v[64:79]
    v_mfma_f32_32x32x16_bf16 v[80:95], v[204:207], v[132:135], v[80:95]
    v_mfma_f32_32x32x16_bf16 v[96:111], v[24:27], v[132:135], v[96:111]
    buffer_load_dwordx4 v[128:131], v4, s[32:35], s62 offen offset:0 sc1
    buffer_load_dwordx4 v[132:135], v7, s[32:35], s62 offen offset:0 sc1
    s_waitcnt vmcnt(11)
    v_or3_b32 v0, v136, v137, v138
    s_waitcnt vmcnt(10)
    v_or3_b32 v5, v140, v141, v142
    v_or3_b32 v0, v0, v139, v143
    v_or_b32 v0, v0, v5
    v_cmp_gt_i32 vcc, 0, v0
    s_cbranch_vccnz spin_89
spb_90:
    v_mfma_f32_32x32x16_bf16 v[48:63], v[216:219], v[136:139], v[48:63]
    v_mfma_f32_32x32x16_bf16 v[64:79], v[28:31], v[136:139], v[64:79]
    v_mfma_f32_32x32x16_bf16 v[80:95], v[216:219], v[140:143], v[80:95]
    v_mfma_f32_32x32x16_bf16 v[96:111], v[28:31], v[140:143], v[96:111]
    buffer_load_dwordx4 v[136:139], v4, s[32:35], s62 offen offset:1024 sc1
    buffer_load_dwordx4 v[140:143], v7, s[32:35], s62 offen offset:1024 sc1
    s_waitcnt vmcnt(11)
    v_or3_b32 v0, v168, v169, v170
    s_waitcnt vmcnt(10)
    v_or3_b32 v5, v172, v173, v174
    v_or3_b32 v0, v0, v171, v175
    v_or_b32 v0, v0, v5
    v_cmp_gt_i32 vcc, 0, v0
    s_cbranch_vccnz spin_91
spb_92:
    v_mfma_f32_32x32x16_bf16 v[48:63], v[224:227], v[168:171], v[48:63]
    v_mfma_f32_32x32x16_bf16 v[64:79], v[32:35], v[168:171], v[64:79]
    v_mfma_f32_32x32x16_bf16 v[80:95], v[224:227], v[172:175], v[80:95]
    v_mfma_f32_32x32x16_bf16 v[96:111], v[32:35], v[172:175], v[96:111]
    buffer_load_dwordx4 v[168:171], v4, s[32:35], s62 offen offset:2048 sc1
    buffer_load_dwordx4 v[172:175], v7, s[32:35], s62 offen offset:2048 sc1
    s_waitcnt vmcnt(11)
    v_or3_b32 v0, v212, v213, v214
    s_waitcnt vmcnt(10)
    v_or3_b32 v5, v220, v221, v222
    v_or3_b32 v0, v0, v215, v223
    v_or_b32 v0, v0, v5
    v_cmp_gt_i32 vcc, 0, v0
    s_cbranch_vccnz spin_93
spb_94:
    v_mfma_f32_32x32x16_bf16 v[48:63], v[228:231], v[212:215], v[48:63]
    v_mfma_f32_32x32x16_bf16 v[64:79], v[36:39], v[212:215], v[64:79]
    v_mfma_f32_32x32x16_bf16 v[80:95], v[228:231], v[220:223], v[80:95]
    v_mfma_f32_32x32x16_bf16 v[96:111], v[36:39], v[220:223], v[96:111]
    buffer_load_dwordx4 v[212:215], v4, s[32:35], s62 offen offset:3072 sc1
    buffer_load_dwordx4 v[220:223], v7, s[32:35], s62 offen offset:3072 sc1
    s_add_u32 s62, s62, 4096
    s_waitcnt vmcnt(11)
    v_or3_b32 v0, v112, v113, v114
    s_waitcnt vmcnt(10)
    v_or3_b32 v5, v116, v117, v118
    v_or3_b32 v0, v0, v115, v119
    v_or_b32 v0, v0, v5
    v_cmp_gt_i32 vcc, 0, v0
    s_cbranch_vccnz spin_95
spb_96:
    v_mfma_f32_32x32x16_bf16 v[48:63], v[232:235], v[112:115], v[48:63]
    v_mfma_f32_32x32x16_bf16 v[64:79], v[40:43], v[112:115], v[64:79]
    v_mfma_f32_32x32x16_bf16 v[80:95], v[232:235], v[116:119], v[80:95]
    v_mfma_f32_32x32x16_bf16 v[96:111], v[40:43], v[116:119], v[96:111]
    buffer_load_dwordx4 v[112:115], v4, s[32:35], s62 offen offset:0 sc1
    buffer_load_dwordx4 v[116:119], v7, s[32:35], s62 offen offset:0 sc1
    s_waitcnt vmcnt(11)
    v_or3_b32 v0, v120, v121, v122
    s_waitcnt vmcnt(10)
    v_or3_b32 v5, v124, v125, v126
    v_or3_b32 v0, v0, v123, v127
    v_or_b32 v0, v0, v5
    v_cmp_gt_i32 vcc, 0, v0
    s_cbranch_vccnz spin_97
spb_98:
    v_mfma_f32_32x32x16_bf16 v[48:63], v[236:239], v[120:123], v[48:63]
    v_mfma_f32_32x32x16_bf16 v[64:79], v[44:47], v[120:123], v[64:79]
    v_mfma_f32_32x32x16_bf16 v[80:95], v[236:239], v[124:127], v[80:95]
    v_mfma_f32_32x32x16_bf16 v[96:111], v[44:47], v[124:127], v[96:111]
    buffer_load_dwordx4 v[120:123], v4, s[32:35], s62 offen offset:1024 sc1
    buffer_load_dwordx4 v[124:127], v7, s[32:35], s62 offen offset:1024 sc1
    s_waitcnt vmcnt(11)
    v_or3_b32 v0, v128, v129, v130
    s_waitcnt vmcnt(10)
    v_or3_b32 v5, v132, v133, v134
    v_or3_b32 v0, v0, v131, v135
    v_or_b32 v0, v0, v5
    v_cmp_gt_i32 vcc, 0, v0
    s_cbranch_vccnz spin_99
spb_100:
    v_mfma_f32_32x32x16_bf16 v[48:63], v[144:147], v[128:131], v[48:63]
    v_mfma_f32_32x32x16_bf16 v[64:79], v[176:179], v[128:131], v[64:79]
    v_mfma_f32_32x32x16_bf16 v[80:95], v[144:147], v[132:135], v[80:95]
    v_mfma_f32_32x32x16_bf16 v[96:111], v[176:179], v[132:135], v[96:111]
    s_waitcnt vmcnt(9)
    v_or3_b32 v0, v136, v137, v138
    s_waitcnt vmcnt(8)
    v_or3_b32 v5, v140, v141, v142
    v_or3_b32 v0, v0, v139, v143
    v_or_b32 v0, v0, v5
    v_cmp_gt_i32 vcc, 0, v0
    s_cbranch_vccnz spin_101
spb_102:
    v_mfma_f32_32x32x16_bf16 v[48:63], v[148:151], v[136:139], v[48:63]
    v_mfma_f32_32x32x16_bf16 v[64:79], v[184:187], v[136:139], v[64:79]
    v_mfma_f32_32x32x16_bf16 v[80:95], v[148:151], v[140:143], v[80:95]
    v_mfma_f32_32x32x16_bf16 v[96:111], v[184:187], v[140:143], v[96:111]
    s_waitcnt vmcnt(7)
    v_or3_b32 v0, v168, v169, v170
    s_waitcnt vmcnt(6)
    v_or3_b32 v5, v172, v173, v174
    v_or3_b32 v0, v0, v171, v175
    v_or_b32 v0, v0, v5
    v_cmp_gt_i32 vcc, 0, v0
    s_cbranch_vccnz spin_103
spb_104:
    v_mfma_f32_32x32x16_bf16 v[48:63], v[152:155], v[168:171], v[48:63]
    v_mfma_f32_32x32x16_bf16 v[64:79], v[188:191], v[168:171], v[64:79]
    v_mfma_f32_32x32x16_bf16 v[80:95], v[152:155], v[172:175], v[80:95]
    v_mfma_f32_32x32x16_bf16 v[96:111], v[188:191], v[172:175], v[96:111]
    s_waitcnt vmcnt(5)
    v_or3_b32 v0, v212, v213, v214
    s_waitcnt vmcnt(4)
    v_or3_b32 v5, v220, v221, v222
    v_or3_b32 v0, v0, v215, v223
    v_or_b32 v0, v0, v5
    v_cmp_gt_i32 vcc, 0, v0
    s_cbranch_vccnz spin_105
spb_106:
    v_mfma_f32_32x32x16_bf16 v[48:63], v[156:159], v[212:215], v[48:63]
    v_mfma_f32_32x32x16_bf16 v[64:79], v[196:199], v[212:215], v[64:79]
    v_mfma_f32_32x32x16_bf16 v[80:95], v[156:159], v[220:223], v[80:95]
    v_mfma_f32_32x32x16_bf16 v[96:111], v[196:199], v[220:223], v[96:111]
    s_waitcnt vmcnt(3)
    v_or3_b32 v0, v112, v113, v114
    s_waitcnt vmcnt(2)
    v_or3_b32 v5, v116, v117, v118
    v_or3_b32 v0, v0, v115, v119
    v_or_b32 v0, v0, v5
    v_cmp_gt_i32 vcc, 0, v0
    s_cbranch_vccnz spin_107
spb_108:
    v_mfma_f32_32x32x16_bf16 v[48:63], v[160:163], v[112:115], v[48:63]
    v_mfma_f32_32x32x16_bf16 v[64:79], v[200:203], v[112:115], v[64:79]
    v_mfma_f32_32x32x16_bf16 v[80:95], v[160:163], v[116:119], v[80:95]
    v_mfma_f32_32x32x16_bf16 v[96:111], v[200:203], v[116:119], v[96:111]
    s_waitcnt vmcnt(1)
    v_or3_b32 v0, v120, v121, v122
    s_waitcnt vmcnt(0)
    v_or3_b32 v5, v124, v125, v126
    v_or3_b32 v0, v0, v123, v127
    v_or_b32 v0, v0, v5
    v_cmp_gt_i32 vcc, 0, v0
    s_cbranch_vccnz spin_109
spb_110:
    v_mfma_f32_32x32x16_bf16 v[48:63], v[164:167], v[120:123], v[48:63]
    v_mfma_f32_32x32x16_bf16 v[64:79], v[208:211], v[120:123], v[64:79]
    v_mfma_f32_32x32x16_bf16 v[80:95], v[164:167], v[124:127], v[80:95]
    v_mfma_f32_32x32x16_bf16 v[96:111], v[208:211], v[124:127], v[96:111]
    v_add_u32 v5, 0x10000, v10
    s_nop 7
    ds_write_b128 v10, v[48:51] offset:0
    ds_write_b128 v10, v[52:55] offset:1024
    ds_write_b128 v10, v[56:59] offset:16384
    ds_write_b128 v10, v[60:63] offset:17408
    ds_write_b128 v10, v[64:67] offset:32768
    ds_write_b128 v10, v[68:71] offset:33792
    ds_write_b128 v10, v[72:75] offset:49152
    ds_write_b128 v10, v[76:79] offset:50176
    ds_write_b128 v5, v[80:83] offset:0
    ds_write_b128 v5, v[84:87] offset:1024
    ds_write_b128 v5, v[88:91] offset:16384
    ds_write_b128 v5, v[92:95] offset:17408
    ds_write_b128 v5, v[96:99] offset:32768
    ds_write_b128 v5, v[100:103] offset:33792
    ds_write_b128 v5, v[104:107] offset:49152
    ds_write_b128 v5, v[108:111] offset:50176
    s_waitcnt lgkmcnt(0)
    s_barrier
    ds_read_b128 v[48:51], v11 offset:0
    ds_read_b128 v[52:55], v11 offset:1024
    ds_read_b128 v[56:59], v11 offset:2048
    ds_read_b128 v[60:63], v11 offset:3072
    ds_read_b128 v[64:67], v11 offset:4096
    ds_read_b128 v[68:71], v11 offset:5120
    ds_read_b128 v[72:75], v11 offset:6144
    ds_read_b128 v[76:79], v11 offset:7168
    ds_read_b128 v[80:83], v11 offset:8192
    ds_read_b128 v[84:87], v11 offset:9216
    ds_read_b128 v[88:91], v11 offset:10240
    ds_read_b128 v[92:95], v11 offset:11264
    ds_read_b128 v[96:99], v11 offset:12288
    ds_read_b128 v[100:103], v11 offset:13312
    ds_read_b128 v[104:107], v11 offset:14336
    ds_read_b128 v[108:111], v11 offset:15360
    s_waitcnt lgkmcnt(13)
    v_add_f32 v48, v48, v56
    v_add_f32 v49, v49, v57
    v_add_f32 v50, v50, v58
    v_add_f32 v51, v51, v59
    s_waitcnt lgkmcnt(12)
    v_add_f32 v52, v52, v60
    v_add_f32 v53, v53, v61
    v_add_f32 v54, v54, v62
    v_add_f32 v55, v55, v63
    s_waitcnt lgkmcnt(9)
    v_add_f32 v64, v64, v72
    v_add_f32 v65, v65, v73
    v_add_f32 v66, v66, v74
    v_add_f32 v67, v67, v75
    s_waitcnt lgkmcnt(8)
    v_add_f32 v68, v68, v76
    v_add_f32 v69, v69, v77
    v_add_f32 v70, v70, v78
    v_add_f32 v71, v71, v79
    v_add_f32 v48, v48, v64
    v_add_f32 v49, v49, v65
    v_add_f32 v50, v50, v66
    v_add_f32 v51, v51, v67
    v_add_f32 v52, v52, v68
    v_add_f32 v53, v53, v69
    v_add_f32 v54, v54, v70
    v_add_f32 v55, v55, v71
    s_waitcnt lgkmcnt(5)
    v_add_f32 v80, v80, v88
    v_add_f32 v81, v81, v89
    v_add_f32 v82, v82, v90
    v_add_f32 v83, v83, v91
    s_waitcnt lgkmcnt(4)
    v_add_f32 v84, v84, v92
    v_add_f32 v85, v85, v93
    v_add_f32 v86, v86, v94
    v_add_f32 v87, v87, v95
    s_waitcnt lgkmcnt(1)
    v_add_f32 v96, v96, v104
    v_add_f32 v97, v97, v105
    v_add_f32 v98, v98, v106
    v_add_f32 v99, v99, v107
    s_waitcnt lgkmcnt(0)
    v_add_f32 v100, v100, v108
    v_add_f32 v101, v101, v109
    v_add_f32 v102, v102, v110
    v_add_f32 v103, v103, v111
    v_add_f32 v80, v80, v96
    v_add_f32 v81, v81, v97
    v_add_f32 v82, v82, v98
    v_add_f32 v83, v83, v99
    v_add_f32 v84, v84, v100
    v_add_f32 v85, v85, v101
    v_add_f32 v86, v86, v102
    v_add_f32 v87, v87, v103
    v_add_f32 v48, v48, v80
    v_add_f32 v49, v49, v81
    v_add_f32 v50, v50, v82
    v_add_f32 v51, v51, v83
    v_add_f32 v52, v52, v84
    v_add_f32 v53, v53, v85
    v_add_f32 v54, v54, v86
    v_add_f32 v55, v55, v87
    v_fma_f32 v48, v48, v3, v244
    v_fma_f32 v49, v49, v3, v245
    v_fma_f32 v50, v50, v3, v246
    v_fma_f32 v51, v51, v3, v247
    v_fma_f32 v52, v52, v3, v248
    v_fma_f32 v53, v53, v3, v249
    v_fma_f32 v54, v54, v3, v250
    v_fma_f32 v55, v55, v3, v251
    v_cvt_pk_bf16_f32 v12, v48, v49
    v_cvt_pk_bf16_f32 v13, v50, v51
    v_cvt_pk_bf16_f32 v14, v52, v53
    v_cvt_pk_bf16_f32 v15, v54, v55
    s_nop 0
    v_permlane32_swap_b32 v12, v14
    v_permlane32_swap_b32 v13, v15
    buffer_store_dwordx4 v[12:15], v9, s[24:27], s55 offen
kfend_1:
    s_endpgm
vis_25:
    s_sub_u32 s75, s75, 2
    s_add_u32 s43, s43, 1
    s_lshl_b32 s48, s44, 13
    s_add_u32 s48, s48, 98304
    s_cmp_eq_u32 s43, 3
    s_cbranch_scc1 vs_111
    s_cmp_eq_u32 s43, 4
    s_cbranch_scc1 vs_112
    s_add_u32 m0, s48, 0
    s_nop 0
    buffer_load_dwordx4 v245, s[36:39], s72 offen lds
    s_add_u32 s72, s72, s61
    s_add_u32 m0, s48, 1024
    s_nop 0
    buffer_load_dwordx4 v245, s[36:39], s72 offen lds
    s_add_u32 s72, s72, s61
    s_add_u32 m0, s48, 2048
    s_nop 0
    buffer_load_dwordx4 v245, s[36:39], s72 offen lds
    s_add_u32 s72, s72, s61
    s_add_u32 m0, s48, 3072
    s_nop 0
    buffer_load_dwordx4 v245, s[36:39], s72 offen lds
    s_add_u32 s72, s72, s61
    s_branch vbk_26
vs_111:
    s_cmp_ge_u32 s44, 4
    s_cbranch_scc1 vbk_26
    v_add_u32 v252, s48, v243
    v_xor_b32 v253, 64, v252
    v_xor_b32 v254, 128, v252
    v_xor_b32 v255, 192, v252
    ds_read_b64_tr_b16 v[224:225], v252
    ds_read_b64_tr_b16 v[226:227], v252 offset:2048
    ds_read_b64_tr_b16 v[228:229], v253
    ds_read_b64_tr_b16 v[230:231], v253 offset:2048
    ds_read_b64_tr_b16 v[232:233], v254
    ds_read_b64_tr_b16 v[234:235], v254 offset:2048
    ds_read_b64_tr_b16 v[236:237], v255
    ds_read_b64_tr_b16 v[238:239], v255 offset:2048
    s_waitcnt lgkmcnt(0)
    buffer_store_dwordx4 v[224:227], v4, s[32:35], s100 offen sc1
    s_add_u32 s100, s100, s101
    buffer_store_dwordx4 v[228:231], v4, s[32:35], s100 offen sc1
    s_add_u32 s100, s100, s101
    buffer_store_dwordx4 v[232:235], v4, s[32:35], s100 offen sc1
    s_add_u32 s100, s100, s101
    buffer_store_dwordx4 v[236:239], v4, s[32:35], s100 offen sc1
    s_add_u32 s100, s100, s101
    s_branch vbk_26
vs_112:
    v_mov_b32 v247, 7
    buffer_store_dword v247, v240, s[32:35], s5 offen sc1
    buffer_store_byte v247, v246, s[8:11], 0 offen sc1
    s_mov_b32 s75, -1
    s_branch vbk_26
fb_27:
    s_nop 15
    v_max3_f32 v0, v128, v129, v130
    v_max3_f32 v0, v0, v131, v132
    v_max3_f32 v0, v0, v133, v134
    v_max3_f32 v0, v0, v135, v136
    v_max3_f32 v0, v0, v137, v138
    v_max3_f32 v0, v0, v139, v140
    v_max3_f32 v0, v0, v141, v142
    v_max_f32 v0, v0, v143
    v_mov_b32 v249, v0
    s_nop 1
    v_permlane32_swap_b32 v0, v249
    v_max_f32 v0, v0, v249
    v_max_f32 v0, 0, v0
    v_sub_f32 v160, v160, v0
    v_sub_f32 v161, v161, v0
    v_sub_f32 v162, v162, v0
    v_sub_f32 v163, v163, v0
    v_sub_f32 v164, v164, v0
    v_sub_f32 v165, v165, v0
    v_sub_f32 v166, v166, v0
    v_sub_f32 v167, v167, v0
    v_sub_f32 v168, v168, v0
    v_sub_f32 v169, v169, v0
    v_sub_f32 v170, v170, v0
    v_sub_f32 v171, v171, v0
    v_sub_f32 v172, v172, v0
    v_sub_f32 v173, v173, v0
    v_sub_f32 v174, v174, v0
    v_sub_f32 v175, v175, v0
    v_sub_f32 v128, v128, v0
    v_sub_f32 v129, v129, v0
    v_sub_f32 v130, v130, v0
    v_sub_f32 v131, v131, v0
    v_sub_f32 v132, v132, v0
    v_sub_f32 v133, v133, v0
    v_sub_f32 v134, v134, v0
    v_sub_f32 v135, v135, v0
    v_sub_f32 v136, v136, v0
    v_sub_f32 v137, v137, v0
    v_sub_f32 v138, v138, v0
    v_sub_f32 v139, v139, v0
    v_sub_f32 v140, v140, v0
    v_sub_f32 v141, v141, v0
    v_sub_f32 v142, v142, v0
    v_sub_f32 v143, v143, v0
    v_sub_f32 v112, v112, v0
    v_sub_f32 v113, v113, v0
    v_sub_f32 v114, v114, v0
    v_sub_f32 v115, v115, v0
    v_sub_f32 v116, v116, v0
    v_sub_f32 v117, v117, v0
    v_sub_f32 v118, v118, v0
    v_sub_f32 v119, v119, v0
    v_sub_f32 v120, v120, v0
    v_sub_f32 v121, v121, v0
    v_sub_f32 v122, v122, v0
    v_sub_f32 v123, v123, v0
    v_sub_f32 v124, v124, v0
    v_sub_f32 v125, v125, v0
    v_sub_f32 v126, v126, v0
    v_sub_f32 v127, v127, v0
    v_sub_f32 v0, 0, v0
    v_exp_f32 v0, v0
    s_nop 0
    v_mul_f32 v48, v48, v0
    v_mul_f32 v49, v49, v0
    v_mul_f32 v50, v50, v0
    v_mul_f32 v51, v51, v0
    v_mul_f32 v52, v52, v0
    v_mul_f32 v53, v53, v0
    v_mul_f32 v54, v54, v0
    v_mul_f32 v55, v55, v0
    v_mul_f32 v56, v56, v0
    v_mul_f32 v57, v57, v0
    v_mul_f32 v58, v58, v0
    v_mul_f32 v59, v59, v0
    v_mul_f32 v60, v60, v0
    v_mul_f32 v61, v61, v0
    v_mul_f32 v62, v62, v0
    v_mul_f32 v63, v63, v0
    v_mul_f32 v64, v64, v0
    v_mul_f32 v65, v65, v0
    v_mul_f32 v66, v66, v0
    v_mul_f32 v67, v67, v0
    v_mul_f32 v68, v68, v0
    v_mul_f32 v69, v69, v0
    v_mul_f32 v70, v70, v0
    v_mul_f32 v71, v71, v0
    v_mul_f32 v72, v72, v0
    v_mul_f32 v73, v73, v0
    v_mul_f32 v74, v74, v0
    v_mul_f32 v75, v75, v0
    v_mul_f32 v76, v76, v0
    v_mul_f32 v77, v77, v0
    v_mul_f32 v78, v78, v0
    v_mul_f32 v79, v79, v0
    v_mul_f32 v80, v80, v0
    v_mul_f32 v81, v81, v0
    v_mul_f32 v82, v82, v0
    v_mul_f32 v83, v83, v0
    v_mul_f32 v84, v84, v0
    v_mul_f32 v85, v85, v0
    v_mul_f32 v86, v86, v0
    v_mul_f32 v87, v87, v0
    v_mul_f32 v88, v88, v0
    v_mul_f32 v89, v89, v0
    v_mul_f32 v90, v90, v0
    v_mul_f32 v91, v91, v0
    v_mul_f32 v92, v92, v0
    v_mul_f32 v93, v93, v0
    v_mul_f32 v94, v94, v0
    v_mul_f32 v95, v95, v0
    v_mul_f32 v96, v96, v0
    v_mul_f32 v97, v97, v0
    v_mul_f32 v98, v98, v0
    v_mul_f32 v99, v99, v0
    v_mul_f32 v100, v100, v0
    v_mul_f32 v101, v101, v0
    v_mul_f32 v102, v102, v0
    v_mul_f32 v103, v103, v0
    v_mul_f32 v104, v104, v0
    v_mul_f32 v105, v105, v0
    v_mul_f32 v106, v106, v0
    v_mul_f32 v107, v107, v0
    v_mul_f32 v108, v108, v0
    v_mul_f32 v109, v109, v0
    v_mul_f32 v110, v110, v0
    v_mul_f32 v111, v111, v0
    v_mul_f32 v7, v7, v0
    v_exp_f32 v10, v128
    v_exp_f32 v11, v129
    v_add_f32 v8, v7, v10
    v_exp_f32 v12, v130
    v_add_f32 v8, v8, v11
    v_cvt_pk_bf16_f32 v152, v10, v11
    v_exp_f32 v13, v131
    v_add_f32 v8, v8, v12
    v_exp_f32 v10, v132
    v_add_f32 v8, v8, v13
    v_cvt_pk_bf16_f32 v153, v12, v13
    v_exp_f32 v11, v133
    v_add_f32 v8, v8, v10
    v_exp_f32 v12, v134
    v_add_f32 v8, v8, v11
    v_cvt_pk_bf16_f32 v154, v10, v11
    v_exp_f32 v13, v135
    v_add_f32 v8, v8, v12
    v_exp_f32 v10, v136
    v_add_f32 v8, v8, v13
    v_cvt_pk_bf16_f32 v155, v12, v13
    v_exp_f32 v11, v137
    v_add_f32 v8, v8, v10
    v_exp_f32 v12, v138
    v_add_f32 v8, v8, v11
    v_cvt_pk_bf16_f32 v156, v10, v11
    v_exp_f32 v13, v139
    v_add_f32 v8, v8, v12
    v_exp_f32 v10, v140
    v_add_f32 v8, v8, v13
    v_cvt_pk_bf16_f32 v157, v12, v13
    v_exp_f32 v11, v141
    v_add_f32 v8, v8, v10
    v_exp_f32 v12, v142
    v_add_f32 v8, v8, v11
    v_cvt_pk_bf16_f32 v158, v10, v11
    v_exp_f32 v13, v143
    v_add_f32 v8, v8, v12
    v_add_f32 v8, v8, v13
    v_cvt_pk_bf16_f32 v159, v12, v13
    s_nop 3
    s_branch fbr_28
fb_29:
    s_nop 15
    v_max3_f32 v0, v112, v113, v114
    v_max3_f32 v0, v0, v115, v116
    v_max3_f32 v0, v0, v117, v118
    v_max3_f32 v0, v0, v119, v120
    v_max3_f32 v0, v0, v121, v122
    v_max3_f32 v0, v0, v123, v124
    v_max3_f32 v0, v0, v125, v126
    v_max_f32 v0, v0, v127
    v_mov_b32 v249, v0
    s_nop 1
    v_permlane32_swap_b32 v0, v249
    v_max_f32 v0, v0, v249
    v_max_f32 v0, 0, v0
    v_sub_f32 v160, v160, v0
    v_sub_f32 v161, v161, v0
    v_sub_f32 v162, v162, v0
    v_sub_f32 v163, v163, v0
    v_sub_f32 v164, v164, v0
    v_sub_f32 v165, v165, v0
    v_sub_f32 v166, v166, v0
    v_sub_f32 v167, v167, v0
    v_sub_f32 v168, v168, v0
    v_sub_f32 v169, v169, v0
    v_sub_f32 v170, v170, v0
    v_sub_f32 v171, v171, v0
    v_sub_f32 v172, v172, v0
    v_sub_f32 v173, v173, v0
    v_sub_f32 v174, v174, v0
    v_sub_f32 v175, v175, v0
    v_sub_f32 v112, v112, v0
    v_sub_f32 v113, v113, v0
    v_sub_f32 v114, v114, v0
    v_sub_f32 v115, v115, v0
    v_sub_f32 v116, v116, v0
    v_sub_f32 v117, v117, v0
    v_sub_f32 v118, v118, v0
    v_sub_f32 v119, v119, v0
    v_sub_f32 v120, v120, v0
    v_sub_f32 v121, v121, v0
    v_sub_f32 v122, v122, v0
    v_sub_f32 v123, v123, v0
    v_sub_f32 v124, v124, v0
    v_sub_f32 v125, v125, v0
    v_sub_f32 v126, v126, v0
    v_sub_f32 v127, v127, v0
    v_sub_f32 v128, v128, v0
    v_sub_f32 v129, v129, v0
    v_sub_f32 v130, v130, v0
    v_sub_f32 v131, v131, v0
    v_sub_f32 v132, v132, v0
    v_sub_f32 v133, v133, v0
    v_sub_f32 v134, v134, v0
    v_sub_f32 v135, v135, v0
    v_sub_f32 v136, v136, v0
    v_sub_f32 v137, v137, v0
    v_sub_f32 v138, v138, v0
    v_sub_f32 v139, v139, v0
    v_sub_f32 v140, v140, v0
    v_sub_f32 v141, v141, v0
    v_sub_f32 v142, v142, v0
    v_sub_f32 v143, v143, v0
    v_sub_f32 v0, 0, v0
    v_exp_f32 v0, v0
    s_nop 0
    v_mul_f32 v48, v48, v0
    v_mul_f32 v49, v49, v0
    v_mul_f32 v50, v50, v0
    v_mul_f32 v51, v51, v0
    v_mul_f32 v52, v52, v0
    v_mul_f32 v53, v53, v0
    v_mul_f32 v54, v54, v0
    v_mul_f32 v55, v55, v0
    v_mul_f32 v56, v56, v0
    v_mul_f32 v57, v57, v0
    v_mul_f32 v58, v58, v0
    v_mul_f32 v59, v59, v0
    v_mul_f32 v60, v60, v0
    v_mul_f32 v61, v61, v0
    v_mul_f32 v62, v62, v0
    v_mul_f32 v63, v63, v0
    v_mul_f32 v64, v64, v0
    v_mul_f32 v65, v65, v0
    v_mul_f32 v66, v66, v0
    v_mul_f32 v67, v67, v0
    v_mul_f32 v68, v68, v0
    v_mul_f32 v69, v69, v0
    v_mul_f32 v70, v70, v0
    v_mul_f32 v71, v71, v0
    v_mul_f32 v72, v72, v0
    v_mul_f32 v73, v73, v0
    v_mul_f32 v74, v74, v0
    v_mul_f32 v75, v75, v0
    v_mul_f32 v76, v76, v0
    v_mul_f32 v77, v77, v0
    v_mul_f32 v78, v78, v0
    v_mul_f32 v79, v79, v0
    v_mul_f32 v80, v80, v0
    v_mul_f32 v81, v81, v0
    v_mul_f32 v82, v82, v0
    v_mul_f32 v83, v83, v0
    v_mul_f32 v84, v84, v0
    v_mul_f32 v85, v85, v0
    v_mul_f32 v86, v86, v0
    v_mul_f32 v87, v87, v0
    v_mul_f32 v88, v88, v0
    v_mul_f32 v89, v89, v0
    v_mul_f32 v90, v90, v0
    v_mul_f32 v91, v91, v0
    v_mul_f32 v92, v92, v0
    v_mul_f32 v93, v93, v0
    v_mul_f32 v94, v94, v0
    v_mul_f32 v95, v95, v0
    v_mul_f32 v96, v96, v0
    v_mul_f32 v97, v97, v0
    v_mul_f32 v98, v98, v0
    v_mul_f32 v99, v99, v0
    v_mul_f32 v100, v100, v0
    v_mul_f32 v101, v101, v0
    v_mul_f32 v102, v102, v0
    v_mul_f32 v103, v103, v0
    v_mul_f32 v104, v104, v0
    v_mul_f32 v105, v105, v0
    v_mul_f32 v106, v106, v0
    v_mul_f32 v107, v107, v0
    v_mul_f32 v108, v108, v0
    v_mul_f32 v109, v109, v0
    v_mul_f32 v110, v110, v0
    v_mul_f32 v111, v111, v0
    v_mul_f32 v8, v8, v0
    v_exp_f32 v10, v112
    v_exp_f32 v11, v113
    v_add_f32 v7, v8, v10
    v_exp_f32 v12, v114
    v_add_f32 v7, v7, v11
    v_cvt_pk_bf16_f32 v144, v10, v11
    v_exp_f32 v13, v115
    v_add_f32 v7, v7, v12
    v_exp_f32 v10, v116
    v_add_f32 v7, v7, v13
    v_cvt_pk_bf16_f32 v145, v12, v13
    v_exp_f32 v11, v117
    v_add_f32 v7, v7, v10
    v_exp_f32 v12, v118
    v_add_f32 v7, v7, v11
    v_cvt_pk_bf16_f32 v146, v10, v11
    v_exp_f32 v13, v119
    v_add_f32 v7, v7, v12
    v_exp_f32 v10, v120
    v_add_f32 v7, v7, v13
    v_cvt_pk_bf16_f32 v147, v12, v13
    v_exp_f32 v11, v121
    v_add_f32 v7, v7, v10
    v_exp_f32 v12, v122
    v_add_f32 v7, v7, v11
    v_cvt_pk_bf16_f32 v148, v10, v11
    v_exp_f32 v13, v123
    v_add_f32 v7, v7, v12
    v_exp_f32 v10, v124
    v_add_f32 v7, v7, v13
    v_cvt_pk_bf16_f32 v149, v12, v13
    v_exp_f32 v11, v125
    v_add_f32 v7, v7, v10
    v_exp_f32 v12, v126
    v_add_f32 v7, v7, v11
    v_cvt_pk_bf16_f32 v150, v10, v11
    v_exp_f32 v13, v127
    v_add_f32 v7, v7, v12
    v_add_f32 v7, v7, v13
    v_cvt_pk_bf16_f32 v151, v12, v13
    s_nop 3
    s_branch fbr_30
fb_39:
    s_nop 15
    v_max3_f32 v0, v112, v113, v114
    v_max3_f32 v0, v0, v115, v116
    v_max3_f32 v0, v0, v117, v118
    v_max3_f32 v0, v0, v119, v120
    v_max3_f32 v0, v0, v121, v122
    v_max3_f32 v0, v0, v123, v124
    v_max3_f32 v0, v0, v125, v126
    v_max_f32 v0, v0, v127
    v_mov_b32 v249, v0
    s_nop 1
    v_permlane32_swap_b32 v0, v249
    v_max_f32 v0, v0, v249
    v_max_f32 v0, 0, v0
    v_sub_f32 v160, v160, v0
    v_sub_f32 v161, v161, v0
    v_sub_f32 v162, v162, v0
    v_sub_f32 v163, v163, v0
    v_sub_f32 v164, v164, v0
    v_sub_f32 v165, v165, v0
    v_sub_f32 v166, v166, v0
    v_sub_f32 v167, v167, v0
    v_sub_f32 v168, v168, v0
    v_sub_f32 v169, v169, v0
    v_sub_f32 v170, v170, v0
    v_sub_f32 v171, v171, v0
    v_sub_f32 v172, v172, v0
    v_sub_f32 v173, v173, v0
    v_sub_f32 v174, v174, v0
    v_sub_f32 v175, v175, v0
    v_sub_f32 v112, v112, v0
    v_sub_f32 v113, v113, v0
    v_sub_f32 v114, v114, v0
    v_sub_f32 v115, v115, v0
    v_sub_f32 v116, v116, v0
    v_sub_f32 v117, v117, v0
    v_sub_f32 v118, v118, v0
    v_sub_f32 v119, v119, v0
    v_sub_f32 v120, v120, v0
    v_sub_f32 v121, v121, v0
    v_sub_f32 v122, v122, v0
    v_sub_f32 v123, v123, v0
    v_sub_f32 v124, v124, v0
    v_sub_f32 v125, v125, v0
    v_sub_f32 v126, v126, v0
    v_sub_f32 v127, v127, v0
    v_sub_f32 v128, v128, v0
    v_sub_f32 v129, v129, v0
    v_sub_f32 v130, v130, v0
    v_sub_f32 v131, v131, v0
    v_sub_f32 v132, v132, v0
    v_sub_f32 v133, v133, v0
    v_sub_f32 v134, v134, v0
    v_sub_f32 v135, v135, v0
    v_sub_f32 v136, v136, v0
    v_sub_f32 v137, v137, v0
    v_sub_f32 v138, v138, v0
    v_sub_f32 v139, v139, v0
    v_sub_f32 v140, v140, v0
    v_sub_f32 v141, v141, v0
    v_sub_f32 v142, v142, v0
    v_sub_f32 v143, v143, v0
    v_sub_f32 v0, 0, v0
    v_exp_f32 v0, v0
    s_nop 0
    v_mul_f32 v48, v48, v0
    v_mul_f32 v49, v49, v0
    v_mul_f32 v50, v50, v0
    v_mul_f32 v51, v51, v0
    v_mul_f32 v52, v52, v0
    v_mul_f32 v53, v53, v0
    v_mul_f32 v54, v54, v0
    v_mul_f32 v55, v55, v0
    v_mul_f32 v56, v56, v0
    v_mul_f32 v57, v57, v0
    v_mul_f32 v58, v58, v0
    v_mul_f32 v59, v59, v0
    v_mul_f32 v60, v60, v0
    v_mul_f32 v61, v61, v0
    v_mul_f32 v62, v62, v0
    v_mul_f32 v63, v63, v0
    v_mul_f32 v64, v64, v0
    v_mul_f32 v65, v65, v0
    v_mul_f32 v66, v66, v0
    v_mul_f32 v67, v67, v0
    v_mul_f32 v68, v68, v0
    v_mul_f32 v69, v69, v0
    v_mul_f32 v70, v70, v0
    v_mul_f32 v71, v71, v0
    v_mul_f32 v72, v72, v0
    v_mul_f32 v73, v73, v0
    v_mul_f32 v74, v74, v0
    v_mul_f32 v75, v75, v0
    v_mul_f32 v76, v76, v0
    v_mul_f32 v77, v77, v0
    v_mul_f32 v78, v78, v0
    v_mul_f32 v79, v79, v0
    v_mul_f32 v80, v80, v0
    v_mul_f32 v81, v81, v0
    v_mul_f32 v82, v82, v0
    v_mul_f32 v83, v83, v0
    v_mul_f32 v84, v84, v0
    v_mul_f32 v85, v85, v0
    v_mul_f32 v86, v86, v0
    v_mul_f32 v87, v87, v0
    v_mul_f32 v88, v88, v0
    v_mul_f32 v89, v89, v0
    v_mul_f32 v90, v90, v0
    v_mul_f32 v91, v91, v0
    v_mul_f32 v92, v92, v0
    v_mul_f32 v93, v93, v0
    v_mul_f32 v94, v94, v0
    v_mul_f32 v95, v95, v0
    v_mul_f32 v96, v96, v0
    v_mul_f32 v97, v97, v0
    v_mul_f32 v98, v98, v0
    v_mul_f32 v99, v99, v0
    v_mul_f32 v100, v100, v0
    v_mul_f32 v101, v101, v0
    v_mul_f32 v102, v102, v0
    v_mul_f32 v103, v103, v0
    v_mul_f32 v104, v104, v0
    v_mul_f32 v105, v105, v0
    v_mul_f32 v106, v106, v0
    v_mul_f32 v107, v107, v0
    v_mul_f32 v108, v108, v0
    v_mul_f32 v109, v109, v0
    v_mul_f32 v110, v110, v0
    v_mul_f32 v111, v111, v0
    v_mul_f32 v8, v8, v0
    v_exp_f32 v10, v112
    v_exp_f32 v11, v113
    v_add_f32 v7, v8, v10
    v_exp_f32 v12, v114
    v_add_f32 v7, v7, v11
    v_cvt_pk_bf16_f32 v144, v10, v11
    v_exp_f32 v13, v115
    v_add_f32 v7, v7, v12
    v_exp_f32 v10, v116
    v_add_f32 v7, v7, v13
    v_cvt_pk_bf16_f32 v145, v12, v13
    v_exp_f32 v11, v117
    v_add_f32 v7, v7, v10
    v_exp_f32 v12, v118
    v_add_f32 v7, v7, v11
    v_cvt_pk_bf16_f32 v146, v10, v11
    v_exp_f32 v13, v119
    v_add_f32 v7, v7, v12
    v_exp_f32 v10, v120
    v_add_f32 v7, v7, v13
    v_cvt_pk_bf16_f32 v147, v12, v13
    v_exp_f32 v11, v121
    v_add_f32 v7, v7, v10
    v_exp_f32 v12, v122
    v_add_f32 v7, v7, v11
    v_cvt_pk_bf16_f32 v148, v10, v11
    v_exp_f32 v13, v123
    v_add_f32 v7, v7, v12
    v_exp_f32 v10, v124
    v_add_f32 v7, v7, v13
    v_cvt_pk_bf16_f32 v149, v12, v13
    v_exp_f32 v11, v125
    v_add_f32 v7, v7, v10
    v_exp_f32 v12, v126
    v_add_f32 v7, v7, v11
    v_cvt_pk_bf16_f32 v150, v10, v11
    v_exp_f32 v13, v127
    v_add_f32 v7, v7, v12
    v_add_f32 v7, v7, v13
    v_cvt_pk_bf16_f32 v151, v12, v13
    s_nop 3
    s_branch fbr_40
fb_42:
    s_nop 15
    v_max3_f32 v0, v128, v129, v130
    v_max3_f32 v0, v0, v131, v132
    v_max3_f32 v0, v0, v133, v134
    v_max3_f32 v0, v0, v135, v136
    v_max3_f32 v0, v0, v137, v138
    v_max3_f32 v0, v0, v139, v140
    v_max3_f32 v0, v0, v141, v142
    v_max_f32 v0, v0, v143
    v_mov_b32 v249, v0
    s_nop 1
    v_permlane32_swap_b32 v0, v249
    v_max_f32 v0, v0, v249
    v_max_f32 v0, 0, v0
    v_sub_f32 v160, v160, v0
    v_sub_f32 v161, v161, v0
    v_sub_f32 v162, v162, v0
    v_sub_f32 v163, v163, v0
    v_sub_f32 v164, v164, v0
    v_sub_f32 v165, v165, v0
    v_sub_f32 v166, v166, v0
    v_sub_f32 v167, v167, v0
    v_sub_f32 v168, v168, v0
    v_sub_f32 v169, v169, v0
    v_sub_f32 v170, v170, v0
    v_sub_f32 v171, v171, v0
    v_sub_f32 v172, v172, v0
    v_sub_f32 v173, v173, v0
    v_sub_f32 v174, v174, v0
    v_sub_f32 v175, v175, v0
    v_sub_f32 v128, v128, v0
    v_sub_f32 v129, v129, v0
    v_sub_f32 v130, v130, v0
    v_sub_f32 v131, v131, v0
    v_sub_f32 v132, v132, v0
    v_sub_f32 v133, v133, v0
    v_sub_f32 v134, v134, v0
    v_sub_f32 v135, v135, v0
    v_sub_f32 v136, v136, v0
    v_sub_f32 v137, v137, v0
    v_sub_f32 v138, v138, v0
    v_sub_f32 v139, v139, v0
    v_sub_f32 v140, v140, v0
    v_sub_f32 v141, v141, v0
    v_sub_f32 v142, v142, v0
    v_sub_f32 v143, v143, v0
    v_sub_f32 v0, 0, v0
    v_exp_f32 v0, v0
    s_nop 0
    v_mul_f32 v48, v48, v0
    v_mul_f32 v49, v49, v0
    v_mul_f32 v50, v50, v0
    v_mul_f32 v51, v51, v0
    v_mul_f32 v52, v52, v0
    v_mul_f32 v53, v53, v0
    v_mul_f32 v54, v54, v0
    v_mul_f32 v55, v55, v0
    v_mul_f32 v56, v56, v0
    v_mul_f32 v57, v57, v0
    v_mul_f32 v58, v58, v0
    v_mul_f32 v59, v59, v0
    v_mul_f32 v60, v60, v0
    v_mul_f32 v61, v61, v0
    v_mul_f32 v62, v62, v0
    v_mul_f32 v63, v63, v0
    v_mul_f32 v64, v64, v0
    v_mul_f32 v65, v65, v0
    v_mul_f32 v66, v66, v0
    v_mul_f32 v67, v67, v0
    v_mul_f32 v68, v68, v0
    v_mul_f32 v69, v69, v0
    v_mul_f32 v70, v70, v0
    v_mul_f32 v71, v71, v0
    v_mul_f32 v72, v72, v0
    v_mul_f32 v73, v73, v0
    v_mul_f32 v74, v74, v0
    v_mul_f32 v75, v75, v0
    v_mul_f32 v76, v76, v0
    v_mul_f32 v77, v77, v0
    v_mul_f32 v78, v78, v0
    v_mul_f32 v79, v79, v0
    v_mul_f32 v80, v80, v0
    v_mul_f32 v81, v81, v0
    v_mul_f32 v82, v82, v0
    v_mul_f32 v83, v83, v0
    v_mul_f32 v84, v84, v0
    v_mul_f32 v85, v85, v0
    v_mul_f32 v86, v86, v0
    v_mul_f32 v87, v87, v0
    v_mul_f32 v88, v88, v0
    v_mul_f32 v89, v89, v0
    v_mul_f32 v90, v90, v0
    v_mul_f32 v91, v91, v0
    v_mul_f32 v92, v92, v0
    v_mul_f32 v93, v93, v0
    v_mul_f32 v94, v94, v0
    v_mul_f32 v95, v95, v0
    v_mul_f32 v96, v96, v0
    v_mul_f32 v97, v97, v0
    v_mul_f32 v98, v98, v0
    v_mul_f32 v99, v99, v0
    v_mul_f32 v100, v100, v0
    v_mul_f32 v101, v101, v0
    v_mul_f32 v102, v102, v0
    v_mul_f32 v103, v103, v0
    v_mul_f32 v104, v104, v0
    v_mul_f32 v105, v105, v0
    v_mul_f32 v106, v106, v0
    v_mul_f32 v107, v107, v0
    v_mul_f32 v108, v108, v0
    v_mul_f32 v109, v109, v0
    v_mul_f32 v110, v110, v0
    v_mul_f32 v111, v111, v0
    v_mul_f32 v7, v7, v0
    v_exp_f32 v10, v128
    v_exp_f32 v11, v129
    v_add_f32 v8, v7, v10
    v_exp_f32 v12, v130
    v_add_f32 v8, v8, v11
    v_cvt_pk_bf16_f32 v152, v10, v11
    v_exp_f32 v13, v131
    v_add_f32 v8, v8, v12
    v_exp_f32 v10, v132
    v_add_f32 v8, v8, v13
    v_cvt_pk_bf16_f32 v153, v12, v13
    v_exp_f32 v11, v133
    v_add_f32 v8, v8, v10
    v_exp_f32 v12, v134
    v_add_f32 v8, v8, v11
    v_cvt_pk_bf16_f32 v154, v10, v11
    v_exp_f32 v13, v135
    v_add_f32 v8, v8, v12
    v_exp_f32 v10, v136
    v_add_f32 v8, v8, v13
    v_cvt_pk_bf16_f32 v155, v12, v13
    v_exp_f32 v11, v137
    v_add_f32 v8, v8, v10
    v_exp_f32 v12, v138
    v_add_f32 v8, v8, v11
    v_cvt_pk_bf16_f32 v156, v10, v11
    v_exp_f32 v13, v139
    v_add_f32 v8, v8, v12
    v_exp_f32 v10, v140
    v_add_f32 v8, v8, v13
    v_cvt_pk_bf16_f32 v157, v12, v13
    v_exp_f32 v11, v141
    v_add_f32 v8, v8, v10
    v_exp_f32 v12, v142
    v_add_f32 v8, v8, v11
    v_cvt_pk_bf16_f32 v158, v10, v11
    v_exp_f32 v13, v143
    v_add_f32 v8, v8, v12
    v_add_f32 v8, v8, v13
    v_cvt_pk_bf16_f32 v159, v12, v13
    s_nop 3
    s_branch fbr_43
fb_55:
    s_nop 15
    v_max3_f32 v0, v128, v129, v130
    v_max3_f32 v0, v0, v131, v132
    v_max3_f32 v0, v0, v133, v134
    v_max3_f32 v0, v0, v135, v136
    v_max3_f32 v0, v0, v137, v138
    v_max3_f32 v0, v0, v139, v140
    v_max3_f32 v0, v0, v141, v142
    v_max_f32 v0, v0, v143
    v_mov_b32 v249, v0
    s_nop 1
    v_permlane32_swap_b32 v0, v249
    v_max_f32 v0, v0, v249
    v_max_f32 v0, 0, v0
    v_sub_f32 v160, v160, v0
    v_sub_f32 v161, v161, v0
    v_sub_f32 v162, v162, v0
    v_sub_f32 v163, v163, v0
    v_sub_f32 v164, v164, v0
    v_sub_f32 v165, v165, v0
    v_sub_f32 v166, v166, v0
    v_sub_f32 v167, v167, v0
    v_sub_f32 v168, v168, v0
    v_sub_f32 v169, v169, v0
    v_sub_f32 v170, v170, v0
    v_sub_f32 v171, v171, v0
    v_sub_f32 v172, v172, v0
    v_sub_f32 v173, v173, v0
    v_sub_f32 v174, v174, v0
    v_sub_f32 v175, v175, v0
    v_sub_f32 v128, v128, v0
    v_sub_f32 v129, v129, v0
    v_sub_f32 v130, v130, v0
    v_sub_f32 v131, v131, v0
    v_sub_f32 v132, v132, v0
    v_sub_f32 v133, v133, v0
    v_sub_f32 v134, v134, v0
    v_sub_f32 v135, v135, v0
    v_sub_f32 v136, v136, v0
    v_sub_f32 v137, v137, v0
    v_sub_f32 v138, v138, v0
    v_sub_f32 v139, v139, v0
    v_sub_f32 v140, v140, v0
    v_sub_f32 v141, v141, v0
    v_sub_f32 v142, v142, v0
    v_sub_f32 v143, v143, v0
    v_sub_f32 v0, 0, v0
    v_exp_f32 v0, v0
    s_nop 0
    v_mul_f32 v48, v48, v0
    v_mul_f32 v49, v49, v0
    v_mul_f32 v50, v50, v0
    v_mul_f32 v51, v51, v0
    v_mul_f32 v52, v52, v0
    v_mul_f32 v53, v53, v0
    v_mul_f32 v54, v54, v0
    v_mul_f32 v55, v55, v0
    v_mul_f32 v56, v56, v0
    v_mul_f32 v57, v57, v0
    v_mul_f32 v58, v58, v0
    v_mul_f32 v59, v59, v0
    v_mul_f32 v60, v60, v0
    v_mul_f32 v61, v61, v0
    v_mul_f32 v62, v62, v0
    v_mul_f32 v63, v63, v0
    v_mul_f32 v64, v64, v0
    v_mul_f32 v65, v65, v0
    v_mul_f32 v66, v66, v0
    v_mul_f32 v67, v67, v0
    v_mul_f32 v68, v68, v0
    v_mul_f32 v69, v69, v0
    v_mul_f32 v70, v70, v0
    v_mul_f32 v71, v71, v0
    v_mul_f32 v72, v72, v0
    v_mul_f32 v73, v73, v0
    v_mul_f32 v74, v74, v0
    v_mul_f32 v75, v75, v0
    v_mul_f32 v76, v76, v0
    v_mul_f32 v77, v77, v0
    v_mul_f32 v78, v78, v0
    v_mul_f32 v79, v79, v0
    v_mul_f32 v80, v80, v0
    v_mul_f32 v81, v81, v0
    v_mul_f32 v82, v82, v0
    v_mul_f32 v83, v83, v0
    v_mul_f32 v84, v84, v0
    v_mul_f32 v85, v85, v0
    v_mul_f32 v86, v86, v0
    v_mul_f32 v87, v87, v0
    v_mul_f32 v88, v88, v0
    v_mul_f32 v89, v89, v0
    v_mul_f32 v90, v90, v0
    v_mul_f32 v91, v91, v0
    v_mul_f32 v92, v92, v0
    v_mul_f32 v93, v93, v0
    v_mul_f32 v94, v94, v0
    v_mul_f32 v95, v95, v0
    v_mul_f32 v96, v96, v0
    v_mul_f32 v97, v97, v0
    v_mul_f32 v98, v98, v0
    v_mul_f32 v99, v99, v0
    v_mul_f32 v100, v100, v0
    v_mul_f32 v101, v101, v0
    v_mul_f32 v102, v102, v0
    v_mul_f32 v103, v103, v0
    v_mul_f32 v104, v104, v0
    v_mul_f32 v105, v105, v0
    v_mul_f32 v106, v106, v0
    v_mul_f32 v107, v107, v0
    v_mul_f32 v108, v108, v0
    v_mul_f32 v109, v109, v0
    v_mul_f32 v110, v110, v0
    v_mul_f32 v111, v111, v0
    v_mul_f32 v7, v7, v0
    v_exp_f32 v10, v128
    v_exp_f32 v11, v129
    v_add_f32 v8, v7, v10
    v_exp_f32 v12, v130
    v_add_f32 v8, v8, v11
    v_cvt_pk_bf16_f32 v152, v10, v11
    v_exp_f32 v13, v131
    v_add_f32 v8, v8, v12
    v_exp_f32 v10, v132
    v_add_f32 v8, v8, v13
    v_cvt_pk_bf16_f32 v153, v12, v13
    v_exp_f32 v11, v133
    v_add_f32 v8, v8, v10
    v_exp_f32 v12, v134
    v_add_f32 v8, v8, v11
    v_cvt_pk_bf16_f32 v154, v10, v11
    v_exp_f32 v13, v135
    v_add_f32 v8, v8, v12
    v_exp_f32 v10, v136
    v_add_f32 v8, v8, v13
    v_cvt_pk_bf16_f32 v155, v12, v13
    v_exp_f32 v11, v137
    v_add_f32 v8, v8, v10
    v_exp_f32 v12, v138
    v_add_f32 v8, v8, v11
    v_cvt_pk_bf16_f32 v156, v10, v11
    v_exp_f32 v13, v139
    v_add_f32 v8, v8, v12
    v_exp_f32 v10, v140
    v_add_f32 v8, v8, v13
    v_cvt_pk_bf16_f32 v157, v12, v13
    v_exp_f32 v11, v141
    v_add_f32 v8, v8, v10
    v_exp_f32 v12, v142
    v_add_f32 v8, v8, v11
    v_cvt_pk_bf16_f32 v158, v10, v11
    v_exp_f32 v13, v143
    v_add_f32 v8, v8, v12
    v_add_f32 v8, v8, v13
    v_cvt_pk_bf16_f32 v159, v12, v13
    s_nop 3
    s_branch fbr_56
spin_10:
    s_mov_b32 s48, 0x10000
sl_113:
    s_sleep 4
    buffer_load_dword v124, v18, s[8:11], 0 offen sc1
    s_waitcnt vmcnt(0)
    v_and_b32 v124, v124, v19
    v_cmp_ne_u32 vcc, v124, v19
    s_sub_u32 s48, s48, 1
    s_cmp_eq_u32 s48, 0
    s_cbranch_scc1 spb_11
    s_cbranch_vccnz sl_113
    s_branch spb_11
spin_12:
    s_mov_b32 s48, 0x10000
sl_114:
    s_sleep 4
    buffer_load_dword v13, v18, s[32:35], s16 offen sc1
    s_waitcnt vmcnt(0)
    v_and_b32 v13, v13, v12
    v_cmp_ne_u32 vcc, v13, v12
    s_sub_u32 s48, s48, 1
    s_cmp_eq_u32 s48, 0
    s_cbranch_scc1 spb_13
    s_cbranch_vccnz sl_114
    s_branch spb_13
spin_14:
    s_mov_b32 s48, 0x10000
sl_115:
    s_sleep 4
    buffer_load_dword v124, v18, s[8:11], 0 offen sc1
    s_waitcnt vmcnt(0)
    v_and_b32 v124, v124, v19
    v_cmp_ne_u32 vcc, v124, v19
    s_sub_u32 s48, s48, 1
    s_cmp_eq_u32 s48, 0
    s_cbranch_scc1 spb_15
    s_cbranch_vccnz sl_115
    s_branch spb_15
spin_16:
    s_mov_b32 s48, 0x10000
sl_116:
    s_sleep 4
    buffer_load_dword v13, v18, s[32:35], s16 offen sc1
    s_waitcnt vmcnt(0)
    v_and_b32 v13, v13, v12
    v_cmp_ne_u32 vcc, v13, v12
    s_sub_u32 s48, s48, 1
    s_cmp_eq_u32 s48, 0
    s_cbranch_scc1 spb_17
    s_cbranch_vccnz sl_116
    s_branch spb_17
spin_20:
    s_mov_b32 s48, 0x10000
sl_117:
    s_sleep 4
    buffer_load_dword v13, v10, s[32:35], s16 offen sc1
    s_waitcnt vmcnt(0)
    v_and_b32 v13, v13, v12
    v_cmp_ne_u32 vcc, v13, v12
    s_sub_u32 s48, s48, 1
    s_cmp_eq_u32 s48, 0
    s_cbranch_scc1 spb_21
    s_cbranch_vccnz sl_117
    s_branch spb_21
spin_65:
    s_mov_b32 s48, 0x10000
sl_118:
    s_sleep 4
    buffer_load_dword v247, v241, s[32:35], s4 offen sc1
    s_waitcnt vmcnt(0)
    v_and_b32 v247, 4, v247
    v_cmp_ne_u32 vcc, 4, v247
    s_sub_u32 s48, s48, 1
    s_cmp_eq_u32 s48, 0
    s_cbranch_scc1 spb_66
    s_cbranch_vccnz sl_118
    s_branch spb_66
spin_67:
    s_mov_b32 s48, 0x10000
sl_119:
    s_sleep 4
    buffer_load_dword v245, v244, s[8:11], 0 offen sc1
    s_waitcnt vmcnt(0)
    v_and_b32 v245, s60, v245
    v_cmp_ne_u32 vcc, s60, v245
    s_sub_u32 s48, s48, 1
    s_cmp_eq_u32 s48, 0
    s_cbranch_scc1 spb_68
    s_cbranch_vccnz sl_119
    s_branch spb_68
spin_83:
    s_mov_b32 s48, 0x10000
sl_120:
    s_add_u32 s49, s63, 0
    buffer_load_dwordx4 v[112:115], v4, s[32:35], s49 offen offset:0 sc1
    buffer_load_dwordx4 v[116:119], v7, s[32:35], s49 offen offset:0 sc1
    buffer_load_dwordx4 v[120:123], v4, s[32:35], s49 offen offset:1024 sc1
    buffer_load_dwordx4 v[124:127], v7, s[32:35], s49 offen offset:1024 sc1
    buffer_load_dwordx4 v[128:131], v4, s[32:35], s49 offen offset:2048 sc1
    buffer_load_dwordx4 v[132:135], v7, s[32:35], s49 offen offset:2048 sc1
    buffer_load_dwordx4 v[136:139], v4, s[32:35], s49 offen offset:3072 sc1
    buffer_load_dwordx4 v[140:143], v7, s[32:35], s49 offen offset:3072 sc1
    s_add_u32 s49, s63, 4096
    buffer_load_dwordx4 v[168:171], v4, s[32:35], s49 offen offset:0 sc1
    buffer_load_dwordx4 v[172:175], v7, s[32:35], s49 offen offset:0 sc1
    buffer_load_dwordx4 v[212:215], v4, s[32:35], s49 offen offset:1024 sc1
    buffer_load_dwordx4 v[220:223], v7, s[32:35], s49 offen offset:1024 sc1
    s_waitcnt vmcnt(11)
    v_or3_b32 v0, v112, v113, v114
    s_waitcnt vmcnt(10)
    v_or3_b32 v5, v116, v117, v118
    v_or3_b32 v0, v0, v115, v119
    v_or_b32 v0, v0, v5
    v_cmp_gt_i32 vcc, 0, v0
    s_sub_u32 s48, s48, 1
    s_cmp_eq_u32 s48, 0
    s_cbranch_scc1 spb_84
    s_cbranch_vccnz sl_120
    s_branch spb_84
spin_85:
    s_mov_b32 s48, 0x10000
sl_121:
    s_add_u32 s49, s63, 0
    buffer_load_dwordx4 v[120:123], v4, s[32:35], s49 offen offset:1024 sc1
    buffer_load_dwordx4 v[124:127], v7, s[32:35], s49 offen offset:1024 sc1
    buffer_load_dwordx4 v[128:131], v4, s[32:35], s49 offen offset:2048 sc1
    buffer_load_dwordx4 v[132:135], v7, s[32:35], s49 offen offset:2048 sc1
    buffer_load_dwordx4 v[136:139], v4, s[32:35], s49 offen offset:3072 sc1
    buffer_load_dwordx4 v[140:143], v7, s[32:35], s49 offen offset:3072 sc1
    s_add_u32 s49, s63, 4096
    buffer_load_dwordx4 v[168:171], v4, s[32:35], s49 offen offset:0 sc1
    buffer_load_dwordx4 v[172:175], v7, s[32:35], s49 offen offset:0 sc1
    buffer_load_dwordx4 v[212:215], v4, s[32:35], s49 offen offset:1024 sc1
    buffer_load_dwordx4 v[220:223], v7, s[32:35], s49 offen offset:1024 sc1
    buffer_load_dwordx4 v[112:115], v4, s[32:35], s49 offen offset:2048 sc1
    buffer_load_dwordx4 v[116:119], v7, s[32:35], s49 offen offset:2048 sc1
    s_waitcnt vmcnt(11)
    v_or3_b32 v0, v120, v121, v122
    s_waitcnt vmcnt(10)
    v_or3_b32 v5, v124, v125, v126
    v_or3_b32 v0, v0, v123, v127
    v_or_b32 v0, v0, v5
    v_cmp_gt_i32 vcc, 0, v0
    s_sub_u32 s48, s48, 1
    s_cmp_eq_u32 s48, 0
    s_cbranch_scc1 spb_86
    s_cbranch_vccnz sl_121
    s_branch spb_86
spin_87:
    s_mov_b32 s48, 0x10000
sl_122:
    s_add_u32 s49, s63, 0
    buffer_load_dwordx4 v[128:131], v4, s[32:35], s49 offen offset:2048 sc1
    buffer_load_dwordx4 v[132:135], v7, s[32:35], s49 offen offset:2048 sc1
    buffer_load_dwordx4 v[136:139], v4, s[32:35], s49 offen offset:3072 sc1
    buffer_load_dwordx4 v[140:143], v7, s[32:35], s49 offen offset:3072 sc1
    s_add_u32 s49, s63, 4096
    buffer_load_dwordx4 v[168:171], v4, s[32:35], s49 offen offset:0 sc1
    buffer_load_dwordx4 v[172:175], v7, s[32:35], s49 offen offset:0 sc1
    buffer_load_dwordx4 v[212:215], v4, s[32:35], s49 offen offset:1024 sc1
    buffer_load_dwordx4 v[220:223], v7, s[32:35], s49 offen offset:1024 sc1
    buffer_load_dwordx4 v[112:115], v4, s[32:35], s49 offen offset:2048 sc1
    buffer_load_dwordx4 v[116:119], v7, s[32:35], s49 offen offset:2048 sc1
    buffer_load_dwordx4 v[120:123], v4, s[32:35], s49 offen offset:3072 sc1
    buffer_load_dwordx4 v[124:127], v7, s[32:35], s49 offen offset:3072 sc1
    s_waitcnt vmcnt(11)
    v_or3_b32 v0, v128, v129, v130
    s_waitcnt vmcnt(10)
    v_or3_b32 v5, v132, v133, v134
    v_or3_b32 v0, v0, v131, v135
    v_or_b32 v0, v0, v5
    v_cmp_gt_i32 vcc, 0, v0
    s_sub_u32 s48, s48, 1
    s_cmp_eq_u32 s48, 0
    s_cbranch_scc1 spb_88
    s_cbranch_vccnz sl_122
    s_branch spb_88
spin_89:
    s_mov_b32 s48, 0x10000
sl_123:
    s_add_u32 s49, s63, 0
    buffer_load_dwordx4 v[136:139], v4, s[32:35], s49 offen offset:3072 sc1
    buffer_load_dwordx4 v[140:143], v7, s[32:35], s49 offen offset:3072 sc1
    s_add_u32 s49, s63, 4096
    buffer_load_dwordx4 v[168:171], v4, s[32:35], s49 offen offset:0 sc1
    buffer_load_dwordx4 v[172:175], v7, s[32:35], s49 offen offset:0 sc1
    buffer_load_dwordx4 v[212:215], v4, s[32:35], s49 offen offset:1024 sc1
    buffer_load_dwordx4 v[220:223], v7, s[32:35], s49 offen offset:1024 sc1
    buffer_load_dwordx4 v[112:115], v4, s[32:35], s49 offen offset:2048 sc1
    buffer_load_dwordx4 v[116:119], v7, s[32:35], s49 offen offset:2048 sc1
    buffer_load_dwordx4 v[120:123], v4, s[32:35], s49 offen offset:3072 sc1
    buffer_load_dwordx4 v[124:127], v7, s[32:35], s49 offen offset:3072 sc1
    s_add_u32 s49, s63, 8192
    buffer_load_dwordx4 v[128:131], v4, s[32:35], s49 offen offset:0 sc1
    buffer_load_dwordx4 v[132:135], v7, s[32:35], s49 offen offset:0 sc1
    s_waitcnt vmcnt(11)
    v_or3_b32 v0, v136, v137, v138
    s_waitcnt vmcnt(10)
    v_or3_b32 v5, v140, v141, v142
    v_or3_b32 v0, v0, v139, v143
    v_or_b32 v0, v0, v5
    v_cmp_gt_i32 vcc, 0, v0
    s_sub_u32 s48, s48, 1
    s_cmp_eq_u32 s48, 0
    s_cbranch_scc1 spb_90
    s_cbranch_vccnz sl_123
    s_branch spb_90
spin_91:
    s_mov_b32 s48, 0x10000
sl_124:
    s_add_u32 s49, s63, 4096
    buffer_load_dwordx4 v[168:171], v4, s[32:35], s49 offen offset:0 sc1
    buffer_load_dwordx4 v[172:175], v7, s[32:35], s49 offen offset:0 sc1
    buffer_load_dwordx4 v[212:215], v4, s[32:35], s49 offen offset:1024 sc1
    buffer_load_dwordx4 v[220:223], v7, s[32:35], s49 offen offset:1024 sc1
    buffer_load_dwordx4 v[112:115], v4, s[32:35], s49 offen offset:2048 sc1
    buffer_load_dwordx4 v[116:119], v7, s[32:35], s49 offen offset:2048 sc1
    buffer_load_dwordx4 v[120:123], v4, s[32:35], s49 offen offset:3072 sc1
    buffer_load_dwordx4 v[124:127], v7, s[32:35], s49 offen offset:3072 sc1
    s_add_u32 s49, s63, 8192
    buffer_load_dwordx4 v[128:131], v4, s[32:35], s49 offen offset:0 sc1
    buffer_load_dwordx4 v[132:135], v7, s[32:35], s49 offen offset:0 sc1
    buffer_load_dwordx4 v[136:139], v4, s[32:35], s49 offen offset:1024 sc1
    buffer_load_dwordx4 v[140:143], v7, s[32:35], s49 offen offset:1024 sc1
    s_waitcnt vmcnt(11)
    v_or3_b32 v0, v168, v169, v170
    s_waitcnt vmcnt(10)
    v_or3_b32 v5, v172, v173, v174
    v_or3_b32 v0, v0, v171, v175
    v_or_b32 v0, v0, v5
    v_cmp_gt_i32 vcc, 0, v0
    s_sub_u32 s48, s48, 1
    s_cmp_eq_u32 s48, 0
    s_cbranch_scc1 spb_92
    s_cbranch_vccnz sl_124
    s_branch spb_92
spin_93:
    s_mov_b32 s48, 0x10000
sl_125:
    s_add_u32 s49, s63, 4096
    buffer_load_dwordx4 v[212:215], v4, s[32:35], s49 offen offset:1024 sc1
    buffer_load_dwordx4 v[220:223], v7, s[32:35], s49 offen offset:1024 sc1
    buffer_load_dwordx4 v[112:115], v4, s[32:35], s49 offen offset:2048 sc1
    buffer_load_dwordx4 v[116:119], v7, s[32:35], s49 offen offset:2048 sc1
    buffer_load_dwordx4 v[120:123], v4, s[32:35], s49 offen offset:3072 sc1
    buffer_load_dwordx4 v[124:127], v7, s[32:35], s49 offen offset:3072 sc1
    s_add_u32 s49, s63, 8192
    buffer_load_dwordx4 v[128:131], v4, s[32:35], s49 offen offset:0 sc1
    buffer_load_dwordx4 v[132:135], v7, s[32:35], s49 offen offset:0 sc1
    buffer_load_dwordx4 v[136:139], v4, s[32:35], s49 offen offset:1024 sc1
    buffer_load_dwordx4 v[140:143], v7, s[32:35], s49 offen offset:1024 sc1
    buffer_load_dwordx4 v[168:171], v4, s[32:35], s49 offen offset:2048 sc1
    buffer_load_dwordx4 v[172:175], v7, s[32:35], s49 offen offset:2048 sc1
    s_waitcnt vmcnt(11)
    v_or3_b32 v0, v212, v213, v214
    s_waitcnt vmcnt(10)
    v_or3_b32 v5, v220, v221, v222
    v_or3_b32 v0, v0, v215, v223
    v_or_b32 v0, v0, v5
    v_cmp_gt_i32 vcc, 0, v0
    s_sub_u32 s48, s48, 1
    s_cmp_eq_u32 s48, 0
    s_cbranch_scc1 spb_94
    s_cbranch_vccnz sl_125
    s_branch spb_94
spin_95:
    s_mov_b32 s48, 0x10000
sl_126:
    s_add_u32 s49, s63, 4096
    buffer_load_dwordx4 v[112:115], v4, s[32:35], s49 offen offset:2048 sc1
    buffer_load_dwordx4 v[116:119], v7, s[32:35], s49 offen offset:2048 sc1
    buffer_load_dwordx4 v[120:123], v4, s[32:35], s49 offen offset:3072 sc1
    buffer_load_dwordx4 v[124:127], v7, s[32:35], s49 offen offset:3072 sc1
    s_add_u32 s49, s63, 8192
    buffer_load_dwordx4 v[128:131], v4, s[32:35], s49 offen offset:0 sc1
    buffer_load_dwordx4 v[132:135], v7, s[32:35], s49 offen offset:0 sc1
    buffer_load_dwordx4 v[136:139], v4, s[32:35], s49 offen offset:1024 sc1
    buffer_load_dwordx4 v[140:143], v7, s[32:35], s49 offen offset:1024 sc1
    buffer_load_dwordx4 v[168:171], v4, s[32:35], s49 offen offset:2048 sc1
    buffer_load_dwordx4 v[172:175], v7, s[32:35], s49 offen offset:2048 sc1
    buffer_load_dwordx4 v[212:215], v4, s[32:35], s49 offen offset:3072 sc1
    buffer_load_dwordx4 v[220:223], v7, s[32:35], s49 offen offset:3072 sc1
    s_waitcnt vmcnt(11)
    v_or3_b32 v0, v112, v113, v114
    s_waitcnt vmcnt(10)
    v_or3_b32 v5, v116, v117, v118
    v_or3_b32 v0, v0, v115, v119
    v_or_b32 v0, v0, v5
    v_cmp_gt_i32 vcc, 0, v0
    s_sub_u32 s48, s48, 1
    s_cmp_eq_u32 s48, 0
    s_cbranch_scc1 spb_96
    s_cbranch_vccnz sl_126
    s_branch spb_96
spin_97:
    s_mov_b32 s48, 0x10000
sl_127:
    s_add_u32 s49, s63, 4096
    buffer_load_dwordx4 v[120:123], v4, s[32:35], s49 offen offset:3072 sc1
    buffer_load_dwordx4 v[124:127], v7, s[32:35], s49 offen offset:3072 sc1
    s_add_u32 s49, s63, 8192
    buffer_load_dwordx4 v[128:131], v4, s[32:35], s49 offen offset:0 sc1
    buffer_load_dwordx4 v[132:135], v7, s[32:35], s49 offen offset:0 sc1
    buffer_load_dwordx4 v[136:139], v4, s[32:35], s49 offen offset:1024 sc1
    buffer_load_dwordx4 v[140:143], v7, s[32:35], s49 offen offset:1024 sc1
    buffer_load_dwordx4 v[168:171], v4, s[32:35], s49 offen offset:2048 sc1
    buffer_load_dwordx4 v[172:175], v7, s[32:35], s49 offen offset:2048 sc1
    buffer_load_dwordx4 v[212:215], v4, s[32:35], s49 offen offset:3072 sc1
    buffer_load_dwordx4 v[220:223], v7, s[32:35], s49 offen offset:3072 sc1
    s_add_u32 s49, s63, 12288
    buffer_load_dwordx4 v[112:115], v4, s[32:35], s49 offen offset:0 sc1
    buffer_load_dwordx4 v[116:119], v7, s[32:35], s49 offen offset:0 sc1
    s_waitcnt vmcnt(11)
    v_or3_b32 v0, v120, v121, v122
    s_waitcnt vmcnt(10)
    v_or3_b32 v5, v124, v125, v126
    v_or3_b32 v0, v0, v123, v127
    v_or_b32 v0, v0, v5
    v_cmp_gt_i32 vcc, 0, v0
    s_sub_u32 s48, s48, 1
    s_cmp_eq_u32 s48, 0
    s_cbranch_scc1 spb_98
    s_cbranch_vccnz sl_127
    s_branch spb_98
spin_99:
    s_mov_b32 s48, 0x10000
sl_128:
    s_add_u32 s49, s63, 8192
    buffer_load_dwordx4 v[128:131], v4, s[32:35], s49 offen offset:0 sc1
    buffer_load_dwordx4 v[132:135], v7, s[32:35], s49 offen offset:0 sc1
    buffer_load_dwordx4 v[136:139], v4, s[32:35], s49 offen offset:1024 sc1
    buffer_load_dwordx4 v[140:143], v7, s[32:35], s49 offen offset:1024 sc1
    buffer_load_dwordx4 v[168:171], v4, s[32:35], s49 offen offset:2048 sc1
    buffer_load_dwordx4 v[172:175], v7, s[32:35], s49 offen offset:2048 sc1
    buffer_load_dwordx4 v[212:215], v4, s[32:35], s49 offen offset:3072 sc1
    buffer_load_dwordx4 v[220:223], v7, s[32:35], s49 offen offset:3072 sc1
    s_add_u32 s49, s63, 12288
    buffer_load_dwordx4 v[112:115], v4, s[32:35], s49 offen offset:0 sc1
    buffer_load_dwordx4 v[116:119], v7, s[32:35], s49 offen offset:0 sc1
    buffer_load_dwordx4 v[120:123], v4, s[32:35], s49 offen offset:1024 sc1
    buffer_load_dwordx4 v[124:127], v7, s[32:35], s49 offen offset:1024 sc1
    s_waitcnt vmcnt(11)
    v_or3_b32 v0, v128, v129, v130
    s_waitcnt vmcnt(10)
    v_or3_b32 v5, v132, v133, v134
    v_or3_b32 v0, v0, v131, v135
    v_or_b32 v0, v0, v5
    v_cmp_gt_i32 vcc, 0, v0
    s_sub_u32 s48, s48, 1
    s_cmp_eq_u32 s48, 0
    s_cbranch_scc1 spb_100
    s_cbranch_vccnz sl_128
    s_branch spb_100
spin_101:
    s_mov_b32 s48, 0x10000
sl_129:
    s_add_u32 s49, s63, 8192
    buffer_load_dwordx4 v[136:139], v4, s[32:35], s49 offen offset:1024 sc1
    buffer_load_dwordx4 v[140:143], v7, s[32:35], s49 offen offset:1024 sc1
    buffer_load_dwordx4 v[168:171], v4, s[32:35], s49 offen offset:2048 sc1
    buffer_load_dwordx4 v[172:175], v7, s[32:35], s49 offen offset:2048 sc1
    buffer_load_dwordx4 v[212:215], v4, s[32:35], s49 offen offset:3072 sc1
    buffer_load_dwordx4 v[220:223], v7, s[32:35], s49 offen offset:3072 sc1
    s_add_u32 s49, s63, 12288
    buffer_load_dwordx4 v[112:115], v4, s[32:35], s49 offen offset:0 sc1
    buffer_load_dwordx4 v[116:119], v7, s[32:35], s49 offen offset:0 sc1
    buffer_load_dwordx4 v[120:123], v4, s[32:35], s49 offen offset:1024 sc1
    buffer_load_dwordx4 v[124:127], v7, s[32:35], s49 offen offset:1024 sc1
    s_waitcnt vmcnt(9)
    v_or3_b32 v0, v136, v137, v138
    s_waitcnt vmcnt(8)
    v_or3_b32 v5, v140, v141, v142
    v_or3_b32 v0, v0, v139, v143
    v_or_b32 v0, v0, v5
    v_cmp_gt_i32 vcc, 0, v0
    s_sub_u32 s48, s48, 1
    s_cmp_eq_u32 s48, 0
    s_cbranch_scc1 spb_102
    s_cbranch_vccnz sl_129
    s_branch spb_102
spin_103:
    s_mov_b32 s48, 0x10000
sl_130:
    s_add_u32 s49, s63, 8192
    buffer_load_dwordx4 v[168:171], v4, s[32:35], s49 offen offset:2048 sc1
    buffer_load_dwordx4 v[172:175], v7, s[32:35], s49 offen offset:2048 sc1
    buffer_load_dwordx4 v[212:215], v4, s[32:35], s49 offen offset:3072 sc1
    buffer_load_dwordx4 v[220:223], v7, s[32:35], s49 offen offset:3072 sc1
    s_add_u32 s49, s63, 12288
    buffer_load_dwordx4 v[112:115], v4, s[32:35], s49 offen offset:0 sc1
    buffer_load_dwordx4 v[116:119], v7, s[32:35], s49 offen offset:0 sc1
    buffer_load_dwordx4 v[120:123], v4, s[32:35], s49 offen offset:1024 sc1
    buffer_load_dwordx4 v[124:127], v7, s[32:35], s49 offen offset:1024 sc1
    s_waitcnt vmcnt(7)
    v_or3_b32 v0, v168, v169, v170
    s_waitcnt vmcnt(6)
    v_or3_b32 v5, v172, v173, v174
    v_or3_b32 v0, v0, v171, v175
    v_or_b32 v0, v0, v5
    v_cmp_gt_i32 vcc, 0, v0
    s_sub_u32 s48, s48, 1
    s_cmp_eq_u32 s48, 0
    s_cbranch_scc1 spb_104
    s_cbranch_vccnz sl_130
    s_branch spb_104
spin_105:
    s_mov_b32 s48, 0x10000
sl_131:
    s_add_u32 s49, s63, 8192
    buffer_load_dwordx4 v[212:215], v4, s[32:35], s49 offen offset:3072 sc1
    buffer_load_dwordx4 v[220:223], v7, s[32:35], s49 offen offset:3072 sc1
    s_add_u32 s49, s63, 12288
    buffer_load_dwordx4 v[112:115], v4, s[32:35], s49 offen offset:0 sc1
    buffer_load_dwordx4 v[116:119], v7, s[32:35], s49 offen offset:0 sc1
    buffer_load_dwordx4 v[120:123], v4, s[32:35], s49 offen offset:1024 sc1
    buffer_load_dwordx4 v[124:127], v7, s[32:35], s49 offen offset:1024 sc1
    s_waitcnt vmcnt(5)
    v_or3_b32 v0, v212, v213, v214
    s_waitcnt vmcnt(4)
    v_or3_b32 v5, v220, v221, v222
    v_or3_b32 v0, v0, v215, v223
    v_or_b32 v0, v0, v5
    v_cmp_gt_i32 vcc, 0, v0
    s_sub_u32 s48, s48, 1
    s_cmp_eq_u32 s48, 0
    s_cbranch_scc1 spb_106
    s_cbranch_vccnz sl_131
    s_branch spb_106
spin_107:
    s_mov_b32 s48, 0x10000
sl_132:
    s_add_u32 s49, s63, 12288
    buffer_load_dwordx4 v[112:115], v4, s[32:35], s49 offen offset:0 sc1
    buffer_load_dwordx4 v[116:119], v7, s[32:35], s49 offen offset:0 sc1
    buffer_load_dwordx4 v[120:123], v4, s[32:35], s49 offen offset:1024 sc1
    buffer_load_dwordx4 v[124:127], v7, s[32:35], s49 offen offset:1024 sc1
    s_waitcnt vmcnt(3)
    v_or3_b32 v0, v112, v113, v114
    s_waitcnt vmcnt(2)
    v_or3_b32 v5, v116, v117, v118
    v_or3_b32 v0, v0, v115, v119
    v_or_b32 v0, v0, v5
    v_cmp_gt_i32 vcc, 0, v0
    s_sub_u32 s48, s48, 1
    s_cmp_eq_u32 s48, 0
    s_cbranch_scc1 spb_108
    s_cbranch_vccnz sl_132
    s_branch spb_108
spin_109:
    s_mov_b32 s48, 0x10000
sl_133:
    s_add_u32 s49, s63, 12288
    buffer_load_dwordx4 v[120:123], v4, s[32:35], s49 offen offset:1024 sc1
    buffer_load_dwordx4 v[124:127], v7, s[32:35], s49 offen offset:1024 sc1
    s_waitcnt vmcnt(1)
    v_or3_b32 v0, v120, v121, v122
    s_waitcnt vmcnt(0)
    v_or3_b32 v5, v124, v125, v126
    v_or3_b32 v0, v0, v123, v127
    v_or_b32 v0, v0, v5
    v_cmp_gt_i32 vcc, 0, v0
    s_sub_u32 s48, s48, 1
    s_cmp_eq_u32 s48, 0
    s_cbranch_scc1 spb_110
    s_cbranch_vccnz sl_133
    s_branch spb_110
.section .rodata,"a"
.p2align 6
.amdhsa_kernel fused_kernel
  .amdhsa_next_free_vgpr 256
  .amdhsa_next_free_sgpr 102
  .amdhsa_accum_offset 256
  .amdhsa_group_segment_fixed_size 0
  .amdhsa_kernarg_size 96
  .amdhsa_user_sgpr_count 2
  .amdhsa_user_sgpr_kernarg_segment_ptr 1
  .amdhsa_system_sgpr_workgroup_id_x 1
  .amdhsa_float_denorm_mode_32 3
  .amdhsa_float_denorm_mode_16_64 3
.end_amdhsa_kernel
```
